```python
import torch

def _softmax(x, axis=-1):
    return torch.softmax(x, dim=axis)
def _gelu(x):
    return torch.nn.functional.gelu(x, approximate="tanh")
def _silu(x):
    return torch.nn.functional.silu(x)
def _sigmoid(x):
    return torch.sigmoid(x)
def _layernorm(x, axis=-1, eps=1e-5):
    m = x.mean(dim=axis, keepdim=True)
    v = x.var(dim=axis, keepdim=True, unbiased=False)
    return (x - m) / torch.sqrt(v + eps)
def _scatter_add(tgt, idx, src, axis=0):
    return tgt.clone().index_add_(axis, idx, src)
def _segment_sum(src, seg, n):
    out = torch.zeros((n,) + src.shape[1:], dtype=src.dtype)
    return out.index_add_(0, seg, src)
def _pad(x, pw):
    flat = tuple(v for pair in reversed(pw) for v in pair)
    return torch.nn.functional.pad(x, flat)

kernel_name = 'parallel_sum__sliding_block__glu_gated_bilinear__prompt'

def setup_inputs():

    _w = (lambda a: (lambda t: t.to(torch.bfloat16) if t.is_floating_point() else t)(torch.as_tensor(a)))
    def _A_setup():
        B, S, D = 1, 2048, 512
        return {
            "x": _w((lambda *s: torch.randn(*s, dtype=torch.bfloat16) * 0.05)(B, S, D)),
            "wqkv": _w((lambda *s: torch.randn(*s, dtype=torch.bfloat16) * 0.05)(D, 3 * D)),
            "wo": _w((lambda *s: torch.randn(*s, dtype=torch.bfloat16) * 0.05)(D, D)),
        }
    _A_in = _A_setup()

    def _B_setup():
        B, S, D, F = 1, 2048, 512, 1792
        return {
            "x": _w((lambda *s: torch.randn(*s, dtype=torch.bfloat16) * 0.05)(B, S, D)),
            "w_gate": _w((lambda *s: torch.randn(*s, dtype=torch.bfloat16) * 0.8)(D, F) * (D ** -0.5)),
            "w_up": _w((lambda *s: torch.randn(*s, dtype=torch.bfloat16) * 0.8)(D, F) * (D ** -0.5)),
            "w_down": _w((lambda *s: torch.randn(*s, dtype=torch.bfloat16) * 0.8)(F, D) * (F ** -0.5)),
        }
    _B_in = _B_setup()

    return {
        "A_x": _A_in["x"],
        "A_wqkv": _A_in["wqkv"],
        "A_wo": _A_in["wo"],
        "B_x": _B_in["x"],
        "B_w_gate": _B_in["w_gate"],
        "B_w_up": _B_in["w_up"],
        "B_w_down": _B_in["w_down"],
    }

def reference(A_x, A_wqkv, A_wo, B_x, B_w_gate, B_w_up, B_w_down):
    def _A_ref(x, wqkv, wo):
        B, S, D = x.shape
        H = 32; Dh = D // H; W = 256
        qkv = (lambda x, *d: x.permute(*d))((x @ wqkv).reshape(B, S, 3, H, Dh), 2, 0, 3, 1, 4)
        q, k, v = qkv[0], qkv[1], qkv[2]
        scores = torch.einsum("bhqd,bhkd->bhqk", q, k) * (Dh ** -0.5)
        idx = torch.arange(S)
        mask = (idx[:, None] - idx[None, :] >= 0) & (idx[:, None] - idx[None, :] < W)
        scores = torch.where(mask[None, None], scores, -1e9)
        p = _softmax(scores, axis=-1)
        o = torch.einsum("bhqk,bhkd->bhqd", p, v)
        return (lambda x, *d: x.permute(*d))(o, 0, 2, 1, 3).reshape(B, S, D) @ wo

    def _B_ref(x, w_gate, w_up, w_down):
        g = torch.einsum("bsd,df->bsf", x, w_gate)
        u = torch.einsum("bsd,df->bsf", x, w_up)
        h = g * u
        return torch.einsum("bsf,fd->bsd", h, w_down)

    x = A_x
    xn = _layernorm(x, axis=-1)
    return x + _A_ref(xn, A_wqkv, A_wo) + _B_ref(xn, B_w_gate, B_w_up, B_w_down)
```

```asm
; @launch grid=(256,1,1) block=(256,1,1) lds=163840
.amdgcn_target "amdgcn-amd-amdhsa--gfx950"
.text
.globl parallel_sum__sliding_block__glu_gated_bilinear__prompt_kernel
.p2align 8
.type parallel_sum__sliding_block__glu_gated_bilinear__prompt_kernel,@function
parallel_sum__sliding_block__glu_gated_bilinear__prompt_kernel:
    s_cmp_ge_u32 s2, 256
    s_cbranch_scc1 k_exit
    s_load_dwordx16 s[8:23], s[0:1], 0
    s_getpc_b64 s[4:5]
k_pc:
    v_lshrrev_b32 v2, 3, v0
    s_lshr_b32 s6, s2, 3
    s_lshl_b32 s6, s6, 5
    v_add_lshl_u32 v2, v2, s6, 7
    v_min_u32 v2, k_end-k_pc-4, v2
    global_load_dword v26, v2, s[4:5]
    s_load_dwordx4 s[24:27], s[0:1], 64
    s_xor_b32 s2, s2, 1
    s_and_b32 s3, s2, 3
    s_lshr_b32 s74, s2, 6
    s_and_b32 s2, s2, 0x3c
    s_lshl_b32 s3, s3, 6
    s_or_b32 s2, s2, s74
    s_or_b32 s2, s2, s3
    v_lshrrev_b32 v1, 6, v0
    v_and_b32 v0, 63, v0
    s_and_b32 s74, s2, 7
    s_lshr_b32 s75, s2, 3
    v_readfirstlane_b32 s72, v1
    v_lshrrev_b32 v232, 3, v0
    s_and_b32 s76, s75, 3
    v_and_b32 v233, 7, v0
    s_lshr_b32 s77, s75, 2
    v_lshrrev_b32 v234, 4, v0
    s_lshr_b32 s51, s74, 1
    v_xor_b32 v234, v233, v234
    s_and_b32 s79, s51, 1
    v_lshlrev_b32 v235, 10, v232
    s_lshl_b32 s51, s51, 2
    v_lshl_add_u32 v228, v234, 4, v235
    s_add_u32 s51, s51, s76
    v_xor_b32 v229, 64, v228
    s_lshl_b32 s83, s76, 1
    v_add_u32 v229, 7168, v229
    s_xor_b32 s83, s83, s77
    v_add_u32 v230, 14336, v228
    s_xor_b32 s79, s79, s83
    v_add_u32 v231, 14336, v229
    s_lshl_b32 s51, s51, 2
    s_add_u32 s51, s51, s72
    s_and_b32 s3, s74, 1
    s_and_b32 s77, s77, 6
    s_or_b32 s3, s3, s77
    s_mul_i32 s73, s72, 40960
    s_lshl_b32 s79, s79, 7
    v_bfe_u32 v234, v0, 4, 1
    v_lshlrev_b32 v234, 2, v234
    v_xor_b32 v233, v233, v234
    v_lshlrev_b32 v233, 4, v233
    v_lshl_add_u32 v24, v232, 10, v233
    s_lshl_b32 s75, s72, 4
    v_add_u32 v232, s75, v232
    s_movk_i32 s76, 3072
    v_mad_u32_u24 v3, v232, s76, v233
    v_add_u32 v4, 23552, v3
    s_movk_i32 s76, 3584
    v_mad_u32_u24 v5, v232, s76, v233
    v_add_u32 v6, 27648, v5
    s_xor_b32 s64, s79, 0
    s_mul_i32 s56, s64, 1536
    s_mul_i32 s64, s64, 1792
    s_xor_b32 s65, s79, 128
    s_mul_i32 s57, s65, 1536
    s_mul_i32 s65, s65, 1792
    s_lshl_b32 s75, s51, 15
    s_lshl_b32 s74, s3, 7
    s_bitcmp1_b32 s2, 5
    s_cbranch_scc1 k_p
    v_add_u32 v248, 2048, v5
    v_add_u32 v249, 2048, v6
    s_waitcnt lgkmcnt(0)
    s_add_u32 s28, s8, s75
    s_addc_u32 s29, s9, 0
    s_sub_u32 s30, 0x200000, s75
    s_mov_b32 s31, 0x20000
    s_add_u32 m0, s73, 0
    s_xor_b32 s76, s79, 0
    buffer_load_dwordx4 v228, s[28:31], s76 offen offset:0 lds
    buffer_load_dwordx4 v229, s[28:31], s76 offen offset:1024 lds
    buffer_load_dwordx4 v230, s[28:31], s76 offen offset:2048 lds
    buffer_load_dwordx4 v231, s[28:31], s76 offen offset:3072 lds
    s_add_u32 s32, s10, s74
    s_addc_u32 s33, s11, 0
    s_sub_u32 s34, 0x180000, s74
    s_mov_b32 s35, 0x20000
    s_add_u32 s40, s16, s74
    s_addc_u32 s41, s17, 0
    s_sub_u32 s42, 0x1c0000, s74
    s_mov_b32 s43, 0x20000
    s_and_b32 s76, s51, 31
    v_and_b32 v237, 15, v0
    v_lshl_add_u32 v237, s76, 4, v237
    v_mul_u32_u24 v237, 3584, v237
    s_add_u32 m0, s73, 16384
    s_nop 0
    buffer_load_dwordx4 v3, s[32:35], s56 offen lds
    buffer_load_dwordx4 v4, s[32:35], s56 offen offset:1024 lds
    s_add_u32 m0, s73, 18432
    s_nop 0
    buffer_load_dwordx4 v248, s[40:43], s64 offen lds
    buffer_load_dwordx4 v249, s[40:43], s64 offen offset:1024 lds
    s_add_u32 s44, s18, s74
    s_addc_u32 s45, s19, 0
    s_sub_u32 s46, 0x1c0000, s74
    s_mov_b32 s47, 0x20000
    s_add_u32 m0, s73, 20480
    s_nop 0
    buffer_load_dwordx4 v248, s[44:47], s64 offen lds
    buffer_load_dwordx4 v249, s[44:47], s64 offen offset:1024 lds
    s_add_u32 m0, s73, 4096
    s_xor_b32 s76, s79, 128
    buffer_load_dwordx4 v228, s[28:31], s76 offen offset:0 lds
    buffer_load_dwordx4 v229, s[28:31], s76 offen offset:1024 lds
    buffer_load_dwordx4 v230, s[28:31], s76 offen offset:2048 lds
    buffer_load_dwordx4 v231, s[28:31], s76 offen offset:3072 lds
    s_mov_b32 s52, s26
    s_mov_b32 s53, s27
    s_mov_b32 s54, 0x10000000
    s_mov_b32 s55, 0x20000
    s_mov_b32 s26, 256
    s_mov_b32 s27, 0x20000
    s_or_b32 s76, s2, s72
    s_cbranch_scc1 noep_1
    s_memrealtime s[76:77]
    s_waitcnt lgkmcnt(0)
    s_or_b32 s76, s76, 1
    v_mov_b32 v28, s76
    v_mov_b32 v29, s77
    s_mov_b64 exec, 1
    buffer_store_dwordx2 v[28:29], off, s[24:27], 0 sc1
    s_mov_b64 exec, -1
noep_1:
    v_and_b32 v232, 31, v0
    v_lshlrev_b32 v232, 7, v232
    v_add_u32 v232, s73, v232
    v_bfe_u32 v233, v0, 1, 3
    v_lshrrev_b32 v234, 5, v0
    s_lshl_b32 s74, s72, 1
    v_xor_b32 v233, v233, v234
    v_xor_b32 v233, s74, v233
    v_xor_b32 v235, 0, v233
    v_lshl_add_u32 v224, v235, 4, v232
    v_xor_b32 v235, 2, v233
    v_lshl_add_u32 v225, v235, 4, v232
    v_xor_b32 v235, 4, v233
    v_lshl_add_u32 v226, v235, 4, v232
    v_xor_b32 v235, 6, v233
    v_lshl_add_u32 v227, v235, 4, v232
    v_mov_b32 v16, 0
    v_mov_b32 v17, 0
    v_mov_b32 v18, 0
    v_mov_b32 v19, 0
    v_lshlrev_b32 v232, 10, v234
    v_bfe_u32 v233, v0, 2, 2
    v_lshl_add_u32 v232, v233, 7, v232
    v_bfe_u32 v233, v0, 3, 1
    v_lshl_add_u32 v232, v233, 6, v232
    v_bfe_u32 v233, v0, 4, 1
    v_lshl_add_u32 v232, v233, 5, v232
    v_and_b32 v233, 3, v0
    v_lshl_add_u32 v232, v233, 3, v232
    v_xor_b32 v233, 64, v232
    s_xor_b32 s74, s72, 0
    s_mul_i32 s74, s74, 40960
    v_add_u32 v7, s74, v232
    v_add_u32 v8, s74, v233
    s_xor_b32 s74, s72, 1
    s_mul_i32 s74, s74, 40960
    v_add_u32 v9, s74, v232
    v_add_u32 v10, s74, v233
    s_xor_b32 s74, s72, 2
    s_mul_i32 s74, s74, 40960
    v_add_u32 v11, s74, v232
    v_add_u32 v12, s74, v233
    s_xor_b32 s74, s72, 3
    s_mul_i32 s74, s74, 40960
    v_add_u32 v13, s74, v232
    v_add_u32 v14, s74, v233
    v_mov_b32 v232, 0x3f803f80
    s_mov_b32 vcc_lo, 0x30003
    s_mov_b32 vcc_hi, 0x3000300
    v_cndmask_b32 v233, 0, v232, vcc
    s_lshl_b64 vcc, vcc, 4
    v_cndmask_b32 v234, 0, v232, vcc
    v_and_b32 v232, 1, v0
    v_mul_u32_u24 v232, 0xaaaa, v232
    v_add_u32 v30, 0x4444, v232
    v_accvgpr_write_b32 a224, v233
    v_accvgpr_write_b32 a225, v233
    v_accvgpr_write_b32 a226, v234
    v_accvgpr_write_b32 a227, v234
    v_accvgpr_write_b32 a212, 0
    v_accvgpr_write_b32 a213, 0
    v_accvgpr_write_b32 a214, 0
    v_accvgpr_write_b32 a215, 0
    v_accvgpr_write_b32 a192, 0
    v_accvgpr_write_b32 a193, 0
    v_accvgpr_write_b32 a194, 0
    v_accvgpr_write_b32 a195, 0
    v_accvgpr_write_b32 a196, 0
    v_accvgpr_write_b32 a197, 0
    v_accvgpr_write_b32 a198, 0
    v_accvgpr_write_b32 a199, 0
    v_accvgpr_write_b32 a200, 0
    v_accvgpr_write_b32 a201, 0
    v_accvgpr_write_b32 a202, 0
    v_accvgpr_write_b32 a203, 0
    v_accvgpr_write_b32 a204, 0
    v_accvgpr_write_b32 a205, 0
    v_accvgpr_write_b32 a206, 0
    v_accvgpr_write_b32 a207, 0
    v_accvgpr_write_b32 a208, 0
    v_accvgpr_write_b32 a209, 0
    v_accvgpr_write_b32 a210, 0
    v_accvgpr_write_b32 a211, 0
    v_mov_b32 v235, 0x3f803f80
    v_accvgpr_write_b32 a68, v235
    v_accvgpr_mov_b32 a69, a68
    v_accvgpr_mov_b32 a70, a68
    v_accvgpr_mov_b32 a71, a68
    v_accvgpr_mov_b32 a72, a68
    v_accvgpr_mov_b32 a73, a68
    v_accvgpr_mov_b32 a74, a68
    v_accvgpr_mov_b32 a75, a68
    v_accvgpr_mov_b32 a80, a68
    v_accvgpr_mov_b32 a81, a68
    v_accvgpr_mov_b32 a82, a68
    v_accvgpr_mov_b32 a83, a68
    v_accvgpr_mov_b32 a84, a68
    v_accvgpr_mov_b32 a85, a68
    v_accvgpr_mov_b32 a86, a68
    v_accvgpr_mov_b32 a87, a68
    v_accvgpr_mov_b32 a92, a68
    v_accvgpr_mov_b32 a93, a68
    v_accvgpr_mov_b32 a94, a68
    v_accvgpr_mov_b32 a95, a68
    v_accvgpr_mov_b32 a96, a68
    v_accvgpr_mov_b32 a97, a68
    v_accvgpr_mov_b32 a98, a68
    v_accvgpr_mov_b32 a99, a68
    v_accvgpr_mov_b32 a104, a68
    v_accvgpr_mov_b32 a105, a68
    v_accvgpr_mov_b32 a106, a68
    v_accvgpr_mov_b32 a107, a68
    v_accvgpr_mov_b32 a108, a68
    v_accvgpr_mov_b32 a109, a68
    v_accvgpr_mov_b32 a110, a68
    v_accvgpr_mov_b32 a111, a68
    v_accvgpr_mov_b32 a116, a68
    v_accvgpr_mov_b32 a117, a68
    v_accvgpr_mov_b32 a118, a68
    v_accvgpr_mov_b32 a119, a68
    v_accvgpr_mov_b32 a120, a68
    v_accvgpr_mov_b32 a121, a68
    v_accvgpr_mov_b32 a122, a68
    v_accvgpr_mov_b32 a123, a68
    v_accvgpr_mov_b32 a128, a68
    v_accvgpr_mov_b32 a129, a68
    v_accvgpr_mov_b32 a130, a68
    v_accvgpr_mov_b32 a131, a68
    v_accvgpr_mov_b32 a132, a68
    v_accvgpr_mov_b32 a133, a68
    v_accvgpr_mov_b32 a134, a68
    v_accvgpr_mov_b32 a135, a68
    v_accvgpr_mov_b32 a140, a68
    v_accvgpr_mov_b32 a141, a68
    v_accvgpr_mov_b32 a142, a68
    s_add_u32 m0, s73, 22528
    s_nop 0
    buffer_load_dwordx4 v3, s[32:35], s57 offen lds
    buffer_load_dwordx4 v4, s[32:35], s57 offen offset:1024 lds
    s_waitcnt vmcnt(12)
    ds_read_b128 v[32:35], v224 offset:0
    ds_read_b128 v[36:39], v225 offset:0
    ds_read_b128 v[40:43], v226 offset:0
    ds_read_b128 v[44:47], v227 offset:0
    s_waitcnt lgkmcnt(0)
    v_dot2_f32_bf16 v16, v32, v32, v16
    v_dot2_f32_bf16 v17, v33, v33, v17
    v_dot2_f32_bf16 v18, v34, v34, v18
    v_dot2_f32_bf16 v19, v35, v35, v19
    v_dot2_f32_bf16 v16, v36, v36, v16
    v_dot2_f32_bf16 v17, v37, v37, v17
    v_dot2_f32_bf16 v18, v38, v38, v18
    v_dot2_f32_bf16 v19, v39, v39, v19
    v_dot2_f32_bf16 v16, v40, v40, v16
    v_dot2_f32_bf16 v17, v41, v41, v17
    v_dot2_f32_bf16 v18, v42, v42, v18
    v_dot2_f32_bf16 v19, v43, v43, v19
    v_dot2_f32_bf16 v16, v44, v44, v16
    v_dot2_f32_bf16 v17, v45, v45, v17
    v_dot2_f32_bf16 v18, v46, v46, v18
    v_dot2_f32_bf16 v19, v47, v47, v19
    v_smfmac_f32_16x16x64_bf16 a[212:215], a[224:227], v[32:39], v30
    v_smfmac_f32_16x16x64_bf16 a[212:215], a[224:227], v[40:47], v30
    s_waitcnt vmcnt(8)
    s_barrier
    ds_read_b64_tr_b16 a[0:1], v7 offset:16384
    ds_read_b64_tr_b16 a[2:3], v7 offset:16896
    ds_read_b64_tr_b16 a[4:5], v8 offset:16384
    ds_read_b64_tr_b16 a[6:7], v8 offset:16896
    ds_read_b64_tr_b16 a[8:9], v7 offset:18432
    ds_read_b64_tr_b16 a[10:11], v7 offset:18944
    ds_read_b64_tr_b16 a[12:13], v8 offset:18432
    ds_read_b64_tr_b16 a[14:15], v8 offset:18944
    ds_read_b64_tr_b16 a[16:17], v9 offset:16384
    ds_read_b64_tr_b16 a[18:19], v9 offset:16896
    ds_read_b64_tr_b16 a[20:21], v10 offset:16384
    ds_read_b64_tr_b16 a[22:23], v10 offset:16896
    s_waitcnt lgkmcnt(8)
    v_mfma_f32_32x32x16_bf16 v[160:175], a[0:3], v[32:35], 0
    ds_read_b64_tr_b16 a[24:25], v9 offset:18432
    ds_read_b64_tr_b16 a[26:27], v9 offset:18944
    s_add_u32 m0, s73, 24576
    s_xor_b32 s66, s79, 256
    s_mul_i32 s58, s66, 1536
    v_mfma_f32_32x32x16_bf16 v[176:191], a[4:7], v[32:35], 0
    ds_read_b64_tr_b16 a[28:29], v10 offset:18432
    ds_read_b64_tr_b16 a[30:31], v10 offset:18944
    buffer_load_dwordx4 v248, s[40:43], s65 offen lds
    s_mul_i32 s66, s66, 1792
    s_xor_b32 s67, s79, 384
    v_smfmac_f32_16x16x64_bf16 a[192:195], a[224:227], a[0:7], v30
    s_waitcnt lgkmcnt(8)
    v_mfma_f32_32x32x16_bf16 v[192:207], a[8:11], v[32:35], 0
    ds_read_b64_tr_b16 a[0:1], v11 offset:16384
    ds_read_b64_tr_b16 a[2:3], v11 offset:16896
    buffer_load_dwordx4 v249, s[40:43], s65 offen offset:1024 lds
    s_add_u32 m0, s73, 26624
    s_mul_i32 s59, s67, 1536
    v_mfma_f32_32x32x16_bf16 v[208:223], a[12:15], v[32:35], 0
    ds_read_b64_tr_b16 a[4:5], v12 offset:16384
    ds_read_b64_tr_b16 a[6:7], v12 offset:16896
    s_mul_i32 s67, s67, 1792
    s_xor_b32 s68, s79, 512
    s_mul_i32 s60, s68, 1536
    v_smfmac_f32_16x16x64_bf16 a[196:199], a[224:227], a[8:15], v30
    s_waitcnt lgkmcnt(8)
    v_mfma_f32_32x32x16_bf16 v[160:175], a[16:19], v[36:39], v[160:175]
    ds_read_b64_tr_b16 a[8:9], v11 offset:18432
    ds_read_b64_tr_b16 a[10:11], v11 offset:18944
    buffer_load_dwordx4 v248, s[44:47], s65 offen lds
    s_mul_i32 s68, s68, 1792
    s_and_b32 s74, s2, 1
    v_mfma_f32_32x32x16_bf16 v[176:191], a[20:23], v[36:39], v[176:191]
    ds_read_b64_tr_b16 a[12:13], v12 offset:18432
    ds_read_b64_tr_b16 a[14:15], v12 offset:18944
    buffer_load_dwordx4 v249, s[44:47], s65 offen offset:1024 lds
    s_add_u32 m0, s73, 8192
    s_xor_b32 s76, s79, 256
    s_waitcnt lgkmcnt(8)
    v_mfma_f32_32x32x16_bf16 v[192:207], a[24:27], v[36:39], v[192:207]
    ds_read_b64_tr_b16 a[16:17], v13 offset:16384
    ds_read_b64_tr_b16 a[18:19], v13 offset:16896
    s_lshl_b32 s74, s74, 8
    s_add_u32 s4, s20, s74
    s_addc_u32 s5, s21, 0
    v_mfma_f32_32x32x16_bf16 v[208:223], a[28:31], v[36:39], v[208:223]
    ds_read_b64_tr_b16 a[20:21], v14 offset:16384
    ds_read_b64_tr_b16 a[22:23], v14 offset:16896
    buffer_load_dwordx4 v228, s[28:31], s76 offen offset:0 lds
    s_sub_u32 s6, 0x1c0000, s74
    s_mov_b32 s7, 0x20000
    s_waitcnt lgkmcnt(8)
    v_mfma_f32_32x32x16_bf16 v[160:175], a[0:3], v[40:43], v[160:175]
    ds_read_b64_tr_b16 a[24:25], v13 offset:18432
    ds_read_b64_tr_b16 a[26:27], v13 offset:18944
    s_add_u32 s12, s12, s74
    s_addc_u32 s13, s13, 0
    s_sub_u32 s14, 0x80000, s74
    v_mfma_f32_32x32x16_bf16 v[176:191], a[4:7], v[40:43], v[176:191]
    ds_read_b64_tr_b16 a[28:29], v14 offset:18432
    ds_read_b64_tr_b16 a[30:31], v14 offset:18944
    buffer_load_dwordx4 v229, s[28:31], s76 offen offset:1024 lds
    s_mov_b32 s15, 0x20000
    s_waitcnt lgkmcnt(8)
    v_mfma_f32_32x32x16_bf16 v[192:207], a[8:11], v[40:43], v[192:207]
    s_waitcnt vmcnt(6)
    s_barrier
    ds_read_b64_tr_b16 a[0:1], v7 offset:20480
    ds_read_b64_tr_b16 a[2:3], v7 offset:20992
    buffer_load_dwordx4 v230, s[28:31], s76 offen offset:2048 lds
    v_mfma_f32_32x32x16_bf16 v[208:223], a[12:15], v[40:43], v[208:223]
    ds_read_b64_tr_b16 a[4:5], v8 offset:20480
    ds_read_b64_tr_b16 a[6:7], v8 offset:20992
    ds_read_b128 v[48:51], v224 offset:4096
    s_waitcnt lgkmcnt(9)
    v_mfma_f32_32x32x16_bf16 v[160:175], a[16:19], v[44:47], v[160:175]
    ds_read_b64_tr_b16 a[8:9], v9 offset:20480
    ds_read_b64_tr_b16 a[10:11], v9 offset:20992
    buffer_load_dwordx4 v231, s[28:31], s76 offen offset:3072 lds
    ds_read_b128 v[52:55], v225 offset:4096
    v_mfma_f32_32x32x16_bf16 v[176:191], a[20:23], v[44:47], v[176:191]
    ds_read_b64_tr_b16 a[12:13], v10 offset:20480
    ds_read_b64_tr_b16 a[14:15], v10 offset:20992
    buffer_load_dword v26, v237, s[40:43], 0 offen
    ds_read_b128 v[56:59], v226 offset:4096
    s_waitcnt lgkmcnt(11)
    v_mfma_f32_32x32x16_bf16 v[192:207], a[24:27], v[44:47], v[192:207]
    ds_read_b64_tr_b16 a[16:17], v11 offset:20480
    ds_read_b64_tr_b16 a[18:19], v11 offset:20992
    ds_read_b128 v[60:63], v227 offset:4096
    v_mfma_f32_32x32x16_bf16 v[208:223], a[28:31], v[44:47], v[208:223]
    ds_read_b64_tr_b16 a[20:21], v12 offset:20480
    ds_read_b64_tr_b16 a[22:23], v12 offset:20992
    buffer_load_dword v26, v237, s[44:47], 0 offen
    s_add_u32 m0, s73, 28672
    s_waitcnt lgkmcnt(12)
    v_mfma_f32_32x32x16_bf16 a[32:47], a[0:3], v[32:35], 0
    ds_read_b64_tr_b16 a[24:25], v13 offset:20480
    ds_read_b64_tr_b16 a[26:27], v13 offset:20992
    s_bitcmp1_b32 s2, 3
    s_cselect_b32 s75, 0x80, 0
    s_xor_b32 s75, s75, s2
    v_mfma_f32_32x32x16_bf16 a[48:63], a[4:7], v[32:35], 0
    ds_read_b64_tr_b16 a[28:29], v14 offset:20480
    ds_read_b64_tr_b16 a[30:31], v14 offset:20992
    buffer_load_dwordx4 v3, s[32:35], s58 offen lds
    s_and_b32 s75, s75, 0xc0
    s_add_u32 s74, s74, s75
    v_smfmac_f32_16x16x64_bf16 a[200:203], a[224:227], a[0:7], v30
    s_waitcnt lgkmcnt(10)
    v_mfma_f32_32x32x16_bf16 a[32:47], a[8:11], v[36:39], a[32:47]
    ds_read_b64_tr_b16 a[0:1], v7 offset:22528
    ds_read_b64_tr_b16 a[2:3], v7 offset:23040
    buffer_load_dwordx4 v4, s[32:35], s58 offen offset:1024 lds
    s_add_u32 m0, s73, 30720
    s_lshl_b32 s75, s51, 15
    v_mfma_f32_32x32x16_bf16 a[48:63], a[12:15], v[36:39], a[48:63]
    ds_read_b64_tr_b16 a[4:5], v8 offset:22528
    ds_read_b64_tr_b16 a[6:7], v8 offset:23040
    s_add_u32 s75, s75, s74
    s_add_u32 s20, s22, s75
    s_addc_u32 s21, s23, 0
    s_waitcnt lgkmcnt(8)
    v_mfma_f32_32x32x16_bf16 a[32:47], a[16:19], v[40:43], a[32:47]
    ds_read_b64_tr_b16 a[8:9], v9 offset:22528
    ds_read_b64_tr_b16 a[10:11], v9 offset:23040
    buffer_load_dwordx4 v248, s[40:43], s66 offen lds
    s_sub_u32 s22, 0x200000, s75
    s_mov_b32 s23, 0x20000
    v_mfma_f32_32x32x16_bf16 a[48:63], a[20:23], v[40:43], a[48:63]
    ds_read_b64_tr_b16 a[12:13], v10 offset:22528
    ds_read_b64_tr_b16 a[14:15], v10 offset:23040
    buffer_load_dwordx4 v249, s[40:43], s66 offen offset:1024 lds
    s_add_u32 m0, s73, 32768
    s_waitcnt lgkmcnt(8)
    v_mfma_f32_32x32x16_bf16 a[32:47], a[24:27], v[44:47], a[32:47]
    ds_read_b64_tr_b16 a[16:17], v11 offset:22528
    ds_read_b64_tr_b16 a[18:19], v11 offset:23040
    s_add_u32 s8, s8, s75
    s_addc_u32 s9, s9, 0
    s_sub_u32 s10, 0x200000, s75
    v_dot2_f32_bf16 v16, v48, v48, v16
    v_dot2_f32_bf16 v17, v49, v49, v17
    v_dot2_f32_bf16 v18, v50, v50, v18
    v_dot2_f32_bf16 v19, v51, v51, v19
    v_dot2_f32_bf16 v16, v52, v52, v16
    v_dot2_f32_bf16 v17, v53, v53, v17
    v_dot2_f32_bf16 v18, v54, v54, v18
    v_dot2_f32_bf16 v19, v55, v55, v19
    v_dot2_f32_bf16 v16, v56, v56, v16
    v_dot2_f32_bf16 v17, v57, v57, v17
    v_dot2_f32_bf16 v18, v58, v58, v18
    v_dot2_f32_bf16 v19, v59, v59, v19
    v_dot2_f32_bf16 v16, v60, v60, v16
    v_dot2_f32_bf16 v17, v61, v61, v17
    v_dot2_f32_bf16 v18, v62, v62, v18
    v_dot2_f32_bf16 v19, v63, v63, v19
    v_smfmac_f32_16x16x64_bf16 a[212:215], a[224:227], v[48:55], v30
    v_smfmac_f32_16x16x64_bf16 a[212:215], a[224:227], v[56:63], v30
    v_mfma_f32_32x32x16_bf16 a[48:63], a[28:31], v[44:47], a[48:63]
    ds_read_b64_tr_b16 a[20:21], v12 offset:22528
    ds_read_b64_tr_b16 a[22:23], v12 offset:23040
    buffer_load_dwordx4 v248, s[44:47], s66 offen lds
    s_mov_b32 s11, 0x20000
    s_and_b32 s75, s51, 31
    s_waitcnt lgkmcnt(8)
    v_mfma_f32_32x32x16_bf16 v[160:175], a[0:3], v[48:51], v[160:175]
    ds_read_b64_tr_b16 a[24:25], v13 offset:22528
    ds_read_b64_tr_b16 a[26:27], v13 offset:23040
    s_and_b32 s74, s2, 0xc0
    s_lshl1_add_u32 s74, s75, s74
    v_bfe_u32 v236, v0, 1, 2
    v_mfma_f32_32x32x16_bf16 v[176:191], a[4:7], v[48:51], v[176:191]
    ds_read_b64_tr_b16 a[28:29], v14 offset:22528
    ds_read_b64_tr_b16 a[30:31], v14 offset:23040
    buffer_load_dwordx4 v249, s[44:47], s66 offen offset:1024 lds
    s_add_u32 m0, s73, 12288
    s_xor_b32 s76, s79, 384
    v_smfmac_f32_16x16x64_bf16 a[192:195], a[224:227], a[0:7], v30
    s_waitcnt lgkmcnt(8)
    v_mfma_f32_32x32x16_bf16 v[160:175], a[8:11], v[52:55], v[160:175]
    s_waitcnt vmcnt(12)
    s_barrier
    ds_read_b64_tr_b16 a[0:1], v7 offset:24576
    ds_read_b64_tr_b16 a[2:3], v7 offset:25088
    buffer_load_dwordx4 v228, s[28:31], s76 offen offset:0 lds
    v_mfma_f32_32x32x16_bf16 v[176:191], a[12:15], v[52:55], v[176:191]
    ds_read_b64_tr_b16 a[4:5], v8 offset:24576
    ds_read_b64_tr_b16 a[6:7], v8 offset:25088
    v_bfe_u32 v234, v0, 3, 2
    v_lshl_add_u32 v236, s74, 1, v236
    v_add_u32 v232, 1, v234
    s_waitcnt lgkmcnt(8)
    v_mfma_f32_32x32x16_bf16 v[160:175], a[16:19], v[56:59], v[160:175]
    ds_read_b64_tr_b16 a[8:9], v7 offset:26624
    ds_read_b64_tr_b16 a[10:11], v7 offset:27136
    buffer_load_dwordx4 v229, s[28:31], s76 offen offset:1024 lds
    v_lshrrev_b32 v232, 2, v232
    v_lshrrev_b32 v236, v232, v236
    v_mfma_f32_32x32x16_bf16 v[176:191], a[20:23], v[56:59], v[176:191]
    ds_read_b64_tr_b16 a[12:13], v8 offset:26624
    ds_read_b64_tr_b16 a[14:15], v8 offset:27136
    buffer_load_dwordx4 v230, s[28:31], s76 offen offset:2048 lds
    v_lshl_add_u32 v236, v234, 9, v236
    v_and_b32 v234, 1, v0
    s_waitcnt lgkmcnt(8)
    v_mfma_f32_32x32x16_bf16 v[160:175], a[24:27], v[60:63], v[160:175]
    ds_read_b64_tr_b16 a[16:17], v9 offset:24576
    ds_read_b64_tr_b16 a[18:19], v9 offset:25088
    v_lshl_add_u32 v236, v236, 3, v234
    v_lshlrev_b32 v27, 7, v236
    s_xor_b32 s69, s79, 640
    v_mfma_f32_32x32x16_bf16 v[176:191], a[28:31], v[60:63], v[176:191]
    ds_read_b64_tr_b16 a[20:21], v10 offset:24576
    ds_read_b64_tr_b16 a[22:23], v10 offset:25088
    buffer_load_dwordx4 v231, s[28:31], s76 offen offset:3072 lds
    s_add_u32 m0, s73, 34816
    s_mul_i32 s61, s69, 1536
    s_waitcnt lgkmcnt(8)
    v_mfma_f32_32x32x16_bf16 v[192:207], a[0:3], v[48:51], v[192:207]
    ds_read_b64_tr_b16 a[24:25], v9 offset:26624
    ds_read_b64_tr_b16 a[26:27], v9 offset:27136
    s_mul_i32 s69, s69, 1792
    s_xor_b32 s70, s79, 768
    s_mul_i32 s62, s70, 1536
    v_mfma_f32_32x32x16_bf16 v[208:223], a[4:7], v[48:51], v[208:223]
    ds_read_b64_tr_b16 a[28:29], v10 offset:26624
    ds_read_b64_tr_b16 a[30:31], v10 offset:27136
    buffer_load_dwordx4 v3, s[32:35], s59 offen lds
    s_waitcnt vmcnt(13)
    ds_read_b128 v[64:67], v224 offset:8192
    v_smfmac_f32_16x16x64_bf16 a[196:199], a[224:227], a[0:7], v30
    s_waitcnt lgkmcnt(9)
    v_mfma_f32_32x32x16_bf16 a[32:47], a[8:11], v[48:51], a[32:47]
    ds_read_b64_tr_b16 a[0:1], v11 offset:24576
    ds_read_b64_tr_b16 a[2:3], v11 offset:25088
    buffer_load_dwordx4 v4, s[32:35], s59 offen offset:1024 lds
    s_add_u32 m0, s73, 36864
    s_mul_i32 s70, s70, 1792
    v_mfma_f32_32x32x16_bf16 a[48:63], a[12:15], v[48:51], a[48:63]
    ds_read_b64_tr_b16 a[4:5], v12 offset:24576
    ds_read_b64_tr_b16 a[6:7], v12 offset:25088
    ds_read_b128 v[68:71], v225 offset:8192
    s_xor_b32 s71, s79, 896
    v_smfmac_f32_16x16x64_bf16 a[200:203], a[224:227], a[8:15], v30
    s_waitcnt lgkmcnt(10)
    v_mfma_f32_32x32x16_bf16 v[192:207], a[16:19], v[52:55], v[192:207]
    ds_read_b64_tr_b16 a[8:9], v11 offset:26624
    ds_read_b64_tr_b16 a[10:11], v11 offset:27136
    buffer_load_dwordx4 v248, s[40:43], s67 offen lds
    ds_read_b128 v[72:75], v226 offset:8192
    v_mfma_f32_32x32x16_bf16 v[208:223], a[20:23], v[52:55], v[208:223]
    ds_read_b64_tr_b16 a[12:13], v12 offset:26624
    ds_read_b64_tr_b16 a[14:15], v12 offset:27136
    buffer_load_dwordx4 v249, s[40:43], s67 offen offset:1024 lds
    s_add_u32 m0, s73, 16384
    s_mul_i32 s63, s71, 1536
    s_waitcnt lgkmcnt(11)
    v_mfma_f32_32x32x16_bf16 a[32:47], a[24:27], v[52:55], a[32:47]
    ds_read_b64_tr_b16 a[16:17], v13 offset:24576
    ds_read_b64_tr_b16 a[18:19], v13 offset:25088
    ds_read_b128 v[76:79], v227 offset:8192
    s_mul_i32 s71, s71, 1792
    v_mfma_f32_32x32x16_bf16 a[48:63], a[28:31], v[52:55], a[48:63]
    ds_read_b64_tr_b16 a[20:21], v14 offset:24576
    ds_read_b64_tr_b16 a[22:23], v14 offset:25088
    buffer_load_dwordx4 v248, s[44:47], s67 offen lds
    v_add_u32 v25, 7168, v24
    s_mul_i32 s80, s51, 98304
    s_waitcnt lgkmcnt(11)
    v_mfma_f32_32x32x16_bf16 v[192:207], a[0:3], v[56:59], v[192:207]
    ds_read_b64_tr_b16 a[24:25], v13 offset:26624
    ds_read_b64_tr_b16 a[26:27], v13 offset:27136
    s_lshl_b32 s74, s3, 12
    s_add_u32 s80, s80, s74
    s_mul_i32 s82, s51, 163840
    v_mfma_f32_32x32x16_bf16 v[208:223], a[4:7], v[56:59], v[208:223]
    ds_read_b64_tr_b16 a[28:29], v14 offset:26624
    ds_read_b64_tr_b16 a[30:31], v14 offset:27136
    buffer_load_dwordx4 v249, s[44:47], s67 offen offset:1024 lds
    s_add_u32 m0, s73, 0
    s_xor_b32 s76, s79, 512
    s_waitcnt lgkmcnt(9)
    v_mfma_f32_32x32x16_bf16 a[32:47], a[8:11], v[56:59], a[32:47]
    s_waitcnt vmcnt(12)
    s_barrier
    ds_read_b64_tr_b16 a[0:1], v7 offset:28672
    ds_read_b64_tr_b16 a[2:3], v7 offset:29184
    buffer_load_dwordx4 v228, s[28:31], s76 offen offset:0 lds
    v_mfma_f32_32x32x16_bf16 a[48:63], a[12:15], v[56:59], a[48:63]
    ds_read_b64_tr_b16 a[4:5], v8 offset:28672
    ds_read_b64_tr_b16 a[6:7], v8 offset:29184
    s_add_u32 s81, s82, s74
    s_add_u32 s81, s81, 0x800000
    s_add_u32 s82, s81, 0x10000
    s_waitcnt lgkmcnt(8)
    v_mfma_f32_32x32x16_bf16 v[192:207], a[16:19], v[60:63], v[192:207]
    ds_read_b64_tr_b16 a[8:9], v7 offset:30720
    ds_read_b64_tr_b16 a[10:11], v7 offset:31232
    buffer_load_dwordx4 v229, s[28:31], s76 offen offset:1024 lds
    v_lshlrev_b32 v1, 4, v0
    v_add_u32 v22, 0x8000, v1
    v_dot2_f32_bf16 v16, v64, v64, v16
    v_dot2_f32_bf16 v17, v65, v65, v17
    v_dot2_f32_bf16 v18, v66, v66, v18
    v_dot2_f32_bf16 v19, v67, v67, v19
    v_dot2_f32_bf16 v16, v68, v68, v16
    v_dot2_f32_bf16 v17, v69, v69, v17
    v_dot2_f32_bf16 v18, v70, v70, v18
    v_dot2_f32_bf16 v19, v71, v71, v19
    v_dot2_f32_bf16 v16, v72, v72, v16
    v_dot2_f32_bf16 v17, v73, v73, v17
    v_dot2_f32_bf16 v18, v74, v74, v18
    v_dot2_f32_bf16 v19, v75, v75, v19
    v_dot2_f32_bf16 v16, v76, v76, v16
    v_dot2_f32_bf16 v17, v77, v77, v17
    v_dot2_f32_bf16 v18, v78, v78, v18
    v_dot2_f32_bf16 v19, v79, v79, v19
    v_smfmac_f32_16x16x64_bf16 a[212:215], a[224:227], v[64:71], v30
    v_smfmac_f32_16x16x64_bf16 a[212:215], a[224:227], v[72:79], v30
    v_mfma_f32_32x32x16_bf16 v[208:223], a[20:23], v[60:63], v[208:223]
    ds_read_b64_tr_b16 a[12:13], v8 offset:30720
    ds_read_b64_tr_b16 a[14:15], v8 offset:31232
    buffer_load_dwordx4 v230, s[28:31], s76 offen offset:2048 lds
    v_lshrrev_b32 v232, 5, v0
    v_and_b32 v233, 15, v0
    s_waitcnt lgkmcnt(8)
    v_mfma_f32_32x32x16_bf16 a[32:47], a[24:27], v[60:63], a[32:47]
    ds_read_b64_tr_b16 a[16:17], v9 offset:28672
    ds_read_b64_tr_b16 a[18:19], v9 offset:29184
    v_lshlrev_b32 v233, 4, v233
    v_lshl_add_u32 v233, v232, 8, v233
    v_add_u32 v23, 0x10000, v233
    v_mfma_f32_32x32x16_bf16 a[48:63], a[28:31], v[60:63], a[48:63]
    ds_read_b64_tr_b16 a[20:21], v10 offset:28672
    ds_read_b64_tr_b16 a[22:23], v10 offset:29184
    buffer_load_dwordx4 v231, s[28:31], s76 offen offset:3072 lds
    s_lshr_b32 s100, s51, 2
    s_lshl1_add_u32 s100, s100, 0
    s_waitcnt lgkmcnt(8)
    v_mfma_f32_32x32x16_bf16 v[160:175], a[0:3], v[64:67], v[160:175]
    ds_read_b64_tr_b16 a[24:25], v9 offset:30720
    ds_read_b64_tr_b16 a[26:27], v9 offset:31232
    s_lshl_b32 s17, s3, 12
    s_or_b32 s16, s17, 0x0
    s_and_b32 s74, s2, 0xc0
    v_mfma_f32_32x32x16_bf16 v[176:191], a[4:7], v[64:67], v[176:191]
    ds_read_b64_tr_b16 a[28:29], v10 offset:30720
    ds_read_b64_tr_b16 a[30:31], v10 offset:31232
    buffer_load_dword v26, v27, s[4:7], 0 offen
    s_add_u32 m0, s73, 18432
    s_lshl_b32 s18, s74, 6
    v_smfmac_f32_16x16x64_bf16 a[192:195], a[224:227], a[0:7], v30
    s_waitcnt lgkmcnt(8)
    v_mfma_f32_32x32x16_bf16 v[192:207], a[8:11], v[64:67], v[192:207]
    ds_read_b64_tr_b16 a[0:1], v11 offset:28672
    ds_read_b64_tr_b16 a[2:3], v11 offset:29184
    buffer_load_dwordx4 v3, s[32:35], s60 offen lds
    s_lshl_b32 s74, s2, 4
    s_xor_b32 s74, s74, s2
    v_mfma_f32_32x32x16_bf16 v[208:223], a[12:15], v[64:67], v[208:223]
    ds_read_b64_tr_b16 a[4:5], v12 offset:28672
    ds_read_b64_tr_b16 a[6:7], v12 offset:29184
    s_and_b32 s74, s74, 0x80
    s_lshl_b32 s75, s72, 14
    s_or_b32 s74, s74, s75
    v_smfmac_f32_16x16x64_bf16 a[196:199], a[224:227], a[8:15], v30
    s_waitcnt lgkmcnt(8)
    v_mfma_f32_32x32x16_bf16 v[160:175], a[16:19], v[68:71], v[160:175]
    ds_read_b64_tr_b16 a[8:9], v11 offset:30720
    ds_read_b64_tr_b16 a[10:11], v11 offset:31232
    buffer_load_dwordx4 v4, s[32:35], s60 offen offset:1024 lds
    s_add_u32 m0, s73, 20480
    s_lshl4_add_u32 s19, s16, s74
    v_mfma_f32_32x32x16_bf16 v[176:191], a[20:23], v[68:71], v[176:191]
    ds_read_b64_tr_b16 a[12:13], v12 offset:30720
    ds_read_b64_tr_b16 a[14:15], v12 offset:31232
    buffer_load_dwordx4 v248, s[40:43], s68 offen lds
    s_lshl4_add_u32 s48, s17, s74
    s_lshl4_add_u32 s49, s18, s74
    s_waitcnt lgkmcnt(8)
    v_mfma_f32_32x32x16_bf16 v[192:207], a[24:27], v[68:71], v[192:207]
    ds_read_b64_tr_b16 a[16:17], v13 offset:28672
    ds_read_b64_tr_b16 a[18:19], v13 offset:29184
    s_lshl_b32 s0, s51, 4
    s_add_u32 s0, s0, s3
    s_lshl_b32 s0, s0, 7
    v_mfma_f32_32x32x16_bf16 v[208:223], a[28:31], v[68:71], v[208:223]
    ds_read_b64_tr_b16 a[20:21], v14 offset:28672
    ds_read_b64_tr_b16 a[22:23], v14 offset:29184
    buffer_load_dwordx4 v249, s[40:43], s68 offen offset:1024 lds
    s_add_u32 m0, s73, 4096
    s_xor_b32 s76, s79, 640
    s_waitcnt lgkmcnt(8)
    v_mfma_f32_32x32x16_bf16 v[160:175], a[0:3], v[72:75], v[160:175]
    ds_read_b64_tr_b16 a[24:25], v13 offset:30720
    ds_read_b64_tr_b16 a[26:27], v13 offset:31232
    s_waitcnt vmcnt(15)
    ds_read_b128 v[80:83], v224 offset:12288
    v_mfma_f32_32x32x16_bf16 v[176:191], a[4:7], v[72:75], v[176:191]
    ds_read_b64_tr_b16 a[28:29], v14 offset:30720
    ds_read_b64_tr_b16 a[30:31], v14 offset:31232
    buffer_load_dwordx4 v228, s[28:31], s76 offen offset:0 lds
    ds_read_b128 v[84:87], v225 offset:12288
    s_waitcnt lgkmcnt(10)
    v_mfma_f32_32x32x16_bf16 v[192:207], a[8:11], v[72:75], v[192:207]
    s_waitcnt vmcnt(14)
    s_barrier
    ds_read_b64_tr_b16 a[0:1], v7 offset:32768
    ds_read_b64_tr_b16 a[2:3], v7 offset:33280
    buffer_load_dwordx4 v229, s[28:31], s76 offen offset:1024 lds
    v_mfma_f32_32x32x16_bf16 v[208:223], a[12:15], v[72:75], v[208:223]
    ds_read_b64_tr_b16 a[4:5], v8 offset:32768
    ds_read_b64_tr_b16 a[6:7], v8 offset:33280
    ds_read_b128 v[88:91], v226 offset:12288
    v_min_u32 v232, 9, v0
    s_waitcnt lgkmcnt(11)
    v_mfma_f32_32x32x16_bf16 v[160:175], a[16:19], v[76:79], v[160:175]
    ds_read_b64_tr_b16 a[8:9], v9 offset:32768
    ds_read_b64_tr_b16 a[10:11], v9 offset:33280
    buffer_load_dwordx4 v230, s[28:31], s76 offen offset:2048 lds
    ds_read_b128 v[92:95], v227 offset:12288
    v_mfma_f32_32x32x16_bf16 v[176:191], a[20:23], v[76:79], v[176:191]
    ds_read_b64_tr_b16 a[12:13], v10 offset:32768
    ds_read_b64_tr_b16 a[14:15], v10 offset:33280
    buffer_load_dwordx4 v231, s[28:31], s76 offen offset:3072 lds
    s_add_u32 m0, s73, 22528
    v_and_b32 v233, 1, v0
    s_waitcnt lgkmcnt(11)
    v_mfma_f32_32x32x16_bf16 v[192:207], a[24:27], v[76:79], v[192:207]
    ds_read_b64_tr_b16 a[16:17], v11 offset:32768
    ds_read_b64_tr_b16 a[18:19], v11 offset:33280
    v_or_b32 v234, 8, v233
    v_cmp_gt_u32 vcc, 16, v0
    s_lshl_b32 s75, s100, 1
    v_mfma_f32_32x32x16_bf16 v[208:223], a[28:31], v[76:79], v[208:223]
    ds_read_b64_tr_b16 a[20:21], v12 offset:32768
    ds_read_b64_tr_b16 a[22:23], v12 offset:33280
    buffer_load_dwordx4 v3, s[32:35], s61 offen lds
    s_sub_u32 s75, s75, 8
    v_cndmask_b32 v232, v234, v232, vcc
    s_waitcnt lgkmcnt(10)
    v_mfma_f32_32x32x16_bf16 a[32:47], a[0:3], v[64:67], a[32:47]
    ds_read_b64_tr_b16 a[24:25], v13 offset:32768
    ds_read_b64_tr_b16 a[26:27], v13 offset:33280
    v_add_u32 v232, s75, v232
    v_max_i32 v232, 0, v232
    v_cndmask_b32 v234, 0, 8, vcc
    v_mfma_f32_32x32x16_bf16 a[48:63], a[4:7], v[64:67], a[48:63]
    ds_read_b64_tr_b16 a[28:29], v14 offset:32768
    ds_read_b64_tr_b16 a[30:31], v14 offset:33280
    buffer_load_dwordx4 v4, s[32:35], s61 offen offset:1024 lds
    s_add_u32 m0, s73, 24576
    v_lshl_add_u32 v234, v232, 4, v234
    v_smfmac_f32_16x16x64_bf16 a[200:203], a[224:227], a[0:7], v30
    s_waitcnt lgkmcnt(8)
    v_mfma_f32_32x32x16_bf16 a[32:47], a[8:11], v[68:71], a[32:47]
    ds_read_b64_tr_b16 a[0:1], v7 offset:34816
    ds_read_b64_tr_b16 a[2:3], v7 offset:35328
    buffer_load_dwordx4 v248, s[40:43], s69 offen lds
    v_add_lshl_u32 v234, v234, s3, 7
    v_and_b32 v232, 14, v0
    v_dot2_f32_bf16 v16, v80, v80, v16
    v_dot2_f32_bf16 v17, v81, v81, v17
    v_dot2_f32_bf16 v18, v82, v82, v18
    v_dot2_f32_bf16 v19, v83, v83, v19
    v_dot2_f32_bf16 v16, v84, v84, v16
    v_dot2_f32_bf16 v17, v85, v85, v17
    v_dot2_f32_bf16 v18, v86, v86, v18
    v_dot2_f32_bf16 v19, v87, v87, v19
    v_dot2_f32_bf16 v16, v88, v88, v16
    v_dot2_f32_bf16 v17, v89, v89, v17
    v_dot2_f32_bf16 v18, v90, v90, v18
    v_dot2_f32_bf16 v19, v91, v91, v19
    v_dot2_f32_bf16 v16, v92, v92, v16
    v_dot2_f32_bf16 v17, v93, v93, v17
    v_dot2_f32_bf16 v18, v94, v94, v18
    v_dot2_f32_bf16 v19, v95, v95, v19
    v_smfmac_f32_16x16x64_bf16 a[212:215], a[224:227], v[80:87], v30
    v_smfmac_f32_16x16x64_bf16 a[212:215], a[224:227], v[88:95], v30
    v_mfma_f32_32x32x16_bf16 a[48:63], a[12:15], v[68:71], a[48:63]
    ds_read_b64_tr_b16 a[4:5], v8 offset:34816
    ds_read_b64_tr_b16 a[6:7], v8 offset:35328
    s_and_b32 s75, s3, 6
    s_and_b32 s74, s51, 60
    v_lshl_add_u32 v232, v232, 2, v233
    s_waitcnt lgkmcnt(8)
    v_mfma_f32_32x32x16_bf16 a[32:47], a[16:19], v[72:75], a[32:47]
    ds_read_b64_tr_b16 a[8:9], v9 offset:34816
    ds_read_b64_tr_b16 a[10:11], v9 offset:35328
    buffer_load_dwordx4 v249, s[40:43], s69 offen offset:1024 lds
    s_add_u32 m0, s73, 8192
    s_xor_b32 s76, s79, 768
    v_mfma_f32_32x32x16_bf16 a[48:63], a[20:23], v[72:75], a[48:63]
    ds_read_b64_tr_b16 a[12:13], v10 offset:34816
    ds_read_b64_tr_b16 a[14:15], v10 offset:35328
    buffer_load_dwordx4 v228, s[28:31], s76 offen offset:0 lds
    s_lshl4_add_u32 s75, s74, s75
    v_add_lshl_u32 v235, v232, s75, 7
    s_waitcnt lgkmcnt(8)
    v_mfma_f32_32x32x16_bf16 a[32:47], a[24:27], v[76:79], a[32:47]
    ds_read_b64_tr_b16 a[16:17], v11 offset:34816
    ds_read_b64_tr_b16 a[18:19], v11 offset:35328
    v_accvgpr_write_b32 a248, v234
    v_accvgpr_write_b32 a249, v235
    v_and_b32 v232, 31, v0
    v_mfma_f32_32x32x16_bf16 a[48:63], a[28:31], v[76:79], a[48:63]
    ds_read_b64_tr_b16 a[20:21], v12 offset:34816
    ds_read_b64_tr_b16 a[22:23], v12 offset:35328
    buffer_load_dwordx4 v229, s[28:31], s76 offen offset:1024 lds
    v_lshrrev_b32 v233, 5, v0
    v_lshlrev_b32 v233, 2, v233
    s_waitcnt lgkmcnt(8)
    v_mfma_f32_32x32x16_bf16 v[160:175], a[0:3], v[80:83], v[160:175]
    ds_read_b64_tr_b16 a[24:25], v13 offset:34816
    ds_read_b64_tr_b16 a[26:27], v13 offset:35328
    v_sub_u32 v232, v232, v233
    v_accvgpr_write_b32 a250, v232
    v_accvgpr_mov_b32 a143, a68
    v_mfma_f32_32x32x16_bf16 v[176:191], a[4:7], v[80:83], v[176:191]
    ds_read_b64_tr_b16 a[28:29], v14 offset:34816
    ds_read_b64_tr_b16 a[30:31], v14 offset:35328
    buffer_load_dwordx4 v230, s[28:31], s76 offen offset:2048 lds
    v_accvgpr_mov_b32 a144, a68
    v_accvgpr_mov_b32 a145, a68
    v_smfmac_f32_16x16x64_bf16 a[192:195], a[224:227], a[0:7], v30
    s_waitcnt lgkmcnt(8)
    v_mfma_f32_32x32x16_bf16 v[160:175], a[8:11], v[84:87], v[160:175]
    s_waitcnt vmcnt(20)
    s_barrier
    ds_read_b64_tr_b16 a[0:1], v7 offset:36864
    ds_read_b64_tr_b16 a[2:3], v7 offset:37376
    buffer_load_dwordx4 v231, s[28:31], s76 offen offset:3072 lds
    v_mfma_f32_32x32x16_bf16 v[176:191], a[12:15], v[84:87], v[176:191]
    ds_read_b64_tr_b16 a[4:5], v8 offset:36864
    ds_read_b64_tr_b16 a[6:7], v8 offset:37376
    v_accvgpr_mov_b32 a146, a68
    v_accvgpr_mov_b32 a147, a68
    v_accvgpr_mov_b32 a152, a68
    s_waitcnt lgkmcnt(8)
    v_mfma_f32_32x32x16_bf16 v[160:175], a[16:19], v[88:91], v[160:175]
    ds_read_b64_tr_b16 a[8:9], v7 offset:16384
    ds_read_b64_tr_b16 a[10:11], v7 offset:16896
    buffer_load_dword v26, v27, s[12:15], 0 offen
    s_add_u32 m0, s73, 26624
    v_accvgpr_mov_b32 a153, a68
    v_mfma_f32_32x32x16_bf16 v[176:191], a[20:23], v[88:91], v[176:191]
    ds_read_b64_tr_b16 a[12:13], v8 offset:16384
    ds_read_b64_tr_b16 a[14:15], v8 offset:16896
    buffer_load_dwordx4 v3, s[32:35], s62 offen lds
    s_waitcnt vmcnt(19)
    ds_read_b128 v[96:99], v224 offset:0
    s_waitcnt lgkmcnt(9)
    v_mfma_f32_32x32x16_bf16 v[160:175], a[24:27], v[92:95], v[160:175]
    ds_read_b64_tr_b16 a[16:17], v9 offset:36864
    ds_read_b64_tr_b16 a[18:19], v9 offset:37376
    ds_read_b128 v[100:103], v225 offset:0
    v_accvgpr_mov_b32 a154, a68
    v_mfma_f32_32x32x16_bf16 v[176:191], a[28:31], v[92:95], v[176:191]
    ds_read_b64_tr_b16 a[20:21], v10 offset:36864
    ds_read_b64_tr_b16 a[22:23], v10 offset:37376
    buffer_load_dwordx4 v4, s[32:35], s62 offen offset:1024 lds
    s_add_u32 m0, s73, 28672
    v_accvgpr_mov_b32 a155, a68
    s_waitcnt lgkmcnt(10)
    v_mfma_f32_32x32x16_bf16 v[192:207], a[0:3], v[80:83], v[192:207]
    ds_read_b64_tr_b16 a[24:25], v9 offset:16384
    ds_read_b64_tr_b16 a[26:27], v9 offset:16896
    ds_read_b128 v[104:107], v226 offset:0
    v_accvgpr_mov_b32 a156, a68
    v_mfma_f32_32x32x16_bf16 v[208:223], a[4:7], v[80:83], v[208:223]
    ds_read_b64_tr_b16 a[28:29], v10 offset:16384
    ds_read_b64_tr_b16 a[30:31], v10 offset:16896
    buffer_load_dwordx4 v248, s[40:43], s70 offen lds
    ds_read_b128 v[108:111], v227 offset:0
    v_smfmac_f32_16x16x64_bf16 a[196:199], a[224:227], a[0:7], v30
    s_waitcnt lgkmcnt(12)
    v_mfma_f32_32x32x16_bf16 a[32:47], a[8:11], v[80:83], a[32:47]
    ds_read_b64_tr_b16 a[0:1], v11 offset:36864
    ds_read_b64_tr_b16 a[2:3], v11 offset:37376
    buffer_load_dwordx4 v249, s[40:43], s70 offen offset:1024 lds
    s_add_u32 m0, s73, 12288
    s_xor_b32 s76, s79, 896
    v_mfma_f32_32x32x16_bf16 a[48:63], a[12:15], v[80:83], a[48:63]
    ds_read_b64_tr_b16 a[4:5], v12 offset:36864
    ds_read_b64_tr_b16 a[6:7], v12 offset:37376
    v_accvgpr_mov_b32 a157, a68
    v_accvgpr_mov_b32 a158, a68
    v_accvgpr_mov_b32 a159, a68
    v_smfmac_f32_16x16x64_bf16 a[200:203], a[224:227], a[8:15], v30
    s_waitcnt lgkmcnt(10)
    v_mfma_f32_32x32x16_bf16 v[192:207], a[16:19], v[84:87], v[192:207]
    ds_read_b64_tr_b16 a[8:9], v11 offset:16384
    ds_read_b64_tr_b16 a[10:11], v11 offset:16896
    buffer_load_dwordx4 v228, s[28:31], s76 offen offset:0 lds
    v_accvgpr_mov_b32 a164, a68
    v_accvgpr_mov_b32 a165, a68
    v_mfma_f32_32x32x16_bf16 v[208:223], a[20:23], v[84:87], v[208:223]
    ds_read_b64_tr_b16 a[12:13], v12 offset:16384
    ds_read_b64_tr_b16 a[14:15], v12 offset:16896
    buffer_load_dwordx4 v229, s[28:31], s76 offen offset:1024 lds
    v_accvgpr_mov_b32 a166, a68
    v_accvgpr_mov_b32 a167, a68
    s_waitcnt lgkmcnt(9)
    v_mfma_f32_32x32x16_bf16 a[32:47], a[24:27], v[84:87], a[32:47]
    ds_read_b64_tr_b16 a[16:17], v13 offset:36864
    ds_read_b64_tr_b16 a[18:19], v13 offset:37376
    v_accvgpr_mov_b32 a168, a68
    v_accvgpr_mov_b32 a169, a68
    v_accvgpr_mov_b32 a170, a68
    v_mfma_f32_32x32x16_bf16 a[48:63], a[28:31], v[84:87], a[48:63]
    ds_read_b64_tr_b16 a[20:21], v14 offset:36864
    ds_read_b64_tr_b16 a[22:23], v14 offset:37376
    buffer_load_dwordx4 v230, s[28:31], s76 offen offset:2048 lds
    v_accvgpr_mov_b32 a171, a68
    v_accvgpr_mov_b32 a176, a68
    s_waitcnt lgkmcnt(8)
    v_mfma_f32_32x32x16_bf16 v[192:207], a[0:3], v[88:91], v[192:207]
    ds_read_b64_tr_b16 a[24:25], v13 offset:16384
    ds_read_b64_tr_b16 a[26:27], v13 offset:16896
    v_accvgpr_mov_b32 a177, a68
    v_accvgpr_mov_b32 a178, a68
    v_accvgpr_mov_b32 a179, a68
    v_dot2_f32_bf16 v16, v96, v96, v16
    v_dot2_f32_bf16 v17, v97, v97, v17
    v_dot2_f32_bf16 v18, v98, v98, v18
    v_dot2_f32_bf16 v19, v99, v99, v19
    v_dot2_f32_bf16 v16, v100, v100, v16
    v_dot2_f32_bf16 v17, v101, v101, v17
    v_dot2_f32_bf16 v18, v102, v102, v18
    v_dot2_f32_bf16 v19, v103, v103, v19
    v_dot2_f32_bf16 v16, v104, v104, v16
    v_dot2_f32_bf16 v17, v105, v105, v17
    v_dot2_f32_bf16 v18, v106, v106, v18
    v_dot2_f32_bf16 v19, v107, v107, v19
    v_dot2_f32_bf16 v16, v108, v108, v16
    v_dot2_f32_bf16 v17, v109, v109, v17
    v_dot2_f32_bf16 v18, v110, v110, v18
    v_dot2_f32_bf16 v19, v111, v111, v19
    v_smfmac_f32_16x16x64_bf16 a[212:215], a[224:227], v[96:103], v30
    v_smfmac_f32_16x16x64_bf16 a[212:215], a[224:227], v[104:111], v30
    v_mfma_f32_32x32x16_bf16 v[208:223], a[4:7], v[88:91], v[208:223]
    ds_read_b64_tr_b16 a[28:29], v14 offset:16384
    ds_read_b64_tr_b16 a[30:31], v14 offset:16896
    buffer_load_dwordx4 v231, s[28:31], s76 offen offset:3072 lds
    s_add_u32 m0, s73, 30720
    v_accvgpr_mov_b32 a180, a68
    s_waitcnt lgkmcnt(8)
    v_mfma_f32_32x32x16_bf16 a[32:47], a[8:11], v[88:91], a[32:47]
    s_waitcnt vmcnt(21)
    s_barrier
    ds_read_b64_tr_b16 a[0:1], v7 offset:18432
    ds_read_b64_tr_b16 a[2:3], v7 offset:18944
    buffer_load_dwordx4 v3, s[32:35], s63 offen lds
    v_mfma_f32_32x32x16_bf16 a[48:63], a[12:15], v[88:91], a[48:63]
    ds_read_b64_tr_b16 a[4:5], v8 offset:18432
    ds_read_b64_tr_b16 a[6:7], v8 offset:18944
    s_waitcnt vmcnt(18)
    ds_read_b128 v[112:115], v224 offset:4096
    s_waitcnt lgkmcnt(9)
    v_mfma_f32_32x32x16_bf16 v[192:207], a[16:19], v[92:95], v[192:207]
    ds_read_b64_tr_b16 a[8:9], v7 offset:20480
    ds_read_b64_tr_b16 a[10:11], v7 offset:20992
    buffer_load_dwordx4 v4, s[32:35], s63 offen offset:1024 lds
    s_add_u32 m0, s73, 0
    v_accvgpr_mov_b32 a181, a68
    v_mfma_f32_32x32x16_bf16 v[208:223], a[20:23], v[92:95], v[208:223]
    ds_read_b64_tr_b16 a[12:13], v8 offset:20480
    ds_read_b64_tr_b16 a[14:15], v8 offset:20992
    buffer_load_dwordx4 v248, s[40:43], s71 offen lds
    ds_read_b128 v[116:119], v225 offset:4096
    s_waitcnt lgkmcnt(10)
    v_mfma_f32_32x32x16_bf16 a[32:47], a[24:27], v[92:95], a[32:47]
    ds_read_b64_tr_b16 a[16:17], v9 offset:18432
    ds_read_b64_tr_b16 a[18:19], v9 offset:18944
    ds_read_b128 v[120:123], v226 offset:4096
    v_accvgpr_mov_b32 a182, a68
    v_mfma_f32_32x32x16_bf16 a[48:63], a[28:31], v[92:95], a[48:63]
    ds_read_b64_tr_b16 a[20:21], v10 offset:18432
    ds_read_b64_tr_b16 a[22:23], v10 offset:18944
    buffer_load_dwordx4 v249, s[40:43], s71 offen offset:1024 lds
    s_add_u32 m0, s73, 2048
    v_accvgpr_mov_b32 a183, a68
    s_waitcnt lgkmcnt(11)
    v_mfma_f32_32x32x16_bf16 v[160:175], a[0:3], v[96:99], v[160:175]
    ds_read_b64_tr_b16 a[24:25], v9 offset:20480
    ds_read_b64_tr_b16 a[26:27], v9 offset:20992
    ds_read_b128 v[124:127], v227 offset:4096
    v_mfma_f32_32x32x16_bf16 v[176:191], a[4:7], v[96:99], v[176:191]
    ds_read_b64_tr_b16 a[28:29], v10 offset:20480
    ds_read_b64_tr_b16 a[30:31], v10 offset:20992
    buffer_load_dwordx4 v248, s[44:47], s68 offen lds
    v_smfmac_f32_16x16x64_bf16 a[192:195], a[224:227], a[0:7], v30
    s_waitcnt lgkmcnt(11)
    v_mfma_f32_32x32x16_bf16 v[192:207], a[8:11], v[96:99], v[192:207]
    ds_read_b64_tr_b16 a[0:1], v11 offset:18432
    ds_read_b64_tr_b16 a[2:3], v11 offset:18944
    buffer_load_dwordx4 v249, s[44:47], s68 offen offset:1024 lds
    s_add_u32 m0, s73, 32768
    v_mfma_f32_32x32x16_bf16 v[208:223], a[12:15], v[96:99], v[208:223]
    ds_read_b64_tr_b16 a[4:5], v12 offset:18432
    ds_read_b64_tr_b16 a[6:7], v12 offset:18944
    v_smfmac_f32_16x16x64_bf16 a[196:199], a[224:227], a[8:15], v30
    s_waitcnt lgkmcnt(9)
    v_mfma_f32_32x32x16_bf16 v[160:175], a[16:19], v[100:103], v[160:175]
    ds_read_b64_tr_b16 a[8:9], v11 offset:20480
    ds_read_b64_tr_b16 a[10:11], v11 offset:20992
    buffer_load_dwordx4 v248, s[44:47], s69 offen lds
    v_mfma_f32_32x32x16_bf16 v[176:191], a[20:23], v[100:103], v[176:191]
    ds_read_b64_tr_b16 a[12:13], v12 offset:20480
    ds_read_b64_tr_b16 a[14:15], v12 offset:20992
    buffer_load_dwordx4 v249, s[44:47], s69 offen offset:1024 lds
    s_waitcnt lgkmcnt(8)
    v_mfma_f32_32x32x16_bf16 v[192:207], a[24:27], v[100:103], v[192:207]
    ds_read_b64_tr_b16 a[16:17], v13 offset:18432
    ds_read_b64_tr_b16 a[18:19], v13 offset:18944
    v_dot2_f32_bf16 v16, v112, v112, v16
    v_dot2_f32_bf16 v17, v113, v113, v17
    v_dot2_f32_bf16 v18, v114, v114, v18
    v_dot2_f32_bf16 v19, v115, v115, v19
    v_dot2_f32_bf16 v16, v116, v116, v16
    v_dot2_f32_bf16 v17, v117, v117, v17
    v_dot2_f32_bf16 v18, v118, v118, v18
    v_dot2_f32_bf16 v19, v119, v119, v19
    v_dot2_f32_bf16 v16, v120, v120, v16
    v_dot2_f32_bf16 v17, v121, v121, v17
    v_dot2_f32_bf16 v18, v122, v122, v18
    v_dot2_f32_bf16 v19, v123, v123, v19
    v_dot2_f32_bf16 v16, v124, v124, v16
    v_dot2_f32_bf16 v17, v125, v125, v17
    v_dot2_f32_bf16 v18, v126, v126, v18
    v_dot2_f32_bf16 v19, v127, v127, v19
    v_smfmac_f32_16x16x64_bf16 a[212:215], a[224:227], v[112:119], v30
    v_smfmac_f32_16x16x64_bf16 a[212:215], a[224:227], v[120:127], v30
    v_mfma_f32_32x32x16_bf16 v[208:223], a[28:31], v[100:103], v[208:223]
    ds_read_b64_tr_b16 a[20:21], v14 offset:18432
    ds_read_b64_tr_b16 a[22:23], v14 offset:18944
    s_waitcnt lgkmcnt(8)
    v_mfma_f32_32x32x16_bf16 v[160:175], a[0:3], v[104:107], v[160:175]
    ds_read_b64_tr_b16 a[24:25], v13 offset:20480
    ds_read_b64_tr_b16 a[26:27], v13 offset:20992
    v_mfma_f32_32x32x16_bf16 v[176:191], a[4:7], v[104:107], v[176:191]
    ds_read_b64_tr_b16 a[28:29], v14 offset:20480
    ds_read_b64_tr_b16 a[30:31], v14 offset:20992
    s_waitcnt vmcnt(17)
    ds_read_b128 v[128:131], v224 offset:8192
    s_waitcnt lgkmcnt(9)
    v_mfma_f32_32x32x16_bf16 v[192:207], a[8:11], v[104:107], v[192:207]
    s_barrier
    ds_read_b64_tr_b16 a[0:1], v7 offset:22528
    ds_read_b64_tr_b16 a[2:3], v7 offset:23040
    s_add_u32 m0, s73, 34816
    ds_read_b128 v[132:135], v225 offset:8192
    v_mfma_f32_32x32x16_bf16 v[208:223], a[12:15], v[104:107], v[208:223]
    ds_read_b64_tr_b16 a[4:5], v8 offset:22528
    ds_read_b64_tr_b16 a[6:7], v8 offset:23040
    buffer_load_dwordx4 v248, s[44:47], s70 offen lds
    ds_read_b128 v[136:139], v226 offset:8192
    s_waitcnt lgkmcnt(11)
    v_mfma_f32_32x32x16_bf16 v[160:175], a[16:19], v[108:111], v[160:175]
    ds_read_b64_tr_b16 a[8:9], v7 offset:24576
    ds_read_b64_tr_b16 a[10:11], v7 offset:25088
    buffer_load_dwordx4 v249, s[44:47], s70 offen offset:1024 lds
    s_add_u32 m0, s73, 4096
    v_mfma_f32_32x32x16_bf16 v[176:191], a[20:23], v[108:111], v[176:191]
    ds_read_b64_tr_b16 a[12:13], v8 offset:24576
    ds_read_b64_tr_b16 a[14:15], v8 offset:25088
    ds_read_b128 v[140:143], v227 offset:8192
    s_waitcnt lgkmcnt(12)
    v_mfma_f32_32x32x16_bf16 v[192:207], a[24:27], v[108:111], v[192:207]
    ds_read_b64_tr_b16 a[16:17], v9 offset:22528
    ds_read_b64_tr_b16 a[18:19], v9 offset:23040
    buffer_load_dwordx4 v248, s[44:47], s71 offen lds
    v_mfma_f32_32x32x16_bf16 v[208:223], a[28:31], v[108:111], v[208:223]
    ds_read_b64_tr_b16 a[20:21], v10 offset:22528
    ds_read_b64_tr_b16 a[22:23], v10 offset:23040
    buffer_load_dwordx4 v249, s[44:47], s71 offen offset:1024 lds
    s_waitcnt lgkmcnt(10)
    v_mfma_f32_32x32x16_bf16 v[160:175], a[0:3], v[112:115], v[160:175]
    ds_read_b64_tr_b16 a[24:25], v9 offset:24576
    ds_read_b64_tr_b16 a[26:27], v9 offset:25088
    v_mfma_f32_32x32x16_bf16 v[176:191], a[4:7], v[112:115], v[176:191]
    ds_read_b64_tr_b16 a[28:29], v10 offset:24576
    ds_read_b64_tr_b16 a[30:31], v10 offset:25088
    buffer_load_dwordx2 v[28:29], off, s[24:27], 0 sc1
    v_smfmac_f32_16x16x64_bf16 a[192:195], a[224:227], a[0:7], v30
    s_waitcnt lgkmcnt(9)
    v_mfma_f32_32x32x16_bf16 v[192:207], a[8:11], v[112:115], v[192:207]
    ds_read_b64_tr_b16 a[0:1], v11 offset:22528
    ds_read_b64_tr_b16 a[2:3], v11 offset:23040
    v_mfma_f32_32x32x16_bf16 v[208:223], a[12:15], v[112:115], v[208:223]
    ds_read_b64_tr_b16 a[4:5], v12 offset:22528
    ds_read_b64_tr_b16 a[6:7], v12 offset:23040
    v_smfmac_f32_16x16x64_bf16 a[196:199], a[224:227], a[8:15], v30
    s_waitcnt lgkmcnt(8)
    v_mfma_f32_32x32x16_bf16 v[160:175], a[16:19], v[116:119], v[160:175]
    ds_read_b64_tr_b16 a[8:9], v11 offset:24576
    ds_read_b64_tr_b16 a[10:11], v11 offset:25088
    v_dot2_f32_bf16 v16, v128, v128, v16
    v_dot2_f32_bf16 v17, v129, v129, v17
    v_dot2_f32_bf16 v18, v130, v130, v18
    v_dot2_f32_bf16 v19, v131, v131, v19
    v_dot2_f32_bf16 v16, v132, v132, v16
    v_dot2_f32_bf16 v17, v133, v133, v17
    v_dot2_f32_bf16 v18, v134, v134, v18
    v_dot2_f32_bf16 v19, v135, v135, v19
    v_dot2_f32_bf16 v16, v136, v136, v16
    v_dot2_f32_bf16 v17, v137, v137, v17
    v_dot2_f32_bf16 v18, v138, v138, v18
    v_dot2_f32_bf16 v19, v139, v139, v19
    v_dot2_f32_bf16 v16, v140, v140, v16
    v_dot2_f32_bf16 v17, v141, v141, v17
    v_dot2_f32_bf16 v18, v142, v142, v18
    v_dot2_f32_bf16 v19, v143, v143, v19
    v_smfmac_f32_16x16x64_bf16 a[212:215], a[224:227], v[128:135], v30
    v_smfmac_f32_16x16x64_bf16 a[212:215], a[224:227], v[136:143], v30
    v_mfma_f32_32x32x16_bf16 v[176:191], a[20:23], v[116:119], v[176:191]
    ds_read_b64_tr_b16 a[12:13], v12 offset:24576
    ds_read_b64_tr_b16 a[14:15], v12 offset:25088
    s_waitcnt lgkmcnt(8)
    v_mfma_f32_32x32x16_bf16 v[192:207], a[24:27], v[116:119], v[192:207]
    ds_read_b64_tr_b16 a[16:17], v13 offset:22528
    ds_read_b64_tr_b16 a[18:19], v13 offset:23040
    v_mfma_f32_32x32x16_bf16 v[208:223], a[28:31], v[116:119], v[208:223]
    ds_read_b64_tr_b16 a[20:21], v14 offset:22528
    ds_read_b64_tr_b16 a[22:23], v14 offset:23040
    s_waitcnt vmcnt(13)
    ds_read_b128 v[144:147], v224 offset:12288
    s_waitcnt lgkmcnt(9)
    v_mfma_f32_32x32x16_bf16 v[160:175], a[0:3], v[120:123], v[160:175]
    ds_read_b64_tr_b16 a[24:25], v13 offset:24576
    ds_read_b64_tr_b16 a[26:27], v13 offset:25088
    ds_read_b128 v[148:151], v225 offset:12288
    v_mfma_f32_32x32x16_bf16 v[176:191], a[4:7], v[120:123], v[176:191]
    ds_read_b64_tr_b16 a[28:29], v14 offset:24576
    ds_read_b64_tr_b16 a[30:31], v14 offset:25088
    ds_read_b128 v[152:155], v226 offset:12288
    s_waitcnt lgkmcnt(11)
    v_mfma_f32_32x32x16_bf16 v[192:207], a[8:11], v[120:123], v[192:207]
    s_barrier
    ds_read_b64_tr_b16 a[0:1], v7 offset:26624
    ds_read_b64_tr_b16 a[2:3], v7 offset:27136
    s_add_u32 m0, s73, 6144
    ds_read_b128 v[156:159], v227 offset:12288
    v_mfma_f32_32x32x16_bf16 v[208:223], a[12:15], v[120:123], v[208:223]
    ds_read_b64_tr_b16 a[4:5], v8 offset:26624
    ds_read_b64_tr_b16 a[6:7], v8 offset:27136
    buffer_load_dwordx4 v5, s[40:43], s64 offen lds
    s_waitcnt lgkmcnt(12)
    v_mfma_f32_32x32x16_bf16 v[160:175], a[16:19], v[124:127], v[160:175]
    ds_read_b64_tr_b16 a[8:9], v7 offset:28672
    ds_read_b64_tr_b16 a[10:11], v7 offset:29184
    buffer_load_dwordx4 v6, s[40:43], s64 offen offset:1024 lds
    s_add_u32 m0, s73, 36864
    v_mfma_f32_32x32x16_bf16 v[176:191], a[20:23], v[124:127], v[176:191]
    ds_read_b64_tr_b16 a[12:13], v8 offset:28672
    ds_read_b64_tr_b16 a[14:15], v8 offset:29184
    s_waitcnt lgkmcnt(10)
    v_mfma_f32_32x32x16_bf16 v[192:207], a[24:27], v[124:127], v[192:207]
    ds_read_b64_tr_b16 a[16:17], v9 offset:26624
    ds_read_b64_tr_b16 a[18:19], v9 offset:27136
    buffer_load_dwordx4 v5, s[40:43], s65 offen lds
    v_mfma_f32_32x32x16_bf16 v[208:223], a[28:31], v[124:127], v[208:223]
    ds_read_b64_tr_b16 a[20:21], v10 offset:26624
    ds_read_b64_tr_b16 a[22:23], v10 offset:27136
    buffer_load_dwordx4 v6, s[40:43], s65 offen offset:1024 lds
    s_waitcnt lgkmcnt(8)
    v_mfma_f32_32x32x16_bf16 v[160:175], a[0:3], v[128:131], v[160:175]
    ds_read_b64_tr_b16 a[24:25], v9 offset:28672
    ds_read_b64_tr_b16 a[26:27], v9 offset:29184
    v_mfma_f32_32x32x16_bf16 v[176:191], a[4:7], v[128:131], v[176:191]
    ds_read_b64_tr_b16 a[28:29], v10 offset:28672
    ds_read_b64_tr_b16 a[30:31], v10 offset:29184
    v_smfmac_f32_16x16x64_bf16 a[192:195], a[224:227], a[0:7], v30
    s_waitcnt lgkmcnt(8)
    v_mfma_f32_32x32x16_bf16 v[192:207], a[8:11], v[128:131], v[192:207]
    ds_read_b64_tr_b16 a[0:1], v11 offset:26624
    ds_read_b64_tr_b16 a[2:3], v11 offset:27136
    v_dot2_f32_bf16 v16, v144, v144, v16
    v_dot2_f32_bf16 v17, v145, v145, v17
    v_dot2_f32_bf16 v18, v146, v146, v18
    v_dot2_f32_bf16 v19, v147, v147, v19
    v_dot2_f32_bf16 v16, v148, v148, v16
    v_dot2_f32_bf16 v17, v149, v149, v17
    v_dot2_f32_bf16 v18, v150, v150, v18
    v_dot2_f32_bf16 v19, v151, v151, v19
    v_dot2_f32_bf16 v16, v152, v152, v16
    v_dot2_f32_bf16 v17, v153, v153, v17
    v_dot2_f32_bf16 v18, v154, v154, v18
    v_dot2_f32_bf16 v19, v155, v155, v19
    v_dot2_f32_bf16 v16, v156, v156, v16
    v_dot2_f32_bf16 v17, v157, v157, v17
    v_dot2_f32_bf16 v18, v158, v158, v18
    v_dot2_f32_bf16 v19, v159, v159, v19
    v_smfmac_f32_16x16x64_bf16 a[212:215], a[224:227], v[144:151], v30
    v_smfmac_f32_16x16x64_bf16 a[212:215], a[224:227], v[152:159], v30
    v_mfma_f32_32x32x16_bf16 v[208:223], a[12:15], v[128:131], v[208:223]
    ds_read_b64_tr_b16 a[4:5], v12 offset:26624
    ds_read_b64_tr_b16 a[6:7], v12 offset:27136
    v_smfmac_f32_16x16x64_bf16 a[196:199], a[224:227], a[8:15], v30
    s_waitcnt lgkmcnt(8)
    v_mfma_f32_32x32x16_bf16 v[160:175], a[16:19], v[132:135], v[160:175]
    ds_read_b64_tr_b16 a[8:9], v11 offset:28672
    ds_read_b64_tr_b16 a[10:11], v11 offset:29184
    v_accvgpr_read_b32 v20, a212
    v_accvgpr_read_b32 v21, a213
    v_add_f32 v16, v16, v17
    v_mfma_f32_32x32x16_bf16 v[176:191], a[20:23], v[132:135], v[176:191]
    ds_read_b64_tr_b16 a[12:13], v12 offset:28672
    ds_read_b64_tr_b16 a[14:15], v12 offset:29184
    v_add_f32 v18, v18, v19
    v_add_f32 v20, v20, v21
    v_add_f32 v16, v16, v18
    s_waitcnt lgkmcnt(8)
    v_mfma_f32_32x32x16_bf16 v[192:207], a[24:27], v[132:135], v[192:207]
    ds_read_b64_tr_b16 a[16:17], v13 offset:26624
    ds_read_b64_tr_b16 a[18:19], v13 offset:27136
    v_mov_b32 v21, v20
    v_mov_b32 v17, v16
    v_cmp_gt_u32 vcc, 32, v0
    v_mfma_f32_32x32x16_bf16 v[208:223], a[28:31], v[132:135], v[208:223]
    ds_read_b64_tr_b16 a[20:21], v14 offset:26624
    ds_read_b64_tr_b16 a[22:23], v14 offset:27136
    v_lshlrev_b32 v19, 2, v0
    v_permlane32_swap_b32 v20, v21
    v_permlane32_swap_b32 v16, v17
    s_waitcnt lgkmcnt(8)
    v_mfma_f32_32x32x16_bf16 v[160:175], a[0:3], v[136:139], v[160:175]
    ds_read_b64_tr_b16 a[24:25], v13 offset:28672
    ds_read_b64_tr_b16 a[26:27], v13 offset:29184
    v_add_f32 v20, v20, v21
    v_add_f32 v16, v16, v17
    v_mul_f32 v20, 0x3b000000, v20
    v_mfma_f32_32x32x16_bf16 v[176:191], a[4:7], v[136:139], v[176:191]
    ds_read_b64_tr_b16 a[28:29], v14 offset:28672
    ds_read_b64_tr_b16 a[30:31], v14 offset:29184
    v_mul_f32 v16, 0x3b000000, v16
    v_cvt_pk_bf16_f32 v21, -v20, -v20
    v_fma_f32 v16, -v20, v20, v16
    s_waitcnt lgkmcnt(8)
    v_mfma_f32_32x32x16_bf16 v[192:207], a[8:11], v[136:139], v[192:207]
    s_waitcnt vmcnt(13)
    s_barrier
    ds_read_b64_tr_b16 a[0:1], v7 offset:30720
    ds_read_b64_tr_b16 a[2:3], v7 offset:31232
    s_add_u32 m0, s73, 16384
    v_mfma_f32_32x32x16_bf16 v[208:223], a[12:15], v[136:139], v[208:223]
    ds_read_b64_tr_b16 a[4:5], v8 offset:30720
    ds_read_b64_tr_b16 a[6:7], v8 offset:31232
    buffer_load_dwordx4 v5, s[40:43], s66 offen lds
    v_cndmask_b32 v20, 0, v21, vcc
    v_max_f32 v16, 0, v16
    s_waitcnt lgkmcnt(8)
    v_mfma_f32_32x32x16_bf16 v[160:175], a[16:19], v[140:143], v[160:175]
    ds_read_b64_tr_b16 a[8:9], v7 offset:0
    ds_read_b64_tr_b16 a[10:11], v7 offset:512
    buffer_load_dwordx4 v6, s[40:43], s66 offen offset:1024 lds
    s_add_u32 m0, s73, 8192
    v_xor_b32 v21, v21, v20
    v_mfma_f32_32x32x16_bf16 v[176:191], a[20:23], v[140:143], v[176:191]
    ds_read_b64_tr_b16 a[12:13], v8 offset:0
    ds_read_b64_tr_b16 a[14:15], v8 offset:512
    v_cvt_pk_bf16_f32 v17, v16, v16
    v_lshlrev_b32 v16, 16, v17
    v_accvgpr_write_b32 a240, v20
    s_waitcnt lgkmcnt(8)
    v_mfma_f32_32x32x16_bf16 v[192:207], a[24:27], v[140:143], v[192:207]
    ds_read_b64_tr_b16 a[16:17], v9 offset:30720
    ds_read_b64_tr_b16 a[18:19], v9 offset:31232
    buffer_load_dwordx4 v5, s[40:43], s67 offen lds
    v_add_f32 v16, 0x3727c5ac, v16
    v_accvgpr_write_b32 a241, v20
    v_mfma_f32_32x32x16_bf16 v[208:223], a[28:31], v[140:143], v[208:223]
    ds_read_b64_tr_b16 a[20:21], v10 offset:30720
    ds_read_b64_tr_b16 a[22:23], v10 offset:31232
    buffer_load_dwordx4 v6, s[40:43], s67 offen offset:1024 lds
    v_cvt_pk_bf16_f32 v17, v16, v16
    v_accvgpr_write_b32 a242, v20
    s_waitcnt lgkmcnt(8)
    v_mfma_f32_32x32x16_bf16 v[160:175], a[0:3], v[144:147], v[160:175]
    ds_read_b64_tr_b16 a[24:25], v11 offset:30720
    ds_read_b64_tr_b16 a[26:27], v11 offset:31232
    v_lshlrev_b32 v16, 16, v17
    v_accvgpr_write_b32 a243, v20
    v_sqrt_f32 v16, v16
    v_mfma_f32_32x32x16_bf16 v[176:191], a[4:7], v[144:147], v[176:191]
    ds_read_b64_tr_b16 a[28:29], v12 offset:30720
    ds_read_b64_tr_b16 a[30:31], v12 offset:31232
    v_accvgpr_write_b32 a244, v21
    v_cvt_pk_bf16_f32 v17, v16, v16
    v_accvgpr_write_b32 a245, v21
    v_smfmac_f32_16x16x64_bf16 a[192:195], a[224:227], a[0:7], v30
    s_waitcnt lgkmcnt(8)
    v_mfma_f32_32x32x16_bf16 v[192:207], a[8:11], v[144:147], v[192:207]
    ds_read_b64_tr_b16 a[0:1], v13 offset:30720
    ds_read_b64_tr_b16 a[2:3], v13 offset:31232
    v_lshlrev_b32 v16, 16, v17
    v_accvgpr_write_b32 a246, v21
    v_rcp_f32 v31, v16
    v_mfma_f32_32x32x16_bf16 v[208:223], a[12:15], v[144:147], v[208:223]
    ds_read_b64_tr_b16 a[4:5], v14 offset:30720
    ds_read_b64_tr_b16 a[6:7], v14 offset:31232
    v_accvgpr_write_b32 a247, v21
    v_mul_f32 v18, 0x3eb8aa3b, v31
    v_mul_f32 v19, 0x3eb8aa3b, v31
    v_smfmac_f32_16x16x64_bf16 a[196:199], a[224:227], a[8:15], v30
    s_waitcnt lgkmcnt(8)
    v_mfma_f32_32x32x16_bf16 v[160:175], a[16:19], v[148:151], v[160:175]
    ds_read_b64_tr_b16 a[8:9], v9 offset:0
    ds_read_b64_tr_b16 a[10:11], v9 offset:512
    s_lshl_b32 s101, s72, 2
    v_add_u32 v244, s101, v1
    v_accvgpr_read_b32 v240, a192
    s_nop 0
    v_accvgpr_read_b32 v242, a196
    v_accvgpr_read_b32 v241, a193
    v_accvgpr_read_b32 v243, a197
    v_mfma_f32_32x32x16_bf16 v[176:191], a[20:23], v[148:151], v[176:191]
    ds_read_b64_tr_b16 a[12:13], v10 offset:0
    ds_read_b64_tr_b16 a[14:15], v10 offset:512
    v_add_f32 v240, v240, v241
    v_add_f32 v242, v242, v243
    v_cvt_pk_bf16_f32 v241, v240, v240
    v_cvt_pk_bf16_f32 v243, v242, v242
    v_lshlrev_b32 v241, 16, v241
    v_lshlrev_b32 v243, 16, v243
    s_waitcnt lgkmcnt(8)
    v_mfma_f32_32x32x16_bf16 v[160:175], a[24:27], v[152:155], v[160:175]
    ds_read_b64_tr_b16 a[16:17], v11 offset:0
    ds_read_b64_tr_b16 a[18:19], v11 offset:512
    v_sub_f32 v241, v240, v241
    v_sub_f32 v243, v242, v243
    v_cvt_pk_bf16_f32 v240, v240, v241
    v_cvt_pk_bf16_f32 v242, v242, v243
    ds_write_b32 v244, v240 offset:38912
    ds_write_b32 v244, v242 offset:39936
    v_mfma_f32_32x32x16_bf16 v[176:191], a[28:31], v[152:155], v[176:191]
    ds_read_b64_tr_b16 a[20:21], v12 offset:0
    ds_read_b64_tr_b16 a[22:23], v12 offset:512
    s_waitcnt lgkmcnt(10)
    v_mfma_f32_32x32x16_bf16 v[160:175], a[0:3], v[156:159], v[160:175]
    ds_read_b64_tr_b16 a[24:25], v13 offset:0
    ds_read_b64_tr_b16 a[26:27], v13 offset:512
    v_mfma_f32_32x32x16_bf16 v[176:191], a[4:7], v[156:159], v[176:191]
    ds_read_b64_tr_b16 a[28:29], v14 offset:0
    ds_read_b64_tr_b16 a[30:31], v14 offset:512
    s_waitcnt lgkmcnt(10)
    v_mfma_f32_32x32x16_bf16 v[192:207], a[8:11], v[148:151], v[192:207]
    s_waitcnt vmcnt(13) lgkmcnt(6)
    s_barrier
    ds_read_b128 a[232:235], v1 offset:38912
    ds_read_b128 a[236:239], v1 offset:39936
    ds_read_b64_tr_b16 a[0:1], v7 offset:2048
    ds_read_b64_tr_b16 a[2:3], v7 offset:2560
    s_add_u32 m0, s73, 10240
    v_mfma_f32_32x32x16_bf16 v[208:223], a[12:15], v[148:151], v[208:223]
    ds_read_b64_tr_b16 a[4:5], v8 offset:2048
    ds_read_b64_tr_b16 a[6:7], v8 offset:2560
    buffer_load_dwordx4 v5, s[40:43], s68 offen lds
    s_waitcnt lgkmcnt(10)
    v_mfma_f32_32x32x16_bf16 v[192:207], a[16:19], v[152:155], v[192:207]
    ds_read_b64_tr_b16 a[8:9], v9 offset:2048
    ds_read_b64_tr_b16 a[10:11], v9 offset:2560
    s_waitcnt vmcnt(9)
    v_cmp_eq_u64 vcc, 0, v[28:29]
    s_cbranch_vccz eok_2
    s_movk_i32 s101, 30000
elp_3:
    buffer_load_dwordx2 v[28:29], off, s[24:27], 0 sc1
    s_waitcnt vmcnt(0)
    v_cmp_eq_u64 vcc, 0, v[28:29]
    s_cbranch_vccz eok_2
    s_sub_u32 s101, s101, 1
    s_cbranch_scc0 elp_3
eok_2:
    v_mfma_f32_32x32x16_bf16 v[208:223], a[20:23], v[152:155], v[208:223]
    ds_read_b64_tr_b16 a[12:13], v10 offset:2048
    ds_read_b64_tr_b16 a[14:15], v10 offset:2560
    buffer_load_dwordx4 v6, s[40:43], s68 offen offset:1024 lds
    s_add_u32 m0, s73, 18432
    s_waitcnt lgkmcnt(10)
    v_mfma_f32_32x32x16_bf16 v[192:207], a[24:27], v[156:159], v[192:207]
    ds_read_b64_tr_b16 a[16:17], v11 offset:2048
    ds_read_b64_tr_b16 a[18:19], v11 offset:2560
    buffer_load_dwordx4 v5, s[40:43], s69 offen lds
    v_mfma_f32_32x32x16_bf16 v[208:223], a[28:31], v[156:159], v[208:223]
    ds_read_b64_tr_b16 a[20:21], v12 offset:2048
    ds_read_b64_tr_b16 a[22:23], v12 offset:2560
    s_waitcnt lgkmcnt(12)
    v_mfma_f32_32x32x16_bf16 v[160:175], a[232:235], a[240:243], v[160:175]
    v_mfma_f32_32x32x16_bf16 v[176:191], a[232:235], a[244:247], v[176:191]
    v_mfma_f32_32x32x16_bf16 v[192:207], a[236:239], a[240:243], v[192:207]
    v_mfma_f32_32x32x16_bf16 v[208:223], a[236:239], a[244:247], v[208:223]
    s_waitcnt lgkmcnt(8)
    v_mfma_f32_32x32x16_bf16 a[32:47], a[0:3], v[96:99], a[32:47]
    ds_read_b64_tr_b16 a[24:25], v13 offset:2048
    ds_read_b64_tr_b16 a[26:27], v13 offset:2560
    buffer_load_dwordx4 v6, s[40:43], s69 offen offset:1024 lds
    v_mfma_f32_32x32x16_bf16 a[48:63], a[4:7], v[96:99], a[48:63]
    ds_read_b64_tr_b16 a[28:29], v14 offset:2048
    ds_read_b64_tr_b16 a[30:31], v14 offset:2560
    v_smfmac_f32_16x16x64_bf16 a[200:203], a[224:227], a[0:7], v30
    s_waitcnt lgkmcnt(8)
    v_mfma_f32_32x32x16_bf16 a[32:47], a[8:11], v[100:103], a[32:47]
    ds_read_b64_tr_b16 a[0:1], v7 offset:32768
    ds_read_b64_tr_b16 a[2:3], v7 offset:33280
    v_mfma_f32_32x32x16_bf16 a[48:63], a[12:15], v[100:103], a[48:63]
    ds_read_b64_tr_b16 a[4:5], v8 offset:32768
    ds_read_b64_tr_b16 a[6:7], v8 offset:33280
    v_mul_f32 v160, v160, v18
    v_mul_f32 v161, v161, v18
    v_mul_f32 v162, v162, v18
    v_mul_f32 v163, v163, v18
    v_mul_f32 v164, v164, v18
    v_mul_f32 v165, v165, v18
    v_mul_f32 v166, v166, v18
    v_mul_f32 v167, v167, v18
    s_waitcnt lgkmcnt(8)
    v_mfma_f32_32x32x16_bf16 a[32:47], a[16:19], v[104:107], a[32:47]
    ds_read_b64_tr_b16 a[8:9], v9 offset:32768
    ds_read_b64_tr_b16 a[10:11], v9 offset:33280
    v_mul_f32 v168, v168, v18
    v_mul_f32 v169, v169, v18
    v_mul_f32 v170, v170, v18
    v_mul_f32 v171, v171, v18
    v_mul_f32 v172, v172, v18
    v_mul_f32 v173, v173, v18
    v_mul_f32 v174, v174, v18
    v_mul_f32 v175, v175, v18
    v_mfma_f32_32x32x16_bf16 a[48:63], a[20:23], v[104:107], a[48:63]
    ds_read_b64_tr_b16 a[12:13], v10 offset:32768
    ds_read_b64_tr_b16 a[14:15], v10 offset:33280
    v_cvt_pk_bf16_f32 v160, v160, v161
    v_cvt_pk_bf16_f32 v161, v162, v163
    v_cvt_pk_bf16_f32 v162, v164, v165
    v_cvt_pk_bf16_f32 v163, v166, v167
    v_cvt_pk_bf16_f32 v164, v168, v169
    v_cvt_pk_bf16_f32 v165, v170, v171
    v_cvt_pk_bf16_f32 v166, v172, v173
    v_cvt_pk_bf16_f32 v167, v174, v175
    s_waitcnt lgkmcnt(8)
    v_mfma_f32_32x32x16_bf16 a[32:47], a[24:27], v[108:111], a[32:47]
    ds_read_b64_tr_b16 a[16:17], v11 offset:32768
    ds_read_b64_tr_b16 a[18:19], v11 offset:33280
    buffer_store_dwordx4 v[160:163], v1, s[52:55], s80 offen offset:0 sc1
    v_mul_f32 v176, v176, v18
    v_mul_f32 v177, v177, v18
    v_mul_f32 v178, v178, v18
    v_mul_f32 v179, v179, v18
    v_mul_f32 v180, v180, v18
    v_mul_f32 v181, v181, v18
    v_mul_f32 v182, v182, v18
    v_mfma_f32_32x32x16_bf16 a[48:63], a[28:31], v[108:111], a[48:63]
    ds_read_b64_tr_b16 a[20:21], v12 offset:32768
    ds_read_b64_tr_b16 a[22:23], v12 offset:33280
    buffer_store_dwordx4 v[164:167], v1, s[52:55], s80 offen offset:1024 sc1
    v_mul_f32 v183, v183, v18
    v_mul_f32 v184, v184, v18
    v_mul_f32 v185, v185, v18
    v_mul_f32 v186, v186, v18
    v_mul_f32 v187, v187, v18
    v_mul_f32 v188, v188, v18
    v_mul_f32 v189, v189, v18
    s_waitcnt lgkmcnt(8)
    v_mfma_f32_32x32x16_bf16 a[32:47], a[0:3], v[112:115], a[32:47]
    ds_read_b64_tr_b16 a[24:25], v13 offset:32768
    ds_read_b64_tr_b16 a[26:27], v13 offset:33280
    v_mul_f32 v190, v190, v18
    v_mul_f32 v191, v191, v18
    v_cvt_pk_bf16_f32 v176, v176, v177
    v_cvt_pk_bf16_f32 v177, v178, v179
    v_cvt_pk_bf16_f32 v178, v180, v181
    v_cvt_pk_bf16_f32 v179, v182, v183
    v_cvt_pk_bf16_f32 v180, v184, v185
    v_cvt_pk_bf16_f32 v181, v186, v187
    v_mfma_f32_32x32x16_bf16 a[48:63], a[4:7], v[112:115], a[48:63]
    ds_read_b64_tr_b16 a[28:29], v14 offset:32768
    ds_read_b64_tr_b16 a[30:31], v14 offset:33280
    buffer_store_dwordx4 v[176:179], v1, s[52:55], s80 offen offset:2048 sc1
    v_cvt_pk_bf16_f32 v182, v188, v189
    v_cvt_pk_bf16_f32 v183, v190, v191
    v_mul_f32 v18, v31, v31
    v_smfmac_f32_16x16x64_bf16 a[200:203], a[224:227], a[0:7], v30
    s_waitcnt lgkmcnt(8)
    v_mfma_f32_32x32x16_bf16 a[32:47], a[8:11], v[116:119], a[32:47]
    s_barrier
    ds_read_b64_tr_b16 a[0:1], v7 offset:34816
    ds_read_b64_tr_b16 a[2:3], v7 offset:35328
    buffer_store_dwordx4 v[180:183], v1, s[52:55], s80 offen offset:3072 sc1
    s_add_u32 m0, s73, 20480
    v_mul_f32 v19, v31, v31
    v_mfma_f32_32x32x16_bf16 a[48:63], a[12:15], v[116:119], a[48:63]
    ds_read_b64_tr_b16 a[4:5], v8 offset:34816
    ds_read_b64_tr_b16 a[6:7], v8 offset:35328
    s_lshl2_add_u32 s74, s3, s72
    s_lshl_b32 s74, s74, 10
    s_mul_i32 s38, s100, 327680
    s_add_u32 s38, s38, s74
    s_waitcnt lgkmcnt(8)
    v_mfma_f32_32x32x16_bf16 a[32:47], a[16:19], v[120:123], a[32:47]
    ds_read_b64_tr_b16 a[8:9], v7 offset:4096
    ds_read_b64_tr_b16 a[10:11], v7 offset:4608
    buffer_load_dwordx4 v5, s[40:43], s70 offen lds
    s_add_u32 s38, s38, 0x820000
    s_add_u32 s39, s38, 163840
    v_mov_b32 v188, -1
    v_mfma_f32_32x32x16_bf16 a[48:63], a[20:23], v[120:123], a[48:63]
    ds_read_b64_tr_b16 a[12:13], v8 offset:4096
    ds_read_b64_tr_b16 a[14:15], v8 offset:4608
    v_mov_b32 v189, -1
    v_mov_b32 v190, -1
    v_mov_b32 v191, -1
    v_mul_f32 v192, v192, v18
    s_waitcnt lgkmcnt(8)
    v_mfma_f32_32x32x16_bf16 a[32:47], a[24:27], v[124:127], a[32:47]
    ds_read_b64_tr_b16 a[16:17], v9 offset:34816
    ds_read_b64_tr_b16 a[18:19], v9 offset:35328
    buffer_store_dwordx4 v[188:191], v1, s[52:55], s38 offen offset:0 sc1
    v_mul_f32 v193, v193, v18
    v_mul_f32 v194, v194, v18
    v_mul_f32 v195, v195, v18
    v_mfma_f32_32x32x16_bf16 a[48:63], a[28:31], v[124:127], a[48:63]
    ds_read_b64_tr_b16 a[20:21], v10 offset:34816
    ds_read_b64_tr_b16 a[22:23], v10 offset:35328
    buffer_store_dwordx4 v[188:191], v1, s[52:55], s39 offen offset:0 sc1
    v_mul_f32 v196, v196, v18
    v_mul_f32 v197, v197, v18
    v_mul_f32 v198, v198, v18
    s_waitcnt lgkmcnt(8)
    v_mfma_f32_32x32x16_bf16 a[32:47], a[0:3], v[128:131], a[32:47]
    ds_read_b64_tr_b16 a[24:25], v11 offset:34816
    ds_read_b64_tr_b16 a[26:27], v11 offset:35328
    v_mul_f32 v199, v199, v18
    v_mul_f32 v200, v200, v18
    v_mul_f32 v201, v201, v18
    v_mul_f32 v202, v202, v18
    v_mfma_f32_32x32x16_bf16 a[48:63], a[4:7], v[128:131], a[48:63]
    ds_read_b64_tr_b16 a[28:29], v12 offset:34816
    ds_read_b64_tr_b16 a[30:31], v12 offset:35328
    buffer_load_dwordx4 v6, s[40:43], s70 offen offset:1024 lds
    s_add_u32 m0, s73, 12288
    v_mul_f32 v203, v203, v18
    v_mul_f32 v204, v204, v18
    v_smfmac_f32_16x16x64_bf16 a[200:203], a[224:227], a[0:7], v30
    s_waitcnt lgkmcnt(8)
    v_mfma_f32_32x32x16_bf16 a[32:47], a[8:11], v[144:147], a[32:47]
    ds_read_b64_tr_b16 a[0:1], v13 offset:34816
    ds_read_b64_tr_b16 a[2:3], v13 offset:35328
    buffer_load_dwordx4 v5, s[40:43], s71 offen lds
    v_mul_f32 v205, v205, v18
    v_mul_f32 v206, v206, v18
    v_mul_f32 v207, v207, v18
    v_mfma_f32_32x32x16_bf16 a[48:63], a[12:15], v[144:147], a[48:63]
    ds_read_b64_tr_b16 a[4:5], v14 offset:34816
    ds_read_b64_tr_b16 a[6:7], v14 offset:35328
    v_mul_f32 v208, v208, v18
    v_mul_f32 v209, v209, v18
    v_mul_f32 v210, v210, v18
    v_mul_f32 v211, v211, v18
    v_smfmac_f32_16x16x64_bf16 a[200:203], a[224:227], a[8:15], v30
    s_waitcnt lgkmcnt(8)
    v_mfma_f32_32x32x16_bf16 a[32:47], a[16:19], v[132:135], a[32:47]
    ds_read_b64_tr_b16 a[8:9], v9 offset:4096
    ds_read_b64_tr_b16 a[10:11], v9 offset:4608
    buffer_load_dwordx4 v6, s[40:43], s71 offen offset:1024 lds
    v_mul_f32 v212, v212, v18
    v_mul_f32 v213, v213, v18
    v_mul_f32 v214, v214, v18
    v_mfma_f32_32x32x16_bf16 a[48:63], a[20:23], v[132:135], a[48:63]
    ds_read_b64_tr_b16 a[12:13], v10 offset:4096
    ds_read_b64_tr_b16 a[14:15], v10 offset:4608
    s_lshl_b32 s101, s72, 2
    v_add_u32 v244, s101, v1
    v_accvgpr_read_b32 v240, a200
    v_accvgpr_read_b32 v241, a201
    v_add_f32 v240, v240, v241
    v_cvt_pk_bf16_f32 v241, v240, v240
    v_lshlrev_b32 v241, 16, v241
    s_waitcnt lgkmcnt(8)
    v_mfma_f32_32x32x16_bf16 a[32:47], a[24:27], v[136:139], a[32:47]
    ds_read_b64_tr_b16 a[16:17], v11 offset:4096
    ds_read_b64_tr_b16 a[18:19], v11 offset:4608
    v_sub_f32 v241, v240, v241
    v_cvt_pk_bf16_f32 v240, v240, v241
    ds_write_b32 v244, v240 offset:38912
    v_mul_f32 v215, v215, v18
    v_mul_f32 v216, v216, v18
    v_mul_f32 v217, v217, v18
    v_mul_f32 v218, v218, v18
    v_mfma_f32_32x32x16_bf16 a[48:63], a[28:31], v[136:139], a[48:63]
    ds_read_b64_tr_b16 a[20:21], v12 offset:4096
    ds_read_b64_tr_b16 a[22:23], v12 offset:4608
    v_mul_f32 v219, v219, v18
    v_mul_f32 v220, v220, v18
    v_mul_f32 v221, v221, v18
    v_mul_f32 v222, v222, v18
    s_waitcnt lgkmcnt(9)
    v_mfma_f32_32x32x16_bf16 a[32:47], a[0:3], v[140:143], a[32:47]
    ds_read_b64_tr_b16 a[24:25], v13 offset:4096
    ds_read_b64_tr_b16 a[26:27], v13 offset:4608
    v_mul_f32 v223, v223, v18
    s_mul_i32 s75, s100, 196608
    s_add_i32 s28, s75, -786432
    s_max_i32 s28, s28, 0
    v_mfma_f32_32x32x16_bf16 a[48:63], a[4:7], v[140:143], a[48:63]
    ds_read_b64_tr_b16 a[28:29], v14 offset:4096
    ds_read_b64_tr_b16 a[30:31], v14 offset:4608
    s_add_u32 s28, s28, s74
    s_add_i32 s29, s75, -688128
    s_max_i32 s29, s29, 0
    s_add_u32 s29, s29, s74
    s_waitcnt lgkmcnt(9)
    v_mfma_f32_32x32x16_bf16 a[32:47], a[8:11], v[148:151], a[32:47]
    s_waitcnt vmcnt(18) lgkmcnt(6)
    s_barrier
    ds_read_b128 a[232:235], v1 offset:38912
    ds_read_b64_tr_b16 a[0:1], v7 offset:6144
    ds_read_b64_tr_b16 a[2:3], v7 offset:6656
    s_add_u32 m0, s73, 14336
    v_mfma_f32_32x32x16_bf16 a[48:63], a[12:15], v[148:151], a[48:63]
    ds_read_b64_tr_b16 a[4:5], v8 offset:6144
    ds_read_b64_tr_b16 a[6:7], v8 offset:6656
    buffer_load_dwordx4 v5, s[44:47], s64 offen lds
    s_add_i32 s30, s75, -589824
    s_max_i32 s30, s30, 0
    s_add_u32 s30, s30, s74
    s_waitcnt lgkmcnt(9)
    v_mfma_f32_32x32x16_bf16 a[32:47], a[16:19], v[152:155], a[32:47]
    ds_read_b64_tr_b16 a[8:9], v9 offset:6144
    ds_read_b64_tr_b16 a[10:11], v9 offset:6656
    buffer_load_dwordx4 v6, s[44:47], s64 offen offset:1024 lds
    s_add_u32 m0, s73, 22528
    s_add_i32 s31, s75, -491520
    s_max_i32 s31, s31, 0
    v_mfma_f32_32x32x16_bf16 a[48:63], a[20:23], v[152:155], a[48:63]
    ds_read_b64_tr_b16 a[12:13], v10 offset:6144
    ds_read_b64_tr_b16 a[14:15], v10 offset:6656
    s_add_u32 s31, s31, s74
    s_add_i32 s32, s75, -393216
    s_max_i32 s32, s32, 0
    s_add_u32 s32, s32, s74
    s_waitcnt lgkmcnt(9)
    v_mfma_f32_32x32x16_bf16 a[32:47], a[24:27], v[156:159], a[32:47]
    ds_read_b64_tr_b16 a[16:17], v11 offset:6144
    ds_read_b64_tr_b16 a[18:19], v11 offset:6656
    buffer_load_dwordx4 v5, s[44:47], s65 offen lds
    s_add_i32 s33, s75, -294912
    s_max_i32 s33, s33, 0
    s_add_u32 s33, s33, s74
    v_mfma_f32_32x32x16_bf16 a[48:63], a[28:31], v[156:159], a[48:63]
    ds_read_b64_tr_b16 a[20:21], v12 offset:6144
    ds_read_b64_tr_b16 a[22:23], v12 offset:6656
    buffer_load_dwordx4 v6, s[44:47], s65 offen offset:1024 lds
    s_add_i32 s34, s75, -196608
    s_max_i32 s34, s34, 0
    s_add_u32 s34, s34, s74
    s_waitcnt lgkmcnt(12)
    v_mfma_f32_32x32x16_bf16 a[32:47], a[232:235], a[240:243], a[32:47]
    v_mfma_f32_32x32x16_bf16 a[48:63], a[232:235], a[244:247], a[48:63]
    s_waitcnt lgkmcnt(8)
    v_mfma_f32_32x32x16_bf16 v[224:239], a[0:3], v[32:35], 0
    ds_read_b64_tr_b16 a[24:25], v13 offset:6144
    ds_read_b64_tr_b16 a[26:27], v13 offset:6656
    s_add_i32 s35, s75, -98304
    s_max_i32 s35, s35, 0
    s_add_u32 s35, s35, s74
    s_add_i32 s36, s75, 0
    v_mfma_f32_32x32x16_bf16 v[240:255], a[4:7], v[32:35], 0
    ds_read_b64_tr_b16 a[28:29], v14 offset:6144
    ds_read_b64_tr_b16 a[30:31], v14 offset:6656
    s_add_u32 s36, s36, s74
    s_add_i32 s37, s75, 98304
    s_add_u32 s37, s37, s74
    v_smfmac_f32_16x16x64_bf16 a[204:207], a[224:227], a[0:7], v30
    s_waitcnt lgkmcnt(8)
    v_mfma_f32_32x32x16_bf16 v[224:239], a[8:11], v[36:39], v[224:239]
    ds_read_b64_tr_b16 a[0:1], v7 offset:36864
    ds_read_b64_tr_b16 a[2:3], v7 offset:37376
    s_waitcnt vmcnt(10)
    s_add_u32 s83, s0, 0x1800000
    s_mov_b64 exec, 1
    buffer_store_dwordx2 v[28:29], off, s[52:55], s83 sc1
    s_mov_b64 exec, -1
    v_mfma_f32_32x32x16_bf16 v[240:255], a[12:15], v[36:39], v[240:255]
    ds_read_b64_tr_b16 a[4:5], v8 offset:36864
    ds_read_b64_tr_b16 a[6:7], v8 offset:37376
    v_accvgpr_read_b32 v160, a32
    v_accvgpr_read_b32 v161, a33
    v_accvgpr_read_b32 v162, a34
    v_accvgpr_read_b32 v163, a35
    s_waitcnt lgkmcnt(8)
    v_mfma_f32_32x32x16_bf16 v[224:239], a[16:19], v[40:43], v[224:239]
    ds_read_b64_tr_b16 a[8:9], v9 offset:36864
    ds_read_b64_tr_b16 a[10:11], v9 offset:37376
    v_accvgpr_read_b32 v164, a36
    v_accvgpr_read_b32 v165, a37
    v_accvgpr_read_b32 v166, a38
    v_accvgpr_read_b32 v167, a39
    v_mfma_f32_32x32x16_bf16 v[240:255], a[20:23], v[40:43], v[240:255]
    ds_read_b64_tr_b16 a[12:13], v10 offset:36864
    ds_read_b64_tr_b16 a[14:15], v10 offset:37376
    v_accvgpr_read_b32 v168, a40
    v_accvgpr_read_b32 v169, a41
    v_accvgpr_read_b32 v170, a42
    v_accvgpr_read_b32 v171, a43
    s_waitcnt lgkmcnt(8)
    v_mfma_f32_32x32x16_bf16 v[224:239], a[24:27], v[44:47], v[224:239]
    ds_read_b64_tr_b16 a[16:17], v11 offset:36864
    ds_read_b64_tr_b16 a[18:19], v11 offset:37376
    v_accvgpr_read_b32 v172, a44
    v_accvgpr_read_b32 v173, a45
    v_accvgpr_read_b32 v174, a46
    v_accvgpr_read_b32 v175, a47
    v_mfma_f32_32x32x16_bf16 v[240:255], a[28:31], v[44:47], v[240:255]
    ds_read_b64_tr_b16 a[20:21], v12 offset:36864
    ds_read_b64_tr_b16 a[22:23], v12 offset:37376
    v_mul_f32 v192, v192, v160
    v_mul_f32 v193, v193, v161
    v_mul_f32 v194, v194, v162
    v_mul_f32 v195, v195, v163
    s_waitcnt lgkmcnt(8)
    v_mfma_f32_32x32x16_bf16 v[224:239], a[0:3], v[48:51], v[224:239]
    ds_read_b64_tr_b16 a[24:25], v13 offset:36864
    ds_read_b64_tr_b16 a[26:27], v13 offset:37376
    v_mul_f32 v196, v196, v164
    v_mul_f32 v197, v197, v165
    v_mul_f32 v198, v198, v166
    v_mul_f32 v199, v199, v167
    v_mfma_f32_32x32x16_bf16 v[240:255], a[4:7], v[48:51], v[240:255]
    ds_read_b64_tr_b16 a[28:29], v14 offset:36864
    ds_read_b64_tr_b16 a[30:31], v14 offset:37376
    v_mul_f32 v200, v200, v168
    v_mul_f32 v201, v201, v169
    v_mul_f32 v202, v202, v170
    v_mul_f32 v203, v203, v171
    v_smfmac_f32_16x16x64_bf16 a[204:207], a[224:227], a[0:7], v30
    s_waitcnt lgkmcnt(8)
    v_mfma_f32_32x32x16_bf16 v[224:239], a[8:11], v[52:55], v[224:239]
    s_barrier
    ds_read_b64_tr_b16 a[0:1], v7 offset:16384
    ds_read_b64_tr_b16 a[2:3], v7 offset:16896
    s_add_u32 m0, s73, 24576
    v_mul_f32 v204, v204, v172
    v_mul_f32 v205, v205, v173
    v_mfma_f32_32x32x16_bf16 v[240:255], a[12:15], v[52:55], v[240:255]
    ds_read_b64_tr_b16 a[4:5], v8 offset:16384
    ds_read_b64_tr_b16 a[6:7], v8 offset:16896
    buffer_load_dwordx4 v5, s[44:47], s66 offen lds
    v_mul_f32 v206, v206, v174
    v_mul_f32 v207, v207, v175
    v_cvt_pk_bf16_f32 v192, v192, v193
    s_waitcnt lgkmcnt(8)
    v_mfma_f32_32x32x16_bf16 v[224:239], a[16:19], v[56:59], v[224:239]
    ds_read_b64_tr_b16 a[8:9], v9 offset:16384
    ds_read_b64_tr_b16 a[10:11], v9 offset:16896
    buffer_load_dwordx4 v6, s[44:47], s66 offen offset:1024 lds
    s_add_u32 m0, s73, 26624
    v_cvt_pk_bf16_f32 v193, v194, v195
    v_cvt_pk_bf16_f32 v194, v196, v197
    v_mfma_f32_32x32x16_bf16 v[240:255], a[20:23], v[56:59], v[240:255]
    ds_read_b64_tr_b16 a[12:13], v10 offset:16384
    ds_read_b64_tr_b16 a[14:15], v10 offset:16896
    v_cvt_pk_bf16_f32 v195, v198, v199
    v_cvt_pk_bf16_f32 v196, v200, v201
    v_cvt_pk_bf16_f32 v197, v202, v203
    v_cvt_pk_bf16_f32 v198, v204, v205
    s_waitcnt lgkmcnt(8)
    v_mfma_f32_32x32x16_bf16 v[224:239], a[24:27], v[60:63], v[224:239]
    ds_read_b64_tr_b16 a[16:17], v11 offset:16384
    ds_read_b64_tr_b16 a[18:19], v11 offset:16896
    buffer_store_dwordx4 v[192:195], v1, s[52:55], s82 offen offset:0 sc1
    v_cvt_pk_bf16_f32 v199, v206, v207
    v_accvgpr_read_b32 v160, a48
    v_accvgpr_read_b32 v161, a49
    v_mfma_f32_32x32x16_bf16 v[240:255], a[28:31], v[60:63], v[240:255]
    ds_read_b64_tr_b16 a[20:21], v12 offset:16384
    ds_read_b64_tr_b16 a[22:23], v12 offset:16896
    buffer_store_dwordx4 v[196:199], v1, s[52:55], s82 offen offset:1024 sc1
    v_accvgpr_read_b32 v162, a50
    v_accvgpr_read_b32 v163, a51
    v_accvgpr_read_b32 v164, a52
    s_waitcnt lgkmcnt(8)
    v_mfma_f32_32x32x16_bf16 v[224:239], a[0:3], v[64:67], v[224:239]
    ds_read_b64_tr_b16 a[24:25], v13 offset:16384
    ds_read_b64_tr_b16 a[26:27], v13 offset:16896
    v_accvgpr_read_b32 v165, a53
    v_accvgpr_read_b32 v166, a54
    v_accvgpr_read_b32 v167, a55
    v_accvgpr_read_b32 v168, a56
    v_mfma_f32_32x32x16_bf16 v[240:255], a[4:7], v[64:67], v[240:255]
    ds_read_b64_tr_b16 a[28:29], v14 offset:16384
    ds_read_b64_tr_b16 a[30:31], v14 offset:16896
    buffer_load_dwordx4 v5, s[44:47], s67 offen lds
    v_accvgpr_read_b32 v169, a57
    v_accvgpr_read_b32 v170, a58
    v_accvgpr_read_b32 v171, a59
    v_smfmac_f32_16x16x64_bf16 a[204:207], a[224:227], a[0:7], v30
    s_waitcnt lgkmcnt(8)
    v_mfma_f32_32x32x16_bf16 v[224:239], a[8:11], v[68:71], v[224:239]
    ds_read_b64_tr_b16 a[0:1], v7 offset:8192
    ds_read_b64_tr_b16 a[2:3], v7 offset:8704
    v_accvgpr_read_b32 v172, a60
    v_accvgpr_read_b32 v173, a61
    v_accvgpr_read_b32 v174, a62
    v_accvgpr_read_b32 v175, a63
    v_mfma_f32_32x32x16_bf16 v[240:255], a[12:15], v[68:71], v[240:255]
    ds_read_b64_tr_b16 a[4:5], v8 offset:8192
    ds_read_b64_tr_b16 a[6:7], v8 offset:8704
    buffer_load_dwordx4 v6, s[44:47], s67 offen offset:1024 lds
    v_mul_f32 v208, v208, v160
    v_mul_f32 v209, v209, v161
    v_mul_f32 v210, v210, v162
    s_waitcnt lgkmcnt(8)
    v_mfma_f32_32x32x16_bf16 v[224:239], a[16:19], v[72:75], v[224:239]
    ds_read_b64_tr_b16 a[8:9], v9 offset:8192
    ds_read_b64_tr_b16 a[10:11], v9 offset:8704
    v_mul_f32 v211, v211, v163
    v_mul_f32 v212, v212, v164
    v_mul_f32 v213, v213, v165
    v_mul_f32 v214, v214, v166
    v_mfma_f32_32x32x16_bf16 v[240:255], a[20:23], v[72:75], v[240:255]
    ds_read_b64_tr_b16 a[12:13], v10 offset:8192
    ds_read_b64_tr_b16 a[14:15], v10 offset:8704
    v_mul_f32 v215, v215, v167
    v_mul_f32 v216, v216, v168
    v_mul_f32 v217, v217, v169
    v_mul_f32 v218, v218, v170
    s_waitcnt lgkmcnt(8)
    v_mfma_f32_32x32x16_bf16 v[224:239], a[24:27], v[76:79], v[224:239]
    ds_read_b64_tr_b16 a[16:17], v11 offset:8192
    ds_read_b64_tr_b16 a[18:19], v11 offset:8704
    v_mul_f32 v219, v219, v171
    v_mul_f32 v220, v220, v172
    v_mul_f32 v221, v221, v173
    v_mul_f32 v222, v222, v174
    v_mfma_f32_32x32x16_bf16 v[240:255], a[28:31], v[76:79], v[240:255]
    ds_read_b64_tr_b16 a[20:21], v12 offset:8192
    ds_read_b64_tr_b16 a[22:23], v12 offset:8704
    v_mul_f32 v223, v223, v175
    v_cvt_pk_bf16_f32 v208, v208, v209
    v_cvt_pk_bf16_f32 v209, v210, v211
    v_cvt_pk_bf16_f32 v210, v212, v213
    s_waitcnt lgkmcnt(8)
    v_mfma_f32_32x32x16_bf16 v[224:239], a[0:3], v[80:83], v[224:239]
    ds_read_b64_tr_b16 a[24:25], v13 offset:8192
    ds_read_b64_tr_b16 a[26:27], v13 offset:8704
    v_cvt_pk_bf16_f32 v211, v214, v215
    v_cvt_pk_bf16_f32 v212, v216, v217
    v_cvt_pk_bf16_f32 v213, v218, v219
    v_cvt_pk_bf16_f32 v214, v220, v221
    v_mfma_f32_32x32x16_bf16 v[240:255], a[4:7], v[80:83], v[240:255]
    ds_read_b64_tr_b16 a[28:29], v14 offset:8192
    ds_read_b64_tr_b16 a[30:31], v14 offset:8704
    buffer_store_dwordx4 v[208:211], v1, s[52:55], s82 offen offset:2048 sc1
    v_cvt_pk_bf16_f32 v215, v222, v223
    s_mov_b32 s78, 0xffff
    s_mov_b32 s79, 0xffff
    v_smfmac_f32_16x16x64_bf16 a[204:207], a[224:227], a[0:7], v30
    s_waitcnt lgkmcnt(8)
    v_mfma_f32_32x32x16_bf16 v[224:239], a[8:11], v[84:87], v[224:239]
    s_barrier
    ds_read_b64_tr_b16 a[0:1], v7 offset:10240
    ds_read_b64_tr_b16 a[2:3], v7 offset:10752
    buffer_store_dwordx4 v[212:215], v1, s[52:55], s82 offen offset:3072 sc1
    s_add_u32 m0, s73, 28672
    v_accvgpr_read_b32 v3, a248
    v_mfma_f32_32x32x16_bf16 v[240:255], a[12:15], v[84:87], v[240:255]
    ds_read_b64_tr_b16 a[4:5], v8 offset:10240
    ds_read_b64_tr_b16 a[6:7], v8 offset:10752
    v_accvgpr_read_b32 v4, a249
    v_accvgpr_read_b32 v20, a250
    v_mov_b32 v21, 0xf149f2ca
    v_cmp_le_i32 s[56:57], 0, v20
    s_waitcnt lgkmcnt(8)
    v_mfma_f32_32x32x16_bf16 v[224:239], a[16:19], v[88:91], v[224:239]
    ds_read_b64_tr_b16 a[8:9], v9 offset:10240
    ds_read_b64_tr_b16 a[10:11], v9 offset:10752
    buffer_load_dwordx4 v5, s[44:47], s68 offen lds
    v_cmp_le_i32 s[58:59], 1, v20
    v_cmp_le_i32 s[60:61], 2, v20
    v_cndmask_b32 v192, v21, 0, s[56:57]
    v_mfma_f32_32x32x16_bf16 v[240:255], a[20:23], v[88:91], v[240:255]
    ds_read_b64_tr_b16 a[12:13], v10 offset:10240
    ds_read_b64_tr_b16 a[14:15], v10 offset:10752
    buffer_load_dwordx4 v6, s[44:47], s68 offen offset:1024 lds
    s_add_u32 m0, s73, 30720
    v_cndmask_b32 v208, 0, v21, s[56:57]
    v_cmp_le_i32 s[62:63], 3, v20
    s_waitcnt lgkmcnt(8)
    v_mfma_f32_32x32x16_bf16 v[224:239], a[24:27], v[92:95], v[224:239]
    ds_read_b64_tr_b16 a[16:17], v11 offset:10240
    ds_read_b64_tr_b16 a[18:19], v11 offset:10752
    v_cndmask_b32 v193, v21, 0, s[58:59]
    v_cndmask_b32 v209, 0, v21, s[58:59]
    v_cmp_le_i32 s[56:57], 8, v20
    v_cndmask_b32 v194, v21, 0, s[60:61]
    v_mfma_f32_32x32x16_bf16 v[240:255], a[28:31], v[92:95], v[240:255]
    ds_read_b64_tr_b16 a[20:21], v12 offset:10240
    ds_read_b64_tr_b16 a[22:23], v12 offset:10752
    buffer_load_dwordx4 v5, s[44:47], s69 offen lds
    v_cndmask_b32 v210, 0, v21, s[60:61]
    v_cmp_le_i32 s[58:59], 9, v20
    v_cndmask_b32 v195, v21, 0, s[62:63]
    s_waitcnt lgkmcnt(8)
    v_mfma_f32_32x32x16_bf16 v[224:239], a[0:3], v[96:99], v[224:239]
    ds_read_b64_tr_b16 a[24:25], v13 offset:10240
    ds_read_b64_tr_b16 a[26:27], v13 offset:10752
    v_cndmask_b32 v211, 0, v21, s[62:63]
    v_cmp_le_i32 s[60:61], 10, v20
    v_cndmask_b32 v196, v21, 0, s[56:57]
    v_cndmask_b32 v212, 0, v21, s[56:57]
    v_mfma_f32_32x32x16_bf16 v[240:255], a[4:7], v[96:99], v[240:255]
    ds_read_b64_tr_b16 a[28:29], v14 offset:10240
    ds_read_b64_tr_b16 a[30:31], v14 offset:10752
    buffer_load_dwordx4 v6, s[44:47], s69 offen offset:1024 lds
    v_cmp_le_i32 s[62:63], 11, v20
    v_cndmask_b32 v197, v21, 0, s[58:59]
    v_cndmask_b32 v213, 0, v21, s[58:59]
    v_smfmac_f32_16x16x64_bf16 a[204:207], a[224:227], a[0:7], v30
    s_waitcnt lgkmcnt(8)
    v_mfma_f32_32x32x16_bf16 v[224:239], a[8:11], v[100:103], v[224:239]
    ds_read_b64_tr_b16 a[0:1], v7 offset:18432
    ds_read_b64_tr_b16 a[2:3], v7 offset:18944
    v_cmp_le_i32 s[56:57], 16, v20
    v_cndmask_b32 v198, v21, 0, s[60:61]
    v_cndmask_b32 v214, 0, v21, s[60:61]
    v_cmp_le_i32 s[58:59], 17, v20
    v_mfma_f32_32x32x16_bf16 v[240:255], a[12:15], v[100:103], v[240:255]
    ds_read_b64_tr_b16 a[4:5], v8 offset:18432
    ds_read_b64_tr_b16 a[6:7], v8 offset:18944
    v_cndmask_b32 v199, v21, 0, s[62:63]
    v_cndmask_b32 v215, 0, v21, s[62:63]
    v_cmp_le_i32 s[60:61], 18, v20
    v_cndmask_b32 v200, v21, 0, s[56:57]
    s_waitcnt lgkmcnt(8)
    v_mfma_f32_32x32x16_bf16 v[224:239], a[16:19], v[104:107], v[224:239]
    ds_read_b64_tr_b16 a[8:9], v9 offset:18432
    ds_read_b64_tr_b16 a[10:11], v9 offset:18944
    v_cndmask_b32 v216, 0, v21, s[56:57]
    v_cmp_le_i32 s[62:63], 19, v20
    v_cndmask_b32 v201, v21, 0, s[58:59]
    v_cndmask_b32 v217, 0, v21, s[58:59]
    v_mfma_f32_32x32x16_bf16 v[240:255], a[20:23], v[104:107], v[240:255]
    ds_read_b64_tr_b16 a[12:13], v10 offset:18432
    ds_read_b64_tr_b16 a[14:15], v10 offset:18944
    v_cmp_le_i32 s[56:57], 24, v20
    v_cndmask_b32 v202, v21, 0, s[60:61]
    v_cndmask_b32 v218, 0, v21, s[60:61]
    v_cmp_le_i32 s[58:59], 25, v20
    s_waitcnt lgkmcnt(8)
    v_mfma_f32_32x32x16_bf16 v[224:239], a[24:27], v[108:111], v[224:239]
    ds_read_b64_tr_b16 a[16:17], v11 offset:18432
    ds_read_b64_tr_b16 a[18:19], v11 offset:18944
    v_cndmask_b32 v203, v21, 0, s[62:63]
    v_cndmask_b32 v219, 0, v21, s[62:63]
    v_cmp_le_i32 s[60:61], 26, v20
    v_cndmask_b32 v204, v21, 0, s[56:57]
    v_mfma_f32_32x32x16_bf16 v[240:255], a[28:31], v[108:111], v[240:255]
    ds_read_b64_tr_b16 a[20:21], v12 offset:18432
    ds_read_b64_tr_b16 a[22:23], v12 offset:18944
    v_cndmask_b32 v220, 0, v21, s[56:57]
    v_cmp_le_i32 s[62:63], 27, v20
    v_cndmask_b32 v205, v21, 0, s[58:59]
    v_cndmask_b32 v221, 0, v21, s[58:59]
    s_waitcnt lgkmcnt(8)
    v_mfma_f32_32x32x16_bf16 v[224:239], a[0:3], v[112:115], v[224:239]
    ds_read_b64_tr_b16 a[24:25], v13 offset:18432
    ds_read_b64_tr_b16 a[26:27], v13 offset:18944
    v_cndmask_b32 v206, v21, 0, s[60:61]
    v_cndmask_b32 v222, 0, v21, s[60:61]
    v_cndmask_b32 v207, v21, 0, s[62:63]
    v_cndmask_b32 v223, 0, v21, s[62:63]
    v_mfma_f32_32x32x16_bf16 v[240:255], a[4:7], v[112:115], v[240:255]
    ds_read_b64_tr_b16 a[28:29], v14 offset:18432
    ds_read_b64_tr_b16 a[30:31], v14 offset:18944
    v_smfmac_f32_16x16x64_bf16 a[204:207], a[224:227], a[0:7], v30
    s_waitcnt lgkmcnt(8)
    v_mfma_f32_32x32x16_bf16 v[224:239], a[8:11], v[116:119], v[224:239]
    s_waitcnt vmcnt(17)
    s_barrier
    ds_read_b64_tr_b16 a[0:1], v7 offset:20480
    ds_read_b64_tr_b16 a[2:3], v7 offset:20992
    s_add_u32 m0, s73, 0
    v_mfma_f32_32x32x16_bf16 v[240:255], a[12:15], v[116:119], v[240:255]
    ds_read_b64_tr_b16 a[4:5], v8 offset:20480
    ds_read_b64_tr_b16 a[6:7], v8 offset:20992
    buffer_load_dwordx4 v5, s[44:47], s70 offen lds
    s_waitcnt lgkmcnt(8)
    v_mfma_f32_32x32x16_bf16 v[224:239], a[16:19], v[120:123], v[224:239]
    ds_read_b64_tr_b16 a[8:9], v7 offset:12288
    ds_read_b64_tr_b16 a[10:11], v7 offset:12800
    buffer_load_dwordx4 v6, s[44:47], s70 offen offset:1024 lds
    s_add_u32 m0, s73, 2048
    v_mfma_f32_32x32x16_bf16 v[240:255], a[20:23], v[120:123], v[240:255]
    ds_read_b64_tr_b16 a[12:13], v8 offset:12288
    ds_read_b64_tr_b16 a[14:15], v8 offset:12800
    s_waitcnt lgkmcnt(8)
    v_mfma_f32_32x32x16_bf16 v[224:239], a[24:27], v[124:127], v[224:239]
    ds_read_b64_tr_b16 a[16:17], v9 offset:20480
    ds_read_b64_tr_b16 a[18:19], v9 offset:20992
    buffer_load_dwordx4 v5, s[44:47], s71 offen lds
    v_mfma_f32_32x32x16_bf16 v[240:255], a[28:31], v[124:127], v[240:255]
    ds_read_b64_tr_b16 a[20:21], v10 offset:20480
    ds_read_b64_tr_b16 a[22:23], v10 offset:20992
    buffer_load_dwordx4 v6, s[44:47], s71 offen offset:1024 lds
    s_waitcnt lgkmcnt(8)
    v_mfma_f32_32x32x16_bf16 v[224:239], a[0:3], v[128:131], v[224:239]
    ds_read_b64_tr_b16 a[24:25], v11 offset:20480
    ds_read_b64_tr_b16 a[26:27], v11 offset:20992
    v_mfma_f32_32x32x16_bf16 v[240:255], a[4:7], v[128:131], v[240:255]
    ds_read_b64_tr_b16 a[28:29], v12 offset:20480
    ds_read_b64_tr_b16 a[30:31], v12 offset:20992
    v_smfmac_f32_16x16x64_bf16 a[204:207], a[224:227], a[0:7], v30
    s_waitcnt lgkmcnt(8)
    v_mfma_f32_32x32x16_bf16 v[224:239], a[8:11], v[144:147], v[224:239]
    ds_read_b64_tr_b16 a[0:1], v13 offset:20480
    ds_read_b64_tr_b16 a[2:3], v13 offset:20992
    v_mfma_f32_32x32x16_bf16 v[240:255], a[12:15], v[144:147], v[240:255]
    ds_read_b64_tr_b16 a[4:5], v14 offset:20480
    ds_read_b64_tr_b16 a[6:7], v14 offset:20992
    v_smfmac_f32_16x16x64_bf16 a[204:207], a[224:227], a[8:15], v30
    s_waitcnt lgkmcnt(8)
    v_mfma_f32_32x32x16_bf16 v[224:239], a[16:19], v[132:135], v[224:239]
    ds_read_b64_tr_b16 a[8:9], v9 offset:12288
    ds_read_b64_tr_b16 a[10:11], v9 offset:12800
    v_mfma_f32_32x32x16_bf16 v[240:255], a[20:23], v[132:135], v[240:255]
    ds_read_b64_tr_b16 a[12:13], v10 offset:12288
    ds_read_b64_tr_b16 a[14:15], v10 offset:12800
    s_lshl_b32 s101, s72, 2
    v_add_u32 v15, s101, v1
    v_accvgpr_read_b32 v16, a204
    v_accvgpr_read_b32 v17, a205
    v_add_f32 v16, v16, v17
    v_cvt_pk_bf16_f32 v17, v16, v16
    v_lshlrev_b32 v17, 16, v17
    s_waitcnt lgkmcnt(8)
    v_mfma_f32_32x32x16_bf16 v[224:239], a[24:27], v[136:139], v[224:239]
    ds_read_b64_tr_b16 a[16:17], v11 offset:12288
    ds_read_b64_tr_b16 a[18:19], v11 offset:12800
    v_sub_f32 v17, v16, v17
    v_cvt_pk_bf16_f32 v16, v16, v17
    ds_write_b32 v15, v16 offset:38912
    v_mfma_f32_32x32x16_bf16 v[240:255], a[28:31], v[136:139], v[240:255]
    ds_read_b64_tr_b16 a[20:21], v12 offset:12288
    ds_read_b64_tr_b16 a[22:23], v12 offset:12800
    s_waitcnt lgkmcnt(9)
    v_mfma_f32_32x32x16_bf16 v[224:239], a[0:3], v[140:143], v[224:239]
    ds_read_b64_tr_b16 a[24:25], v13 offset:12288
    ds_read_b64_tr_b16 a[26:27], v13 offset:12800
    v_mfma_f32_32x32x16_bf16 v[240:255], a[4:7], v[140:143], v[240:255]
    ds_read_b64_tr_b16 a[28:29], v14 offset:12288
    ds_read_b64_tr_b16 a[30:31], v14 offset:12800
    s_waitcnt lgkmcnt(9)
    v_mfma_f32_32x32x16_bf16 v[224:239], a[8:11], v[148:151], v[224:239]
    s_waitcnt vmcnt(17) lgkmcnt(6)
    s_barrier
    ds_read_b128 a[232:235], v1 offset:38912
    ds_read_b64_tr_b16 a[0:1], v7 offset:14336
    ds_read_b64_tr_b16 a[2:3], v7 offset:14848
    v_mfma_f32_32x32x16_bf16 v[240:255], a[12:15], v[148:151], v[240:255]
    ds_read_b64_tr_b16 a[4:5], v8 offset:14336
    ds_read_b64_tr_b16 a[6:7], v8 offset:14848
    s_waitcnt lgkmcnt(9)
    v_mfma_f32_32x32x16_bf16 v[224:239], a[16:19], v[152:155], v[224:239]
    ds_read_b64_tr_b16 a[8:9], v9 offset:14336
    ds_read_b64_tr_b16 a[10:11], v9 offset:14848
    v_mfma_f32_32x32x16_bf16 v[240:255], a[20:23], v[152:155], v[240:255]
    ds_read_b64_tr_b16 a[12:13], v10 offset:14336
    ds_read_b64_tr_b16 a[14:15], v10 offset:14848
    s_waitcnt lgkmcnt(9)
    v_mfma_f32_32x32x16_bf16 v[224:239], a[24:27], v[156:159], v[224:239]
    ds_read_b64_tr_b16 a[16:17], v11 offset:14336
    ds_read_b64_tr_b16 a[18:19], v11 offset:14848
    v_mfma_f32_32x32x16_bf16 v[240:255], a[28:31], v[156:159], v[240:255]
    ds_read_b64_tr_b16 a[20:21], v12 offset:14336
    ds_read_b64_tr_b16 a[22:23], v12 offset:14848
    s_waitcnt lgkmcnt(12)
    v_mfma_f32_32x32x16_bf16 v[224:239], a[232:235], a[240:243], v[224:239]
    v_mfma_f32_32x32x16_bf16 v[240:255], a[232:235], a[244:247], v[240:255]
    s_waitcnt lgkmcnt(8)
    v_mfma_f32_32x32x16_bf16 v[160:175], a[0:3], v[32:35], 0
    ds_read_b64_tr_b16 a[24:25], v13 offset:14336
    ds_read_b64_tr_b16 a[26:27], v13 offset:14848
    s_mov_b32 s83, 0x1800000
    buffer_load_dwordx2 v[26:27], v3, s[52:55], s83 offen
    v_mfma_f32_32x32x16_bf16 v[176:191], a[4:7], v[32:35], 0
    ds_read_b64_tr_b16 a[28:29], v14 offset:14336
    ds_read_b64_tr_b16 a[30:31], v14 offset:14848
    v_smfmac_f32_16x16x64_bf16 a[208:211], a[224:227], a[0:7], v30
    s_waitcnt lgkmcnt(8)
    v_mfma_f32_32x32x16_bf16 v[160:175], a[8:11], v[36:39], v[160:175]
    ds_read_b64_tr_b16 a[0:1], v7 offset:22528
    ds_read_b64_tr_b16 a[2:3], v7 offset:23040
    s_waitcnt vmcnt(9)
    s_add_u32 s83, s0, 0x1820000
    s_mov_b64 exec, 1
    buffer_store_dwordx2 v[28:29], off, s[52:55], s83 sc1
    s_mov_b64 exec, -1
    v_mfma_f32_32x32x16_bf16 v[176:191], a[12:15], v[36:39], v[176:191]
    ds_read_b64_tr_b16 a[4:5], v8 offset:22528
    ds_read_b64_tr_b16 a[6:7], v8 offset:23040
    v_mul_f32 v224, v224, v18
    v_mul_f32 v225, v225, v18
    v_mul_f32 v226, v226, v18
    s_waitcnt lgkmcnt(8)
    v_mfma_f32_32x32x16_bf16 v[160:175], a[16:19], v[40:43], v[160:175]
    ds_read_b64_tr_b16 a[8:9], v9 offset:22528
    ds_read_b64_tr_b16 a[10:11], v9 offset:23040
    v_mul_f32 v227, v227, v18
    v_mul_f32 v228, v228, v18
    v_mul_f32 v229, v229, v18
    v_mfma_f32_32x32x16_bf16 v[176:191], a[20:23], v[40:43], v[176:191]
    ds_read_b64_tr_b16 a[12:13], v10 offset:22528
    ds_read_b64_tr_b16 a[14:15], v10 offset:23040
    v_mul_f32 v230, v230, v18
    v_mul_f32 v231, v231, v18
    v_mul_f32 v232, v232, v18
    s_waitcnt lgkmcnt(8)
    v_mfma_f32_32x32x16_bf16 v[160:175], a[24:27], v[44:47], v[160:175]
    ds_read_b64_tr_b16 a[16:17], v11 offset:22528
    ds_read_b64_tr_b16 a[18:19], v11 offset:23040
    v_mul_f32 v233, v233, v18
    v_mul_f32 v234, v234, v18
    v_mul_f32 v235, v235, v18
    v_mfma_f32_32x32x16_bf16 v[176:191], a[28:31], v[44:47], v[176:191]
    ds_read_b64_tr_b16 a[20:21], v12 offset:22528
    ds_read_b64_tr_b16 a[22:23], v12 offset:23040
    v_mul_f32 v236, v236, v18
    v_mul_f32 v237, v237, v18
    v_mul_f32 v238, v238, v18
    s_waitcnt lgkmcnt(8)
    v_mfma_f32_32x32x16_bf16 v[160:175], a[0:3], v[48:51], v[160:175]
    ds_read_b64_tr_b16 a[24:25], v13 offset:22528
    ds_read_b64_tr_b16 a[26:27], v13 offset:23040
    v_mul_f32 v239, v239, v18
    v_mul_f32 v240, v240, v18
    v_mul_f32 v241, v241, v18
    v_mfma_f32_32x32x16_bf16 v[176:191], a[4:7], v[48:51], v[176:191]
    ds_read_b64_tr_b16 a[28:29], v14 offset:22528
    ds_read_b64_tr_b16 a[30:31], v14 offset:23040
    v_mul_f32 v242, v242, v18
    v_mul_f32 v243, v243, v18
    v_mul_f32 v244, v244, v18
    v_smfmac_f32_16x16x64_bf16 a[208:211], a[224:227], a[0:7], v30
    s_waitcnt lgkmcnt(8)
    v_mfma_f32_32x32x16_bf16 v[160:175], a[8:11], v[52:55], v[160:175]
    s_barrier
    ds_read_b64_tr_b16 a[0:1], v7 offset:24576
    ds_read_b64_tr_b16 a[2:3], v7 offset:25088
    v_mul_f32 v245, v245, v18
    v_mul_f32 v246, v246, v18
    v_mfma_f32_32x32x16_bf16 v[176:191], a[12:15], v[52:55], v[176:191]
    ds_read_b64_tr_b16 a[4:5], v8 offset:24576
    ds_read_b64_tr_b16 a[6:7], v8 offset:25088
    v_mul_f32 v247, v247, v18
    v_mul_f32 v248, v248, v18
    v_mul_f32 v249, v249, v18
    s_waitcnt lgkmcnt(8)
    v_mfma_f32_32x32x16_bf16 v[160:175], a[16:19], v[56:59], v[160:175]
    ds_read_b64_tr_b16 a[8:9], v9 offset:24576
    ds_read_b64_tr_b16 a[10:11], v9 offset:25088
    v_mul_f32 v250, v250, v18
    v_mul_f32 v251, v251, v18
    v_mul_f32 v252, v252, v18
    v_mfma_f32_32x32x16_bf16 v[176:191], a[20:23], v[56:59], v[176:191]
    ds_read_b64_tr_b16 a[12:13], v10 offset:24576
    ds_read_b64_tr_b16 a[14:15], v10 offset:25088
    v_mul_f32 v253, v253, v18
    v_mul_f32 v254, v254, v18
    v_mul_f32 v255, v255, v18
    s_waitcnt lgkmcnt(8)
    v_mfma_f32_32x32x16_bf16 v[160:175], a[24:27], v[60:63], v[160:175]
    ds_read_b64_tr_b16 a[16:17], v11 offset:24576
    ds_read_b64_tr_b16 a[18:19], v11 offset:25088
    s_lshl2_add_u32 s80, s2, s72
    s_lshl_b32 s80, s80, 13
    s_add_u32 s80, s80, 0x2800000
    v_mfma_f32_32x32x16_bf16 v[176:191], a[28:31], v[60:63], v[176:191]
    ds_read_b64_tr_b16 a[20:21], v12 offset:24576
    ds_read_b64_tr_b16 a[22:23], v12 offset:25088
    s_waitcnt lgkmcnt(8)
    v_mfma_f32_32x32x16_bf16 v[160:175], a[0:3], v[64:67], v[160:175]
    ds_read_b64_tr_b16 a[24:25], v13 offset:24576
    ds_read_b64_tr_b16 a[26:27], v13 offset:25088
    v_mfma_f32_32x32x16_bf16 v[176:191], a[4:7], v[64:67], v[176:191]
    ds_read_b64_tr_b16 a[28:29], v14 offset:24576
    ds_read_b64_tr_b16 a[30:31], v14 offset:25088
    v_smfmac_f32_16x16x64_bf16 a[208:211], a[224:227], a[0:7], v30
    s_waitcnt lgkmcnt(8)
    v_mfma_f32_32x32x16_bf16 v[160:175], a[8:11], v[68:71], v[160:175]
    ds_read_b64_tr_b16 a[0:1], v7 offset:26624
    ds_read_b64_tr_b16 a[2:3], v7 offset:27136
    v_mfma_f32_32x32x16_bf16 v[176:191], a[12:15], v[68:71], v[176:191]
    ds_read_b64_tr_b16 a[4:5], v8 offset:26624
    ds_read_b64_tr_b16 a[6:7], v8 offset:27136
    s_waitcnt lgkmcnt(8)
    v_mfma_f32_32x32x16_bf16 v[160:175], a[16:19], v[72:75], v[160:175]
    ds_read_b64_tr_b16 a[8:9], v9 offset:26624
    ds_read_b64_tr_b16 a[10:11], v9 offset:27136
    s_waitcnt vmcnt(1)
    v_cmp_ne_u64 vcc, v[26:27], v[28:29]
    s_cbranch_vccz pok_4
    s_movk_i32 s101, 30000
    s_mov_b32 s83, 0x1800000
plp_5:
    s_mov_b64 exec, vcc
    buffer_load_dwordx2 v[26:27], v3, s[52:55], s83 offen sc1
    s_mov_b64 exec, -1
    s_waitcnt vmcnt(0)
    v_cmp_ne_u64 vcc, v[26:27], v[28:29]
    s_cbranch_vccz pok_4
    s_sub_u32 s101, s101, 1
    s_cbranch_scc0 plp_5
pok_4:
    v_mfma_f32_32x32x16_bf16 v[176:191], a[20:23], v[72:75], v[176:191]
    ds_read_b64_tr_b16 a[12:13], v10 offset:26624
    ds_read_b64_tr_b16 a[14:15], v10 offset:27136
    s_waitcnt lgkmcnt(8)
    v_mfma_f32_32x32x16_bf16 v[160:175], a[24:27], v[76:79], v[160:175]
    ds_read_b64_tr_b16 a[16:17], v11 offset:26624
    ds_read_b64_tr_b16 a[18:19], v11 offset:27136
    buffer_load_dwordx4 a[184:187], v1, s[52:55], s36 offen
    v_mfma_f32_32x32x16_bf16 v[176:191], a[28:31], v[76:79], v[176:191]
    ds_read_b64_tr_b16 a[20:21], v12 offset:26624
    ds_read_b64_tr_b16 a[22:23], v12 offset:27136
    s_waitcnt lgkmcnt(8)
    v_mfma_f32_32x32x16_bf16 v[160:175], a[0:3], v[80:83], v[160:175]
    ds_read_b64_tr_b16 a[24:25], v13 offset:26624
    ds_read_b64_tr_b16 a[26:27], v13 offset:27136
    buffer_load_dwordx4 a[188:191], v1, s[52:55], s37 offen
    v_mfma_f32_32x32x16_bf16 v[176:191], a[4:7], v[80:83], v[176:191]
    ds_read_b64_tr_b16 a[28:29], v14 offset:26624
    ds_read_b64_tr_b16 a[30:31], v14 offset:27136
    v_smfmac_f32_16x16x64_bf16 a[208:211], a[224:227], a[0:7], v30
    s_waitcnt lgkmcnt(8)
    v_mfma_f32_32x32x16_bf16 v[160:175], a[8:11], v[84:87], v[160:175]
    s_barrier
    ds_read_b64_tr_b16 a[0:1], v7 offset:28672
    ds_read_b64_tr_b16 a[2:3], v7 offset:29184
    buffer_load_dwordx4 a[64:67], v22, s[52:55], s28 offen
    v_mfma_f32_32x32x16_bf16 v[176:191], a[12:15], v[84:87], v[176:191]
    ds_read_b64_tr_b16 a[4:5], v8 offset:28672
    ds_read_b64_tr_b16 a[6:7], v8 offset:29184
    s_waitcnt lgkmcnt(8)
    v_mfma_f32_32x32x16_bf16 v[160:175], a[16:19], v[88:91], v[160:175]
    ds_read_b64_tr_b16 a[8:9], v9 offset:28672
    ds_read_b64_tr_b16 a[10:11], v9 offset:29184
    buffer_load_dwordx4 a[76:79], v22, s[52:55], s29 offen
    v_mfma_f32_32x32x16_bf16 v[176:191], a[20:23], v[88:91], v[176:191]
    ds_read_b64_tr_b16 a[12:13], v10 offset:28672
    ds_read_b64_tr_b16 a[14:15], v10 offset:29184
    s_waitcnt lgkmcnt(8)
    v_mfma_f32_32x32x16_bf16 v[160:175], a[24:27], v[92:95], v[160:175]
    ds_read_b64_tr_b16 a[16:17], v11 offset:28672
    ds_read_b64_tr_b16 a[18:19], v11 offset:29184
    buffer_load_dwordx4 a[88:91], v22, s[52:55], s30 offen
    v_mfma_f32_32x32x16_bf16 v[176:191], a[28:31], v[92:95], v[176:191]
    ds_read_b64_tr_b16 a[20:21], v12 offset:28672
    ds_read_b64_tr_b16 a[22:23], v12 offset:29184
    s_waitcnt lgkmcnt(8)
    v_mfma_f32_32x32x16_bf16 v[160:175], a[0:3], v[96:99], v[160:175]
    ds_read_b64_tr_b16 a[24:25], v13 offset:28672
    ds_read_b64_tr_b16 a[26:27], v13 offset:29184
    buffer_load_dwordx4 a[100:103], v22, s[52:55], s31 offen
    v_mfma_f32_32x32x16_bf16 v[176:191], a[4:7], v[96:99], v[176:191]
    ds_read_b64_tr_b16 a[28:29], v14 offset:28672
    ds_read_b64_tr_b16 a[30:31], v14 offset:29184
    v_smfmac_f32_16x16x64_bf16 a[208:211], a[224:227], a[0:7], v30
    s_waitcnt lgkmcnt(8)
    v_mfma_f32_32x32x16_bf16 v[160:175], a[8:11], v[100:103], v[160:175]
    ds_read_b64_tr_b16 a[0:1], v7 offset:30720
    ds_read_b64_tr_b16 a[2:3], v7 offset:31232
    buffer_load_dwordx4 a[112:115], v22, s[52:55], s32 offen
    v_mfma_f32_32x32x16_bf16 v[176:191], a[12:15], v[100:103], v[176:191]
    ds_read_b64_tr_b16 a[4:5], v8 offset:30720
    ds_read_b64_tr_b16 a[6:7], v8 offset:31232
    s_waitcnt lgkmcnt(8)
    v_mfma_f32_32x32x16_bf16 v[160:175], a[16:19], v[104:107], v[160:175]
    ds_read_b64_tr_b16 a[8:9], v9 offset:30720
    ds_read_b64_tr_b16 a[10:11], v9 offset:31232
    buffer_load_dwordx4 a[124:127], v22, s[52:55], s33 offen
    v_mfma_f32_32x32x16_bf16 v[176:191], a[20:23], v[104:107], v[176:191]
    ds_read_b64_tr_b16 a[12:13], v10 offset:30720
    ds_read_b64_tr_b16 a[14:15], v10 offset:31232
    s_waitcnt lgkmcnt(8)
    v_mfma_f32_32x32x16_bf16 v[160:175], a[24:27], v[108:111], v[160:175]
    ds_read_b64_tr_b16 a[16:17], v11 offset:30720
    ds_read_b64_tr_b16 a[18:19], v11 offset:31232
    buffer_load_dwordx4 a[136:139], v22, s[52:55], s34 offen
    v_mfma_f32_32x32x16_bf16 v[176:191], a[28:31], v[108:111], v[176:191]
    ds_read_b64_tr_b16 a[20:21], v12 offset:30720
    ds_read_b64_tr_b16 a[22:23], v12 offset:31232
    s_waitcnt lgkmcnt(8)
    v_mfma_f32_32x32x16_bf16 v[160:175], a[0:3], v[112:115], v[160:175]
    ds_read_b64_tr_b16 a[24:25], v13 offset:30720
    ds_read_b64_tr_b16 a[26:27], v13 offset:31232
    buffer_load_dwordx4 a[148:151], v22, s[52:55], s35 offen
    v_mfma_f32_32x32x16_bf16 v[176:191], a[4:7], v[112:115], v[176:191]
    ds_read_b64_tr_b16 a[28:29], v14 offset:30720
    ds_read_b64_tr_b16 a[30:31], v14 offset:31232
    v_smfmac_f32_16x16x64_bf16 a[208:211], a[224:227], a[0:7], v30
    s_waitcnt lgkmcnt(8)
    v_mfma_f32_32x32x16_bf16 v[160:175], a[8:11], v[116:119], v[160:175]
    s_barrier
    ds_read_b64_tr_b16 a[0:1], v7 offset:0
    ds_read_b64_tr_b16 a[2:3], v7 offset:512
    buffer_load_dwordx4 a[160:163], v22, s[52:55], s36 offen
    v_mfma_f32_32x32x16_bf16 v[176:191], a[12:15], v[116:119], v[176:191]
    ds_read_b64_tr_b16 a[4:5], v8 offset:0
    ds_read_b64_tr_b16 a[6:7], v8 offset:512
    s_waitcnt lgkmcnt(8)
    v_mfma_f32_32x32x16_bf16 v[160:175], a[16:19], v[120:123], v[160:175]
    ds_read_b64_tr_b16 a[8:9], v7 offset:2048
    ds_read_b64_tr_b16 a[10:11], v7 offset:2560
    buffer_load_dwordx4 a[172:175], v22, s[52:55], s37 offen
    v_mfma_f32_32x32x16_bf16 v[176:191], a[20:23], v[120:123], v[176:191]
    ds_read_b64_tr_b16 a[12:13], v8 offset:2048
    ds_read_b64_tr_b16 a[14:15], v8 offset:2560
    s_waitcnt lgkmcnt(8)
    v_mfma_f32_32x32x16_bf16 v[160:175], a[24:27], v[124:127], v[160:175]
    ds_read_b64_tr_b16 a[16:17], v9 offset:0
    ds_read_b64_tr_b16 a[18:19], v9 offset:512
    s_mov_b64 exec, s[78:79]
    buffer_load_dwordx4 a[68:71], v23, s[52:55], s28 offen offset:0
    buffer_load_dwordx4 a[72:75], v23, s[52:55], s28 offen offset:512
    s_mov_b64 exec, -1
    v_mfma_f32_32x32x16_bf16 v[176:191], a[28:31], v[124:127], v[176:191]
    ds_read_b64_tr_b16 a[20:21], v10 offset:0
    ds_read_b64_tr_b16 a[22:23], v10 offset:512
    s_waitcnt lgkmcnt(8)
    v_mfma_f32_32x32x16_bf16 v[160:175], a[0:3], v[128:131], v[160:175]
    ds_read_b64_tr_b16 a[24:25], v11 offset:0
    ds_read_b64_tr_b16 a[26:27], v11 offset:512
    s_mov_b64 exec, s[78:79]
    buffer_load_dwordx4 a[80:83], v23, s[52:55], s29 offen offset:0
    buffer_load_dwordx4 a[84:87], v23, s[52:55], s29 offen offset:512
    s_mov_b64 exec, -1
    v_mfma_f32_32x32x16_bf16 v[176:191], a[4:7], v[128:131], v[176:191]
    ds_read_b64_tr_b16 a[28:29], v12 offset:0
    ds_read_b64_tr_b16 a[30:31], v12 offset:512
    v_smfmac_f32_16x16x64_bf16 a[208:211], a[224:227], a[0:7], v30
    s_waitcnt lgkmcnt(8)
    v_mfma_f32_32x32x16_bf16 v[160:175], a[8:11], v[144:147], v[160:175]
    ds_read_b64_tr_b16 a[0:1], v13 offset:0
    ds_read_b64_tr_b16 a[2:3], v13 offset:512
    v_mfma_f32_32x32x16_bf16 v[176:191], a[12:15], v[144:147], v[176:191]
    ds_read_b64_tr_b16 a[4:5], v14 offset:0
    ds_read_b64_tr_b16 a[6:7], v14 offset:512
    v_smfmac_f32_16x16x64_bf16 a[208:211], a[224:227], a[8:15], v30
    s_waitcnt lgkmcnt(8)
    v_mfma_f32_32x32x16_bf16 v[160:175], a[16:19], v[132:135], v[160:175]
    ds_read_b64_tr_b16 a[8:9], v9 offset:2048
    ds_read_b64_tr_b16 a[10:11], v9 offset:2560
    v_mfma_f32_32x32x16_bf16 v[176:191], a[20:23], v[132:135], v[176:191]
    ds_read_b64_tr_b16 a[12:13], v10 offset:2048
    ds_read_b64_tr_b16 a[14:15], v10 offset:2560
    s_lshl_b32 s101, s72, 2
    v_add_u32 v15, s101, v1
    v_accvgpr_read_b32 v16, a208
    v_accvgpr_read_b32 v17, a209
    v_add_f32 v16, v16, v17
    v_cvt_pk_bf16_f32 v17, v16, v16
    s_waitcnt lgkmcnt(8)
    v_mfma_f32_32x32x16_bf16 v[160:175], a[24:27], v[136:139], v[160:175]
    ds_read_b64_tr_b16 a[16:17], v11 offset:2048
    ds_read_b64_tr_b16 a[18:19], v11 offset:2560
    v_lshlrev_b32 v17, 16, v17
    v_sub_f32 v17, v16, v17
    v_cvt_pk_bf16_f32 v16, v16, v17
    ds_write_b32 v15, v16 offset:38912
    v_mfma_f32_32x32x16_bf16 v[176:191], a[28:31], v[136:139], v[176:191]
    ds_read_b64_tr_b16 a[20:21], v12 offset:2048
    ds_read_b64_tr_b16 a[22:23], v12 offset:2560
    s_waitcnt lgkmcnt(9)
    v_mfma_f32_32x32x16_bf16 v[160:175], a[0:3], v[140:143], v[160:175]
    ds_read_b64_tr_b16 a[24:25], v13 offset:2048
    ds_read_b64_tr_b16 a[26:27], v13 offset:2560
    v_mfma_f32_32x32x16_bf16 v[176:191], a[4:7], v[140:143], v[176:191]
    ds_read_b64_tr_b16 a[28:29], v14 offset:2048
    ds_read_b64_tr_b16 a[30:31], v14 offset:2560
    s_waitcnt lgkmcnt(9)
    v_mfma_f32_32x32x16_bf16 v[160:175], a[8:11], v[148:151], v[160:175]
    s_waitcnt lgkmcnt(6)
    s_barrier
    ds_read_b128 a[232:235], v1 offset:38912
    v_mfma_f32_32x32x16_bf16 v[176:191], a[12:15], v[148:151], v[176:191]
    s_waitcnt lgkmcnt(5)
    v_mfma_f32_32x32x16_bf16 v[160:175], a[16:19], v[152:155], v[160:175]
    v_mfma_f32_32x32x16_bf16 v[176:191], a[20:23], v[152:155], v[176:191]
    s_waitcnt lgkmcnt(1)
    v_mfma_f32_32x32x16_bf16 v[160:175], a[24:27], v[156:159], v[160:175]
    v_mfma_f32_32x32x16_bf16 v[176:191], a[28:31], v[156:159], v[176:191]
    s_waitcnt lgkmcnt(0)
    v_mfma_f32_32x32x16_bf16 v[160:175], a[232:235], a[240:243], v[160:175]
    v_mfma_f32_32x32x16_bf16 v[176:191], a[232:235], a[244:247], v[176:191]
    s_mul_i32 s74, s51, 163840
    s_add_u32 s74, s74, 0x800000
    v_add_u32 v30, s74, v1
    s_nop 7
    v_pk_mul_f32 v[160:161], v[160:161], v[224:225]
    v_pk_mul_f32 v[162:163], v[162:163], v[226:227]
    v_pk_mul_f32 v[164:165], v[164:165], v[228:229]
    v_pk_mul_f32 v[166:167], v[166:167], v[230:231]
    v_pk_mul_f32 v[168:169], v[168:169], v[232:233]
    v_pk_mul_f32 v[170:171], v[170:171], v[234:235]
    v_pk_mul_f32 v[172:173], v[172:173], v[236:237]
    v_pk_mul_f32 v[174:175], v[174:175], v[238:239]
    v_cvt_pk_bf16_f32 v160, v160, v161
    v_cvt_pk_bf16_f32 v161, v162, v163
    v_cvt_pk_bf16_f32 v162, v164, v165
    v_cvt_pk_bf16_f32 v163, v166, v167
    buffer_store_dwordx4 v[160:163], v1, s[52:55], s81 offen offset:0 sc1
    v_cvt_pk_bf16_f32 v164, v168, v169
    v_cvt_pk_bf16_f32 v165, v170, v171
    v_cvt_pk_bf16_f32 v166, v172, v173
    v_cvt_pk_bf16_f32 v167, v174, v175
    buffer_store_dwordx4 v[164:167], v1, s[52:55], s81 offen offset:1024 sc1
    v_pk_mul_f32 v[176:177], v[176:177], v[240:241]
    v_pk_mul_f32 v[178:179], v[178:179], v[242:243]
    v_pk_mul_f32 v[180:181], v[180:181], v[244:245]
    v_pk_mul_f32 v[182:183], v[182:183], v[246:247]
    v_pk_mul_f32 v[184:185], v[184:185], v[248:249]
    v_pk_mul_f32 v[186:187], v[186:187], v[250:251]
    v_pk_mul_f32 v[188:189], v[188:189], v[252:253]
    v_pk_mul_f32 v[190:191], v[190:191], v[254:255]
    v_cvt_pk_bf16_f32 v176, v176, v177
    v_cvt_pk_bf16_f32 v177, v178, v179
    v_cvt_pk_bf16_f32 v178, v180, v181
    v_cvt_pk_bf16_f32 v179, v182, v183
    buffer_store_dwordx4 v[176:179], v1, s[52:55], s81 offen offset:2048 sc1
    v_cvt_pk_bf16_f32 v180, v184, v185
    v_cvt_pk_bf16_f32 v181, v186, v187
    v_cvt_pk_bf16_f32 v182, v188, v189
    v_cvt_pk_bf16_f32 v183, v190, v191
    buffer_store_dwordx4 v[180:183], v1, s[52:55], s81 offen offset:3072 sc1
    s_barrier
    s_branch k_att
k_p:
    v_lshrrev_b32 v232, 2, v0
    s_lshl_b32 s76, s72, 4
    v_and_b32 v233, 3, v0
    v_add_u32 v232, s76, v232
    s_lshl_b32 s76, s3, 6
    s_sub_u32 s76, 2048, s76
    v_lshl_add_u32 v233, v233, 4, s76
    s_movk_i32 s76, 3584
    v_mad_u32_u24 v15, v232, s76, v233
    s_add_u32 s74, s74, 1024
    s_add_u32 s77, s74, 1024
    s_waitcnt lgkmcnt(0)
    s_add_u32 s28, s8, s75
    s_addc_u32 s29, s9, 0
    s_sub_u32 s30, 0x200000, s75
    s_mov_b32 s31, 0x20000
    s_add_u32 m0, s73, 0
    s_xor_b32 s76, s79, 0
    buffer_load_dwordx4 v228, s[28:31], s76 offen offset:0 lds
    buffer_load_dwordx4 v229, s[28:31], s76 offen offset:1024 lds
    buffer_load_dwordx4 v230, s[28:31], s76 offen offset:2048 lds
    buffer_load_dwordx4 v231, s[28:31], s76 offen offset:3072 lds
    s_add_u32 s32, s10, s74
    s_addc_u32 s33, s11, 0
    s_sub_u32 s34, 0x180000, s74
    s_mov_b32 s35, 0x20000
    s_add_u32 s36, s10, s77
    s_addc_u32 s37, s11, 0
    s_sub_u32 s38, 0x180000, s77
    s_mov_b32 s39, 0x20000
    s_and_b32 s76, s51, 31
    v_and_b32 v237, 15, v0
    v_lshl_add_u32 v237, s76, 4, v237
    v_mul_u32_u24 v237, 3584, v237
    s_add_u32 m0, s73, 16384
    s_nop 0
    buffer_load_dwordx4 v3, s[32:35], s56 offen lds
    buffer_load_dwordx4 v4, s[32:35], s56 offen offset:1024 lds
    s_add_u32 m0, s73, 18432
    s_nop 0
    buffer_load_dwordx4 v3, s[36:39], s56 offen lds
    buffer_load_dwordx4 v4, s[36:39], s56 offen offset:1024 lds
    s_add_u32 s40, s16, s74
    s_addc_u32 s41, s17, 0
    s_sub_u32 s42, 0x1c0000, s74
    s_mov_b32 s43, 0x20000
    s_add_u32 s44, s18, s74
    s_addc_u32 s45, s19, 0
    s_sub_u32 s46, 0x1c0000, s74
    s_mov_b32 s47, 0x20000
    s_add_u32 m0, s73, 20480
    s_nop 0
    buffer_load_dwordx4 v15, s[40:43], s64 offen lds
    s_add_u32 m0, s73, 21504
    s_nop 0
    buffer_load_dwordx4 v15, s[44:47], s64 offen lds
    s_add_u32 m0, s73, 4096
    s_xor_b32 s76, s79, 128
    buffer_load_dwordx4 v228, s[28:31], s76 offen offset:0 lds
    buffer_load_dwordx4 v229, s[28:31], s76 offen offset:1024 lds
    buffer_load_dwordx4 v230, s[28:31], s76 offen offset:2048 lds
    buffer_load_dwordx4 v231, s[28:31], s76 offen offset:3072 lds
    s_mov_b32 s52, s26
    s_mov_b32 s53, s27
    s_mov_b32 s54, 0x10000000
    s_mov_b32 s55, 0x20000
    s_mov_b32 s26, 256
    s_mov_b32 s27, 0x20000
    s_or_b32 s76, s2, s72
    s_cbranch_scc1 noep_6
    s_memrealtime s[76:77]
    s_waitcnt lgkmcnt(0)
    s_or_b32 s76, s76, 1
    v_mov_b32 v28, s76
    v_mov_b32 v29, s77
    s_mov_b64 exec, 1
    buffer_store_dwordx2 v[28:29], off, s[24:27], 0 sc1
    s_mov_b64 exec, -1
noep_6:
    v_and_b32 v232, 31, v0
    v_lshlrev_b32 v232, 7, v232
    v_add_u32 v232, s73, v232
    v_bfe_u32 v233, v0, 1, 3
    v_lshrrev_b32 v234, 5, v0
    s_lshl_b32 s74, s72, 1
    v_xor_b32 v233, v233, v234
    v_xor_b32 v233, s74, v233
    v_xor_b32 v235, 0, v233
    v_lshl_add_u32 v224, v235, 4, v232
    v_xor_b32 v235, 2, v233
    v_lshl_add_u32 v225, v235, 4, v232
    v_xor_b32 v235, 4, v233
    v_lshl_add_u32 v226, v235, 4, v232
    v_xor_b32 v235, 6, v233
    v_lshl_add_u32 v227, v235, 4, v232
    v_mov_b32 v16, 0
    v_mov_b32 v17, 0
    v_mov_b32 v18, 0
    v_mov_b32 v19, 0
    v_lshlrev_b32 v232, 10, v234
    v_bfe_u32 v233, v0, 2, 2
    v_lshl_add_u32 v232, v233, 7, v232
    v_bfe_u32 v233, v0, 3, 1
    v_lshl_add_u32 v232, v233, 6, v232
    v_bfe_u32 v233, v0, 4, 1
    v_lshl_add_u32 v232, v233, 5, v232
    v_and_b32 v233, 3, v0
    v_lshl_add_u32 v232, v233, 3, v232
    v_lshlrev_b32 v234, 9, v234
    v_lshl_add_u32 v234, v233, 3, v234
    v_bfe_u32 v233, v0, 2, 2
    v_lshl_add_u32 v234, v233, 6, v234
    v_bfe_u32 v233, v0, 4, 1
    v_lshl_add_u32 v234, v233, 5, v234
    v_xor_b32 v233, 64, v232
    s_xor_b32 s74, s72, 0
    s_mul_i32 s74, s74, 40960
    v_add_u32 v7, s74, v232
    v_add_u32 v8, s74, v233
    v_add_u32 v250, s74, v234
    s_xor_b32 s74, s72, 1
    s_mul_i32 s74, s74, 40960
    v_add_u32 v9, s74, v232
    v_add_u32 v10, s74, v233
    v_add_u32 v251, s74, v234
    s_xor_b32 s74, s72, 2
    s_mul_i32 s74, s74, 40960
    v_add_u32 v11, s74, v232
    v_add_u32 v12, s74, v233
    v_add_u32 v252, s74, v234
    s_xor_b32 s74, s72, 3
    s_mul_i32 s74, s74, 40960
    v_add_u32 v13, s74, v232
    v_add_u32 v14, s74, v233
    v_add_u32 v253, s74, v234
    v_mov_b32 v232, 0x3f803f80
    s_mov_b32 vcc_lo, 0x30003
    s_mov_b32 vcc_hi, 0x3000300
    v_cndmask_b32 v233, 0, v232, vcc
    s_lshl_b64 vcc, vcc, 4
    v_cndmask_b32 v234, 0, v232, vcc
    v_and_b32 v232, 1, v0
    v_mul_u32_u24 v232, 0xaaaa, v232
    v_add_u32 v30, 0x4444, v232
    v_accvgpr_write_b32 a224, v233
    v_accvgpr_write_b32 a225, v233
    v_accvgpr_write_b32 a226, v234
    v_accvgpr_write_b32 a227, v234
    v_accvgpr_write_b32 a212, 0
    v_accvgpr_write_b32 a213, 0
    v_accvgpr_write_b32 a214, 0
    v_accvgpr_write_b32 a215, 0
    v_accvgpr_write_b32 a192, 0
    v_accvgpr_write_b32 a193, 0
    v_accvgpr_write_b32 a194, 0
    v_accvgpr_write_b32 a195, 0
    v_accvgpr_write_b32 a196, 0
    v_accvgpr_write_b32 a197, 0
    v_accvgpr_write_b32 a198, 0
    v_accvgpr_write_b32 a199, 0
    v_accvgpr_write_b32 a200, 0
    v_accvgpr_write_b32 a201, 0
    v_accvgpr_write_b32 a202, 0
    v_accvgpr_write_b32 a203, 0
    v_accvgpr_write_b32 a204, 0
    v_accvgpr_write_b32 a205, 0
    v_accvgpr_write_b32 a206, 0
    v_accvgpr_write_b32 a207, 0
    v_accvgpr_write_b32 a208, 0
    v_accvgpr_write_b32 a209, 0
    v_accvgpr_write_b32 a210, 0
    v_accvgpr_write_b32 a211, 0
    v_mov_b32 v235, 0x3f803f80
    v_accvgpr_write_b32 a68, v235
    v_accvgpr_mov_b32 a69, a68
    v_accvgpr_mov_b32 a70, a68
    v_accvgpr_mov_b32 a71, a68
    v_accvgpr_mov_b32 a72, a68
    v_accvgpr_mov_b32 a73, a68
    v_accvgpr_mov_b32 a74, a68
    v_accvgpr_mov_b32 a75, a68
    v_accvgpr_mov_b32 a80, a68
    v_accvgpr_mov_b32 a81, a68
    v_accvgpr_mov_b32 a82, a68
    v_accvgpr_mov_b32 a83, a68
    v_accvgpr_mov_b32 a84, a68
    v_accvgpr_mov_b32 a85, a68
    v_accvgpr_mov_b32 a86, a68
    v_accvgpr_mov_b32 a87, a68
    v_accvgpr_mov_b32 a92, a68
    v_accvgpr_mov_b32 a93, a68
    v_accvgpr_mov_b32 a94, a68
    v_accvgpr_mov_b32 a95, a68
    v_accvgpr_mov_b32 a96, a68
    v_accvgpr_mov_b32 a97, a68
    v_accvgpr_mov_b32 a98, a68
    v_accvgpr_mov_b32 a99, a68
    v_accvgpr_mov_b32 a104, a68
    v_accvgpr_mov_b32 a105, a68
    v_accvgpr_mov_b32 a106, a68
    v_accvgpr_mov_b32 a107, a68
    v_accvgpr_mov_b32 a108, a68
    v_accvgpr_mov_b32 a109, a68
    v_accvgpr_mov_b32 a110, a68
    v_accvgpr_mov_b32 a111, a68
    v_accvgpr_mov_b32 a116, a68
    v_accvgpr_mov_b32 a117, a68
    v_accvgpr_mov_b32 a118, a68
    v_accvgpr_mov_b32 a119, a68
    v_accvgpr_mov_b32 a120, a68
    v_accvgpr_mov_b32 a121, a68
    v_accvgpr_mov_b32 a122, a68
    v_accvgpr_mov_b32 a123, a68
    v_accvgpr_mov_b32 a128, a68
    v_accvgpr_mov_b32 a129, a68
    v_accvgpr_mov_b32 a130, a68
    v_accvgpr_mov_b32 a131, a68
    v_accvgpr_mov_b32 a132, a68
    v_accvgpr_mov_b32 a133, a68
    v_accvgpr_mov_b32 a134, a68
    v_accvgpr_mov_b32 a135, a68
    v_accvgpr_mov_b32 a140, a68
    v_accvgpr_mov_b32 a141, a68
    v_accvgpr_mov_b32 a142, a68
    s_add_u32 m0, s73, 22528
    s_nop 0
    buffer_load_dwordx4 v3, s[32:35], s57 offen lds
    buffer_load_dwordx4 v4, s[32:35], s57 offen offset:1024 lds
    s_waitcnt vmcnt(12)
    ds_read_b128 v[32:35], v224 offset:0
    ds_read_b128 v[36:39], v225 offset:0
    ds_read_b128 v[40:43], v226 offset:0
    ds_read_b128 v[44:47], v227 offset:0
    s_waitcnt lgkmcnt(0)
    v_dot2_f32_bf16 v16, v32, v32, v16
    v_dot2_f32_bf16 v17, v33, v33, v17
    v_dot2_f32_bf16 v18, v34, v34, v18
    v_dot2_f32_bf16 v19, v35, v35, v19
    v_dot2_f32_bf16 v16, v36, v36, v16
    v_dot2_f32_bf16 v17, v37, v37, v17
    v_dot2_f32_bf16 v18, v38, v38, v18
    v_dot2_f32_bf16 v19, v39, v39, v19
    v_dot2_f32_bf16 v16, v40, v40, v16
    v_dot2_f32_bf16 v17, v41, v41, v17
    v_dot2_f32_bf16 v18, v42, v42, v18
    v_dot2_f32_bf16 v19, v43, v43, v19
    v_dot2_f32_bf16 v16, v44, v44, v16
    v_dot2_f32_bf16 v17, v45, v45, v17
    v_dot2_f32_bf16 v18, v46, v46, v18
    v_dot2_f32_bf16 v19, v47, v47, v19
    v_smfmac_f32_16x16x64_bf16 a[212:215], a[224:227], v[32:39], v30
    v_smfmac_f32_16x16x64_bf16 a[212:215], a[224:227], v[40:47], v30
    s_waitcnt vmcnt(8)
    s_barrier
    ds_read_b64_tr_b16 a[0:1], v7 offset:16384
    ds_read_b64_tr_b16 a[2:3], v7 offset:16896
    ds_read_b64_tr_b16 a[4:5], v8 offset:16384
    ds_read_b64_tr_b16 a[6:7], v8 offset:16896
    ds_read_b64_tr_b16 a[8:9], v7 offset:18432
    ds_read_b64_tr_b16 a[10:11], v7 offset:18944
    ds_read_b64_tr_b16 a[12:13], v8 offset:18432
    ds_read_b64_tr_b16 a[14:15], v8 offset:18944
    ds_read_b64_tr_b16 a[16:17], v9 offset:16384
    ds_read_b64_tr_b16 a[18:19], v9 offset:16896
    ds_read_b64_tr_b16 a[20:21], v10 offset:16384
    ds_read_b64_tr_b16 a[22:23], v10 offset:16896
    s_waitcnt lgkmcnt(8)
    v_mfma_f32_32x32x16_bf16 v[160:175], a[0:3], v[32:35], 0
    ds_read_b64_tr_b16 a[24:25], v9 offset:18432
    ds_read_b64_tr_b16 a[26:27], v9 offset:18944
    s_add_u32 m0, s73, 24576
    s_xor_b32 s66, s79, 256
    s_mul_i32 s58, s66, 1536
    v_mfma_f32_32x32x16_bf16 v[176:191], a[4:7], v[32:35], 0
    ds_read_b64_tr_b16 a[28:29], v10 offset:18432
    ds_read_b64_tr_b16 a[30:31], v10 offset:18944
    buffer_load_dwordx4 v3, s[36:39], s57 offen lds
    s_mul_i32 s66, s66, 1792
    s_xor_b32 s67, s79, 384
    v_smfmac_f32_16x16x64_bf16 a[192:195], a[224:227], a[0:7], v30
    s_waitcnt lgkmcnt(8)
    v_mfma_f32_32x32x16_bf16 a[32:47], v[32:35], a[8:11], 0
    ds_read_b64_tr_b16 a[0:1], v11 offset:16384
    ds_read_b64_tr_b16 a[2:3], v11 offset:16896
    buffer_load_dwordx4 v4, s[36:39], s57 offen offset:1024 lds
    s_add_u32 m0, s73, 26624
    s_mul_i32 s59, s67, 1536
    v_mfma_f32_32x32x16_bf16 a[48:63], v[32:35], a[12:15], 0
    ds_read_b64_tr_b16 a[4:5], v12 offset:16384
    ds_read_b64_tr_b16 a[6:7], v12 offset:16896
    s_mul_i32 s67, s67, 1792
    s_xor_b32 s68, s79, 512
    s_mul_i32 s60, s68, 1536
    v_smfmac_f32_16x16x64_bf16 a[196:199], a[224:227], a[8:15], v30
    s_waitcnt lgkmcnt(8)
    v_mfma_f32_32x32x16_bf16 v[160:175], a[16:19], v[36:39], v[160:175]
    ds_read_b64_tr_b16 a[8:9], v11 offset:18432
    ds_read_b64_tr_b16 a[10:11], v11 offset:18944
    buffer_load_dwordx4 v15, s[40:43], s65 offen lds
    s_add_u32 m0, s73, 27648
    s_mul_i32 s68, s68, 1792
    v_mfma_f32_32x32x16_bf16 v[176:191], a[20:23], v[36:39], v[176:191]
    ds_read_b64_tr_b16 a[12:13], v12 offset:18432
    ds_read_b64_tr_b16 a[14:15], v12 offset:18944
    buffer_load_dwordx4 v15, s[44:47], s65 offen lds
    s_add_u32 m0, s73, 8192
    s_xor_b32 s76, s79, 256
    s_waitcnt lgkmcnt(8)
    v_mfma_f32_32x32x16_bf16 a[32:47], v[36:39], a[24:27], a[32:47]
    ds_read_b64_tr_b16 a[16:17], v13 offset:16384
    ds_read_b64_tr_b16 a[18:19], v13 offset:16896
    s_and_b32 s74, s2, 1
    s_lshl_b32 s74, s74, 8
    s_add_u32 s74, s74, 512
    v_mfma_f32_32x32x16_bf16 a[48:63], v[36:39], a[28:31], a[48:63]
    ds_read_b64_tr_b16 a[20:21], v14 offset:16384
    ds_read_b64_tr_b16 a[22:23], v14 offset:16896
    buffer_load_dwordx4 v228, s[28:31], s76 offen offset:0 lds
    s_add_u32 s4, s20, s74
    s_addc_u32 s5, s21, 0
    s_waitcnt lgkmcnt(8)
    v_mfma_f32_32x32x16_bf16 v[160:175], a[0:3], v[40:43], v[160:175]
    ds_read_b64_tr_b16 a[24:25], v13 offset:18432
    ds_read_b64_tr_b16 a[26:27], v13 offset:18944
    s_sub_u32 s6, 0x1c0000, s74
    s_mov_b32 s7, 0x20000
    v_mfma_f32_32x32x16_bf16 v[176:191], a[4:7], v[40:43], v[176:191]
    ds_read_b64_tr_b16 a[28:29], v14 offset:18432
    ds_read_b64_tr_b16 a[30:31], v14 offset:18944
    buffer_load_dwordx4 v229, s[28:31], s76 offen offset:1024 lds
    s_add_u32 s12, s12, s74
    s_addc_u32 s13, s13, 0
    s_waitcnt lgkmcnt(8)
    v_mfma_f32_32x32x16_bf16 a[32:47], v[40:43], a[8:11], a[32:47]
    s_waitcnt vmcnt(6)
    s_barrier
    ds_read_b64_tr_b16 a[0:1], v250 offset:20480
    ds_read_b64_tr_b16 a[2:3], v250 offset:20736
    buffer_load_dwordx4 v230, s[28:31], s76 offen offset:2048 lds
    v_mfma_f32_32x32x16_bf16 a[48:63], v[40:43], a[12:15], a[48:63]
    ds_read_b64_tr_b16 a[4:5], v250 offset:21504
    ds_read_b64_tr_b16 a[6:7], v250 offset:21760
    ds_read_b128 v[48:51], v224 offset:4096
    s_sub_u32 s14, 0x80000, s74
    s_waitcnt lgkmcnt(9)
    v_mfma_f32_32x32x16_bf16 v[160:175], a[16:19], v[44:47], v[160:175]
    ds_read_b64_tr_b16 a[8:9], v251 offset:20480
    ds_read_b64_tr_b16 a[10:11], v251 offset:20736
    buffer_load_dwordx4 v231, s[28:31], s76 offen offset:3072 lds
    ds_read_b128 v[52:55], v225 offset:4096
    v_mfma_f32_32x32x16_bf16 v[176:191], a[20:23], v[44:47], v[176:191]
    ds_read_b64_tr_b16 a[12:13], v251 offset:21504
    ds_read_b64_tr_b16 a[14:15], v251 offset:21760
    buffer_load_dword v26, v237, s[40:43], 0 offen
    ds_read_b128 v[56:59], v226 offset:4096
    s_waitcnt lgkmcnt(11)
    v_mfma_f32_32x32x16_bf16 a[32:47], v[44:47], a[24:27], a[32:47]
    ds_read_b64_tr_b16 a[16:17], v252 offset:20480
    ds_read_b64_tr_b16 a[18:19], v252 offset:20736
    ds_read_b128 v[60:63], v227 offset:4096
    s_mov_b32 s15, 0x20000
    v_mfma_f32_32x32x16_bf16 a[48:63], v[44:47], a[28:31], a[48:63]
    ds_read_b64_tr_b16 a[20:21], v252 offset:21504
    ds_read_b64_tr_b16 a[22:23], v252 offset:21760
    buffer_load_dword v26, v237, s[44:47], 0 offen
    s_add_u32 m0, s73, 28672
    s_waitcnt lgkmcnt(12)
    v_mfma_f32_32x32x16_bf16 v[192:207], a[0:3], v[32:35], 0
    ds_read_b64_tr_b16 a[24:25], v253 offset:20480
    ds_read_b64_tr_b16 a[26:27], v253 offset:20736
    s_bitcmp1_b32 s2, 3
    s_cselect_b32 s75, 0x80, 0
    s_xor_b32 s75, s75, s2
    v_mfma_f32_32x32x16_bf16 v[208:223], a[4:7], v[32:35], 0
    ds_read_b64_tr_b16 a[28:29], v253 offset:21504
    ds_read_b64_tr_b16 a[30:31], v253 offset:21760
    buffer_load_dwordx4 v3, s[32:35], s58 offen lds
    s_and_b32 s75, s75, 0xc0
    s_add_u32 s74, s74, s75
    v_smfmac_f32_16x16x64_bf16 a[200:203], a[224:227], a[0:7], v30
    s_waitcnt lgkmcnt(10)
    v_mfma_f32_32x32x16_bf16 v[192:207], a[8:11], v[36:39], v[192:207]
    ds_read_b64_tr_b16 a[0:1], v7 offset:22528
    ds_read_b64_tr_b16 a[2:3], v7 offset:23040
    buffer_load_dwordx4 v4, s[32:35], s58 offen offset:1024 lds
    s_add_u32 m0, s73, 30720
    s_lshl_b32 s75, s51, 15
    v_mfma_f32_32x32x16_bf16 v[208:223], a[12:15], v[36:39], v[208:223]
    ds_read_b64_tr_b16 a[4:5], v8 offset:22528
    ds_read_b64_tr_b16 a[6:7], v8 offset:23040
    s_add_u32 s75, s75, s74
    s_add_u32 s20, s22, s75
    s_addc_u32 s21, s23, 0
    s_waitcnt lgkmcnt(8)
    v_mfma_f32_32x32x16_bf16 v[192:207], a[16:19], v[40:43], v[192:207]
    ds_read_b64_tr_b16 a[8:9], v9 offset:22528
    ds_read_b64_tr_b16 a[10:11], v9 offset:23040
    buffer_load_dwordx4 v3, s[36:39], s58 offen lds
    s_sub_u32 s22, 0x200000, s75
    s_mov_b32 s23, 0x20000
    v_mfma_f32_32x32x16_bf16 v[208:223], a[20:23], v[40:43], v[208:223]
    ds_read_b64_tr_b16 a[12:13], v10 offset:22528
    ds_read_b64_tr_b16 a[14:15], v10 offset:23040
    buffer_load_dwordx4 v4, s[36:39], s58 offen offset:1024 lds
    s_add_u32 m0, s73, 32768
    s_waitcnt lgkmcnt(8)
    v_mfma_f32_32x32x16_bf16 v[192:207], a[24:27], v[44:47], v[192:207]
    ds_read_b64_tr_b16 a[16:17], v11 offset:22528
    ds_read_b64_tr_b16 a[18:19], v11 offset:23040
    s_add_u32 s8, s8, s75
    s_addc_u32 s9, s9, 0
    s_sub_u32 s10, 0x200000, s75
    v_dot2_f32_bf16 v16, v48, v48, v16
    v_dot2_f32_bf16 v17, v49, v49, v17
    v_dot2_f32_bf16 v18, v50, v50, v18
    v_dot2_f32_bf16 v19, v51, v51, v19
    v_dot2_f32_bf16 v16, v52, v52, v16
    v_dot2_f32_bf16 v17, v53, v53, v17
    v_dot2_f32_bf16 v18, v54, v54, v18
    v_dot2_f32_bf16 v19, v55, v55, v19
    v_dot2_f32_bf16 v16, v56, v56, v16
    v_dot2_f32_bf16 v17, v57, v57, v17
    v_dot2_f32_bf16 v18, v58, v58, v18
    v_dot2_f32_bf16 v19, v59, v59, v19
    v_dot2_f32_bf16 v16, v60, v60, v16
    v_dot2_f32_bf16 v17, v61, v61, v17
    v_dot2_f32_bf16 v18, v62, v62, v18
    v_dot2_f32_bf16 v19, v63, v63, v19
    v_smfmac_f32_16x16x64_bf16 a[212:215], a[224:227], v[48:55], v30
    v_smfmac_f32_16x16x64_bf16 a[212:215], a[224:227], v[56:63], v30
    v_mfma_f32_32x32x16_bf16 v[208:223], a[28:31], v[44:47], v[208:223]
    ds_read_b64_tr_b16 a[20:21], v12 offset:22528
    ds_read_b64_tr_b16 a[22:23], v12 offset:23040
    buffer_load_dwordx4 v15, s[40:43], s66 offen lds
    s_add_u32 m0, s73, 33792
    s_mov_b32 s11, 0x20000
    s_waitcnt lgkmcnt(8)
    v_mfma_f32_32x32x16_bf16 v[160:175], a[0:3], v[48:51], v[160:175]
    ds_read_b64_tr_b16 a[24:25], v13 offset:22528
    ds_read_b64_tr_b16 a[26:27], v13 offset:23040
    s_and_b32 s75, s51, 31
    s_and_b32 s74, s2, 0xc0
    s_lshl1_add_u32 s74, s75, s74
    v_mfma_f32_32x32x16_bf16 v[176:191], a[4:7], v[48:51], v[176:191]
    ds_read_b64_tr_b16 a[28:29], v14 offset:22528
    ds_read_b64_tr_b16 a[30:31], v14 offset:23040
    buffer_load_dwordx4 v15, s[44:47], s66 offen lds
    s_add_u32 m0, s73, 12288
    s_xor_b32 s76, s79, 384
    v_smfmac_f32_16x16x64_bf16 a[192:195], a[224:227], a[0:7], v30
    s_waitcnt lgkmcnt(8)
    v_mfma_f32_32x32x16_bf16 v[160:175], a[8:11], v[52:55], v[160:175]
    s_waitcnt vmcnt(12)
    s_barrier
    ds_read_b64_tr_b16 a[0:1], v7 offset:24576
    ds_read_b64_tr_b16 a[2:3], v7 offset:25088
    buffer_load_dwordx4 v228, s[28:31], s76 offen offset:0 lds
    v_mfma_f32_32x32x16_bf16 v[176:191], a[12:15], v[52:55], v[176:191]
    ds_read_b64_tr_b16 a[4:5], v8 offset:24576
    ds_read_b64_tr_b16 a[6:7], v8 offset:25088
    v_bfe_u32 v236, v0, 1, 2
    v_bfe_u32 v234, v0, 3, 2
    v_lshl_add_u32 v236, s74, 1, v236
    s_waitcnt lgkmcnt(8)
    v_mfma_f32_32x32x16_bf16 v[160:175], a[16:19], v[56:59], v[160:175]
    ds_read_b64_tr_b16 a[8:9], v250 offset:26624
    ds_read_b64_tr_b16 a[10:11], v250 offset:26880
    buffer_load_dwordx4 v229, s[28:31], s76 offen offset:1024 lds
    v_add_u32 v232, 1, v234
    v_lshrrev_b32 v232, 2, v232
    v_mfma_f32_32x32x16_bf16 v[176:191], a[20:23], v[56:59], v[176:191]
    ds_read_b64_tr_b16 a[12:13], v250 offset:27648
    ds_read_b64_tr_b16 a[14:15], v250 offset:27904
    buffer_load_dwordx4 v230, s[28:31], s76 offen offset:2048 lds
    v_lshrrev_b32 v236, v232, v236
    v_lshl_add_u32 v236, v234, 9, v236
    s_waitcnt lgkmcnt(8)
    v_mfma_f32_32x32x16_bf16 v[160:175], a[24:27], v[60:63], v[160:175]
    ds_read_b64_tr_b16 a[16:17], v9 offset:24576
    ds_read_b64_tr_b16 a[18:19], v9 offset:25088
    v_and_b32 v234, 1, v0
    v_lshl_add_u32 v236, v236, 3, v234
    v_lshlrev_b32 v27, 7, v236
    v_mfma_f32_32x32x16_bf16 v[176:191], a[28:31], v[60:63], v[176:191]
    ds_read_b64_tr_b16 a[20:21], v10 offset:24576
    ds_read_b64_tr_b16 a[22:23], v10 offset:25088
    buffer_load_dwordx4 v231, s[28:31], s76 offen offset:3072 lds
    s_add_u32 m0, s73, 34816
    s_xor_b32 s69, s79, 640
    s_waitcnt lgkmcnt(8)
    v_mfma_f32_32x32x16_bf16 a[32:47], v[48:51], a[0:3], a[32:47]
    ds_read_b64_tr_b16 a[24:25], v251 offset:26624
    ds_read_b64_tr_b16 a[26:27], v251 offset:26880
    s_mul_i32 s61, s69, 1536
    s_mul_i32 s69, s69, 1792
    s_xor_b32 s70, s79, 768
    v_mfma_f32_32x32x16_bf16 a[48:63], v[48:51], a[4:7], a[48:63]
    ds_read_b64_tr_b16 a[28:29], v251 offset:27648
    ds_read_b64_tr_b16 a[30:31], v251 offset:27904
    buffer_load_dwordx4 v3, s[32:35], s59 offen lds
    s_waitcnt vmcnt(13)
    ds_read_b128 v[64:67], v224 offset:8192
    v_smfmac_f32_16x16x64_bf16 a[196:199], a[224:227], a[0:7], v30
    s_waitcnt lgkmcnt(9)
    v_mfma_f32_32x32x16_bf16 v[192:207], a[8:11], v[48:51], v[192:207]
    ds_read_b64_tr_b16 a[0:1], v11 offset:24576
    ds_read_b64_tr_b16 a[2:3], v11 offset:25088
    buffer_load_dwordx4 v4, s[32:35], s59 offen offset:1024 lds
    s_add_u32 m0, s73, 36864
    s_mul_i32 s62, s70, 1536
    v_mfma_f32_32x32x16_bf16 v[208:223], a[12:15], v[48:51], v[208:223]
    ds_read_b64_tr_b16 a[4:5], v12 offset:24576
    ds_read_b64_tr_b16 a[6:7], v12 offset:25088
    ds_read_b128 v[68:71], v225 offset:8192
    s_mul_i32 s70, s70, 1792
    v_smfmac_f32_16x16x64_bf16 a[200:203], a[224:227], a[8:15], v30
    s_waitcnt lgkmcnt(10)
    v_mfma_f32_32x32x16_bf16 a[32:47], v[52:55], a[16:19], a[32:47]
    ds_read_b64_tr_b16 a[8:9], v252 offset:26624
    ds_read_b64_tr_b16 a[10:11], v252 offset:26880
    buffer_load_dwordx4 v3, s[36:39], s59 offen lds
    ds_read_b128 v[72:75], v226 offset:8192
    v_mfma_f32_32x32x16_bf16 a[48:63], v[52:55], a[20:23], a[48:63]
    ds_read_b64_tr_b16 a[12:13], v252 offset:27648
    ds_read_b64_tr_b16 a[14:15], v252 offset:27904
    buffer_load_dwordx4 v4, s[36:39], s59 offen offset:1024 lds
    s_add_u32 m0, s73, 16384
    s_xor_b32 s71, s79, 896
    s_waitcnt lgkmcnt(11)
    v_mfma_f32_32x32x16_bf16 v[192:207], a[24:27], v[52:55], v[192:207]
    ds_read_b64_tr_b16 a[16:17], v13 offset:24576
    ds_read_b64_tr_b16 a[18:19], v13 offset:25088
    ds_read_b128 v[76:79], v227 offset:8192
    s_mul_i32 s63, s71, 1536
    v_mfma_f32_32x32x16_bf16 v[208:223], a[28:31], v[52:55], v[208:223]
    ds_read_b64_tr_b16 a[20:21], v14 offset:24576
    ds_read_b64_tr_b16 a[22:23], v14 offset:25088
    buffer_load_dwordx4 v15, s[40:43], s67 offen lds
    s_add_u32 m0, s73, 17408
    s_mul_i32 s71, s71, 1792
    s_waitcnt lgkmcnt(11)
    v_mfma_f32_32x32x16_bf16 a[32:47], v[56:59], a[0:3], a[32:47]
    ds_read_b64_tr_b16 a[24:25], v253 offset:26624
    ds_read_b64_tr_b16 a[26:27], v253 offset:26880
    v_add_u32 v25, 7168, v24
    s_mul_i32 s80, s51, 98304
    s_lshl_b32 s74, s3, 12
    v_mfma_f32_32x32x16_bf16 a[48:63], v[56:59], a[4:7], a[48:63]
    ds_read_b64_tr_b16 a[28:29], v253 offset:27648
    ds_read_b64_tr_b16 a[30:31], v253 offset:27904
    buffer_load_dwordx4 v15, s[44:47], s67 offen lds
    s_add_u32 m0, s73, 0
    s_xor_b32 s76, s79, 512
    s_waitcnt lgkmcnt(9)
    v_mfma_f32_32x32x16_bf16 v[192:207], a[8:11], v[56:59], v[192:207]
    s_waitcnt vmcnt(12)
    s_barrier
    ds_read_b64_tr_b16 a[0:1], v7 offset:28672
    ds_read_b64_tr_b16 a[2:3], v7 offset:29184
    buffer_load_dwordx4 v228, s[28:31], s76 offen offset:0 lds
    v_mfma_f32_32x32x16_bf16 v[208:223], a[12:15], v[56:59], v[208:223]
    ds_read_b64_tr_b16 a[4:5], v8 offset:28672
    ds_read_b64_tr_b16 a[6:7], v8 offset:29184
    s_add_u32 s80, s80, s74
    s_add_u32 s50, s80, 0x10000
    s_add_u32 s80, s80, 0x8000
    s_waitcnt lgkmcnt(8)
    v_mfma_f32_32x32x16_bf16 a[32:47], v[60:63], a[16:19], a[32:47]
    ds_read_b64_tr_b16 a[8:9], v7 offset:30720
    ds_read_b64_tr_b16 a[10:11], v7 offset:31232
    buffer_load_dwordx4 v229, s[28:31], s76 offen offset:1024 lds
    s_mul_i32 s82, s51, 163840
    s_add_u32 s81, s82, s74
    v_dot2_f32_bf16 v16, v64, v64, v16
    v_dot2_f32_bf16 v17, v65, v65, v17
    v_dot2_f32_bf16 v18, v66, v66, v18
    v_dot2_f32_bf16 v19, v67, v67, v19
    v_dot2_f32_bf16 v16, v68, v68, v16
    v_dot2_f32_bf16 v17, v69, v69, v17
    v_dot2_f32_bf16 v18, v70, v70, v18
    v_dot2_f32_bf16 v19, v71, v71, v19
    v_dot2_f32_bf16 v16, v72, v72, v16
    v_dot2_f32_bf16 v17, v73, v73, v17
    v_dot2_f32_bf16 v18, v74, v74, v18
    v_dot2_f32_bf16 v19, v75, v75, v19
    v_dot2_f32_bf16 v16, v76, v76, v16
    v_dot2_f32_bf16 v17, v77, v77, v17
    v_dot2_f32_bf16 v18, v78, v78, v18
    v_dot2_f32_bf16 v19, v79, v79, v19
    v_smfmac_f32_16x16x64_bf16 a[212:215], a[224:227], v[64:71], v30
    v_smfmac_f32_16x16x64_bf16 a[212:215], a[224:227], v[72:79], v30
    v_mfma_f32_32x32x16_bf16 a[48:63], v[60:63], a[20:23], a[48:63]
    ds_read_b64_tr_b16 a[12:13], v8 offset:30720
    ds_read_b64_tr_b16 a[14:15], v8 offset:31232
    buffer_load_dwordx4 v230, s[28:31], s76 offen offset:2048 lds
    s_add_u32 s81, s81, 0x808000
    s_lshl_b32 s75, s3, 11
    s_waitcnt lgkmcnt(8)
    v_mfma_f32_32x32x16_bf16 v[192:207], a[24:27], v[60:63], v[192:207]
    ds_read_b64_tr_b16 a[16:17], v9 offset:28672
    ds_read_b64_tr_b16 a[18:19], v9 offset:29184
    s_add_u32 s82, s82, s75
    s_add_u32 s82, s82, 0x818000
    v_lshlrev_b32 v1, 4, v0
    v_mfma_f32_32x32x16_bf16 v[208:223], a[28:31], v[60:63], v[208:223]
    ds_read_b64_tr_b16 a[20:21], v10 offset:28672
    ds_read_b64_tr_b16 a[22:23], v10 offset:29184
    buffer_load_dwordx4 v231, s[28:31], s76 offen offset:3072 lds
    v_add_u32 v22, 0x8000, v1
    v_lshrrev_b32 v232, 5, v0
    s_waitcnt lgkmcnt(8)
    v_mfma_f32_32x32x16_bf16 v[160:175], a[0:3], v[64:67], v[160:175]
    ds_read_b64_tr_b16 a[24:25], v9 offset:30720
    ds_read_b64_tr_b16 a[26:27], v9 offset:31232
    v_and_b32 v233, 15, v0
    v_lshlrev_b32 v233, 4, v233
    v_lshl_add_u32 v233, v232, 8, v233
    v_mfma_f32_32x32x16_bf16 v[176:191], a[4:7], v[64:67], v[176:191]
    ds_read_b64_tr_b16 a[28:29], v10 offset:30720
    ds_read_b64_tr_b16 a[30:31], v10 offset:31232
    buffer_load_dword v26, v27, s[4:7], 0 offen
    s_add_u32 m0, s73, 18432
    v_add_u32 v23, 0x10000, v233
    v_smfmac_f32_16x16x64_bf16 a[192:195], a[224:227], a[0:7], v30
    s_waitcnt lgkmcnt(8)
    v_mfma_f32_32x32x16_bf16 a[32:47], v[64:67], a[8:11], a[32:47]
    ds_read_b64_tr_b16 a[0:1], v11 offset:28672
    ds_read_b64_tr_b16 a[2:3], v11 offset:29184
    buffer_load_dwordx4 v3, s[32:35], s60 offen lds
    v_bfe_u32 v232, v0, 4, 1
    v_lshl_add_u32 v2, v232, 10, v233
    v_mfma_f32_32x32x16_bf16 a[48:63], v[64:67], a[12:15], a[48:63]
    ds_read_b64_tr_b16 a[4:5], v12 offset:28672
    ds_read_b64_tr_b16 a[6:7], v12 offset:29184
    s_lshr_b32 s100, s51, 2
    s_lshl1_add_u32 s100, s100, 1
    s_lshl_b32 s17, s3, 12
    v_smfmac_f32_16x16x64_bf16 a[196:199], a[224:227], a[8:15], v30
    s_waitcnt lgkmcnt(8)
    v_mfma_f32_32x32x16_bf16 v[160:175], a[16:19], v[68:71], v[160:175]
    ds_read_b64_tr_b16 a[8:9], v11 offset:30720
    ds_read_b64_tr_b16 a[10:11], v11 offset:31232
    buffer_load_dwordx4 v4, s[32:35], s60 offen offset:1024 lds
    s_add_u32 m0, s73, 20480
    s_or_b32 s16, s17, 0x8000
    v_mfma_f32_32x32x16_bf16 v[176:191], a[20:23], v[68:71], v[176:191]
    ds_read_b64_tr_b16 a[12:13], v12 offset:30720
    ds_read_b64_tr_b16 a[14:15], v12 offset:31232
    buffer_load_dwordx4 v3, s[36:39], s60 offen lds
    s_and_b32 s74, s2, 0xc0
    s_lshl_b32 s18, s74, 6
    s_waitcnt lgkmcnt(8)
    v_mfma_f32_32x32x16_bf16 a[32:47], v[68:71], a[24:27], a[32:47]
    ds_read_b64_tr_b16 a[16:17], v13 offset:28672
    ds_read_b64_tr_b16 a[18:19], v13 offset:29184
    s_lshl_b32 s74, s2, 4
    s_xor_b32 s74, s74, s2
    s_and_b32 s74, s74, 0x80
    v_mfma_f32_32x32x16_bf16 a[48:63], v[68:71], a[28:31], a[48:63]
    ds_read_b64_tr_b16 a[20:21], v14 offset:28672
    ds_read_b64_tr_b16 a[22:23], v14 offset:29184
    buffer_load_dwordx4 v4, s[36:39], s60 offen offset:1024 lds
    s_add_u32 m0, s73, 4096
    s_xor_b32 s76, s79, 640
    s_waitcnt lgkmcnt(8)
    v_mfma_f32_32x32x16_bf16 v[160:175], a[0:3], v[72:75], v[160:175]
    ds_read_b64_tr_b16 a[24:25], v13 offset:30720
    ds_read_b64_tr_b16 a[26:27], v13 offset:31232
    s_waitcnt vmcnt(15)
    ds_read_b128 v[80:83], v224 offset:12288
    v_mfma_f32_32x32x16_bf16 v[176:191], a[4:7], v[72:75], v[176:191]
    ds_read_b64_tr_b16 a[28:29], v14 offset:30720
    ds_read_b64_tr_b16 a[30:31], v14 offset:31232
    buffer_load_dwordx4 v228, s[28:31], s76 offen offset:0 lds
    ds_read_b128 v[84:87], v225 offset:12288
    s_waitcnt lgkmcnt(10)
    v_mfma_f32_32x32x16_bf16 a[32:47], v[72:75], a[8:11], a[32:47]
    s_waitcnt vmcnt(14)
    s_barrier
    ds_read_b64_tr_b16 a[0:1], v250 offset:32768
    ds_read_b64_tr_b16 a[2:3], v250 offset:33024
    buffer_load_dwordx4 v229, s[28:31], s76 offen offset:1024 lds
    v_mfma_f32_32x32x16_bf16 a[48:63], v[72:75], a[12:15], a[48:63]
    ds_read_b64_tr_b16 a[4:5], v250 offset:33792
    ds_read_b64_tr_b16 a[6:7], v250 offset:34048
    ds_read_b128 v[88:91], v226 offset:12288
    s_lshl_b32 s75, s72, 14
    s_waitcnt lgkmcnt(11)
    v_mfma_f32_32x32x16_bf16 v[160:175], a[16:19], v[76:79], v[160:175]
    ds_read_b64_tr_b16 a[8:9], v251 offset:32768
    ds_read_b64_tr_b16 a[10:11], v251 offset:33024
    buffer_load_dwordx4 v230, s[28:31], s76 offen offset:2048 lds
    ds_read_b128 v[92:95], v227 offset:12288
    v_mfma_f32_32x32x16_bf16 v[176:191], a[20:23], v[76:79], v[176:191]
    ds_read_b64_tr_b16 a[12:13], v251 offset:33792
    ds_read_b64_tr_b16 a[14:15], v251 offset:34048
    buffer_load_dwordx4 v231, s[28:31], s76 offen offset:3072 lds
    s_add_u32 m0, s73, 22528
    s_or_b32 s74, s74, s75
    s_waitcnt lgkmcnt(11)
    v_mfma_f32_32x32x16_bf16 a[32:47], v[76:79], a[24:27], a[32:47]
    ds_read_b64_tr_b16 a[16:17], v252 offset:32768
    ds_read_b64_tr_b16 a[18:19], v252 offset:33024
    s_lshl4_add_u32 s19, s16, s74
    s_lshl4_add_u32 s48, s17, s74
    s_lshl4_add_u32 s49, s18, s74
    v_mfma_f32_32x32x16_bf16 a[48:63], v[76:79], a[28:31], a[48:63]
    ds_read_b64_tr_b16 a[20:21], v252 offset:33792
    ds_read_b64_tr_b16 a[22:23], v252 offset:34048
    buffer_load_dwordx4 v3, s[32:35], s61 offen lds
    s_lshl_b32 s0, s51, 4
    s_add_u32 s0, s0, s3
    s_waitcnt lgkmcnt(10)
    v_mfma_f32_32x32x16_bf16 v[192:207], a[0:3], v[64:67], v[192:207]
    ds_read_b64_tr_b16 a[24:25], v253 offset:32768
    ds_read_b64_tr_b16 a[26:27], v253 offset:33024
    s_add_u32 s0, s0, 8
    s_lshl_b32 s0, s0, 7
    v_min_u32 v232, 9, v0
    v_mfma_f32_32x32x16_bf16 v[208:223], a[4:7], v[64:67], v[208:223]
    ds_read_b64_tr_b16 a[28:29], v253 offset:33792
    ds_read_b64_tr_b16 a[30:31], v253 offset:34048
    buffer_load_dwordx4 v4, s[32:35], s61 offen offset:1024 lds
    s_add_u32 m0, s73, 24576
    v_and_b32 v233, 1, v0
    v_smfmac_f32_16x16x64_bf16 a[200:203], a[224:227], a[0:7], v30
    s_waitcnt lgkmcnt(8)
    v_mfma_f32_32x32x16_bf16 v[192:207], a[8:11], v[68:71], v[192:207]
    ds_read_b64_tr_b16 a[0:1], v7 offset:34816
    ds_read_b64_tr_b16 a[2:3], v7 offset:35328
    buffer_load_dwordx4 v3, s[36:39], s61 offen lds
    v_or_b32 v234, 8, v233
    v_cmp_gt_u32 vcc, 16, v0
    v_dot2_f32_bf16 v16, v80, v80, v16
    v_dot2_f32_bf16 v17, v81, v81, v17
    v_dot2_f32_bf16 v18, v82, v82, v18
    v_dot2_f32_bf16 v19, v83, v83, v19
    v_dot2_f32_bf16 v16, v84, v84, v16
    v_dot2_f32_bf16 v17, v85, v85, v17
    v_dot2_f32_bf16 v18, v86, v86, v18
    v_dot2_f32_bf16 v19, v87, v87, v19
    v_dot2_f32_bf16 v16, v88, v88, v16
    v_dot2_f32_bf16 v17, v89, v89, v17
    v_dot2_f32_bf16 v18, v90, v90, v18
    v_dot2_f32_bf16 v19, v91, v91, v19
    v_dot2_f32_bf16 v16, v92, v92, v16
    v_dot2_f32_bf16 v17, v93, v93, v17
    v_dot2_f32_bf16 v18, v94, v94, v18
    v_dot2_f32_bf16 v19, v95, v95, v19
    v_smfmac_f32_16x16x64_bf16 a[212:215], a[224:227], v[80:87], v30
    v_smfmac_f32_16x16x64_bf16 a[212:215], a[224:227], v[88:95], v30
    v_mfma_f32_32x32x16_bf16 v[208:223], a[12:15], v[68:71], v[208:223]
    ds_read_b64_tr_b16 a[4:5], v8 offset:34816
    ds_read_b64_tr_b16 a[6:7], v8 offset:35328
    s_lshl_b32 s75, s100, 1
    s_sub_u32 s75, s75, 8
    v_cndmask_b32 v232, v234, v232, vcc
    s_waitcnt lgkmcnt(8)
    v_mfma_f32_32x32x16_bf16 v[192:207], a[16:19], v[72:75], v[192:207]
    ds_read_b64_tr_b16 a[8:9], v9 offset:34816
    ds_read_b64_tr_b16 a[10:11], v9 offset:35328
    buffer_load_dwordx4 v4, s[36:39], s61 offen offset:1024 lds
    s_add_u32 m0, s73, 8192
    s_xor_b32 s76, s79, 768
    v_mfma_f32_32x32x16_bf16 v[208:223], a[20:23], v[72:75], v[208:223]
    ds_read_b64_tr_b16 a[12:13], v10 offset:34816
    ds_read_b64_tr_b16 a[14:15], v10 offset:35328
    buffer_load_dwordx4 v228, s[28:31], s76 offen offset:0 lds
    v_add_u32 v232, s75, v232
    v_max_i32 v232, 0, v232
    s_waitcnt lgkmcnt(8)
    v_mfma_f32_32x32x16_bf16 v[192:207], a[24:27], v[76:79], v[192:207]
    ds_read_b64_tr_b16 a[16:17], v11 offset:34816
    ds_read_b64_tr_b16 a[18:19], v11 offset:35328
    v_cndmask_b32 v234, 0, 8, vcc
    v_lshl_add_u32 v234, v232, 4, v234
    v_add_lshl_u32 v234, v234, s3, 7
    v_mfma_f32_32x32x16_bf16 v[208:223], a[28:31], v[76:79], v[208:223]
    ds_read_b64_tr_b16 a[20:21], v12 offset:34816
    ds_read_b64_tr_b16 a[22:23], v12 offset:35328
    buffer_load_dwordx4 v229, s[28:31], s76 offen offset:1024 lds
    v_and_b32 v232, 14, v0
    s_and_b32 s75, s3, 6
    s_waitcnt lgkmcnt(8)
    v_mfma_f32_32x32x16_bf16 v[160:175], a[0:3], v[80:83], v[160:175]
    ds_read_b64_tr_b16 a[24:25], v13 offset:34816
    ds_read_b64_tr_b16 a[26:27], v13 offset:35328
    s_and_b32 s74, s51, 60
    v_lshl_add_u32 v232, v232, 2, v233
    s_lshl4_add_u32 s75, s74, s75
    v_mfma_f32_32x32x16_bf16 v[176:191], a[4:7], v[80:83], v[176:191]
    ds_read_b64_tr_b16 a[28:29], v14 offset:34816
    ds_read_b64_tr_b16 a[30:31], v14 offset:35328
    buffer_load_dwordx4 v230, s[28:31], s76 offen offset:2048 lds
    v_add_lshl_u32 v235, v232, s75, 7
    v_accvgpr_write_b32 a248, v234
    v_smfmac_f32_16x16x64_bf16 a[192:195], a[224:227], a[0:7], v30
    s_waitcnt lgkmcnt(8)
    v_mfma_f32_32x32x16_bf16 v[160:175], a[8:11], v[84:87], v[160:175]
    s_waitcnt vmcnt(20)
    s_barrier
    ds_read_b64_tr_b16 a[0:1], v7 offset:36864
    ds_read_b64_tr_b16 a[2:3], v7 offset:37376
    buffer_load_dwordx4 v231, s[28:31], s76 offen offset:3072 lds
    v_mfma_f32_32x32x16_bf16 v[176:191], a[12:15], v[84:87], v[176:191]
    ds_read_b64_tr_b16 a[4:5], v8 offset:36864
    ds_read_b64_tr_b16 a[6:7], v8 offset:37376
    v_accvgpr_write_b32 a249, v235
    v_and_b32 v232, 31, v0
    v_lshrrev_b32 v233, 5, v0
    s_waitcnt lgkmcnt(8)
    v_mfma_f32_32x32x16_bf16 v[160:175], a[16:19], v[88:91], v[160:175]
    ds_read_b64_tr_b16 a[8:9], v250 offset:16384
    ds_read_b64_tr_b16 a[10:11], v250 offset:16640
    buffer_load_dword v26, v27, s[12:15], 0 offen
    s_add_u32 m0, s73, 26624
    v_lshlrev_b32 v233, 2, v233
    v_mfma_f32_32x32x16_bf16 v[176:191], a[20:23], v[88:91], v[176:191]
    ds_read_b64_tr_b16 a[12:13], v250 offset:17408
    ds_read_b64_tr_b16 a[14:15], v250 offset:17664
    buffer_load_dwordx4 v3, s[32:35], s62 offen lds
    s_waitcnt vmcnt(19)
    ds_read_b128 v[96:99], v224 offset:0
    s_waitcnt lgkmcnt(9)
    v_mfma_f32_32x32x16_bf16 v[160:175], a[24:27], v[92:95], v[160:175]
    ds_read_b64_tr_b16 a[16:17], v9 offset:36864
    ds_read_b64_tr_b16 a[18:19], v9 offset:37376
    ds_read_b128 v[100:103], v225 offset:0
    v_sub_u32 v232, v232, v233
    v_mfma_f32_32x32x16_bf16 v[176:191], a[28:31], v[92:95], v[176:191]
    ds_read_b64_tr_b16 a[20:21], v10 offset:36864
    ds_read_b64_tr_b16 a[22:23], v10 offset:37376
    buffer_load_dwordx4 v4, s[32:35], s62 offen offset:1024 lds
    s_add_u32 m0, s73, 28672
    v_accvgpr_write_b32 a250, v232
    s_waitcnt lgkmcnt(10)
    v_mfma_f32_32x32x16_bf16 a[32:47], v[80:83], a[0:3], a[32:47]
    ds_read_b64_tr_b16 a[24:25], v251 offset:16384
    ds_read_b64_tr_b16 a[26:27], v251 offset:16640
    ds_read_b128 v[104:107], v226 offset:0
    v_accvgpr_mov_b32 a143, a68
    v_mfma_f32_32x32x16_bf16 a[48:63], v[80:83], a[4:7], a[48:63]
    ds_read_b64_tr_b16 a[28:29], v251 offset:17408
    ds_read_b64_tr_b16 a[30:31], v251 offset:17664
    buffer_load_dwordx4 v3, s[36:39], s62 offen lds
    ds_read_b128 v[108:111], v227 offset:0
    v_smfmac_f32_16x16x64_bf16 a[196:199], a[224:227], a[0:7], v30
    s_waitcnt lgkmcnt(12)
    v_mfma_f32_32x32x16_bf16 v[192:207], a[8:11], v[80:83], v[192:207]
    ds_read_b64_tr_b16 a[0:1], v11 offset:36864
    ds_read_b64_tr_b16 a[2:3], v11 offset:37376
    buffer_load_dwordx4 v4, s[36:39], s62 offen offset:1024 lds
    s_add_u32 m0, s73, 12288
    s_xor_b32 s76, s79, 896
    v_mfma_f32_32x32x16_bf16 v[208:223], a[12:15], v[80:83], v[208:223]
    ds_read_b64_tr_b16 a[4:5], v12 offset:36864
    ds_read_b64_tr_b16 a[6:7], v12 offset:37376
    v_accvgpr_mov_b32 a144, a68
    v_accvgpr_mov_b32 a145, a68
    v_accvgpr_mov_b32 a146, a68
    v_smfmac_f32_16x16x64_bf16 a[200:203], a[224:227], a[8:15], v30
    s_waitcnt lgkmcnt(10)
    v_mfma_f32_32x32x16_bf16 a[32:47], v[84:87], a[16:19], a[32:47]
    ds_read_b64_tr_b16 a[8:9], v252 offset:16384
    ds_read_b64_tr_b16 a[10:11], v252 offset:16640
    buffer_load_dwordx4 v228, s[28:31], s76 offen offset:0 lds
    v_accvgpr_mov_b32 a147, a68
    v_accvgpr_mov_b32 a152, a68
    v_mfma_f32_32x32x16_bf16 a[48:63], v[84:87], a[20:23], a[48:63]
    ds_read_b64_tr_b16 a[12:13], v252 offset:17408
    ds_read_b64_tr_b16 a[14:15], v252 offset:17664
    buffer_load_dwordx4 v229, s[28:31], s76 offen offset:1024 lds
    v_accvgpr_mov_b32 a153, a68
    v_accvgpr_mov_b32 a154, a68
    s_waitcnt lgkmcnt(9)
    v_mfma_f32_32x32x16_bf16 v[192:207], a[24:27], v[84:87], v[192:207]
    ds_read_b64_tr_b16 a[16:17], v13 offset:36864
    ds_read_b64_tr_b16 a[18:19], v13 offset:37376
    v_accvgpr_mov_b32 a155, a68
    v_accvgpr_mov_b32 a156, a68
    v_accvgpr_mov_b32 a157, a68
    v_mfma_f32_32x32x16_bf16 v[208:223], a[28:31], v[84:87], v[208:223]
    ds_read_b64_tr_b16 a[20:21], v14 offset:36864
    ds_read_b64_tr_b16 a[22:23], v14 offset:37376
    buffer_load_dwordx4 v230, s[28:31], s76 offen offset:2048 lds
    v_accvgpr_mov_b32 a158, a68
    v_accvgpr_mov_b32 a159, a68
    s_waitcnt lgkmcnt(8)
    v_mfma_f32_32x32x16_bf16 a[32:47], v[88:91], a[0:3], a[32:47]
    ds_read_b64_tr_b16 a[24:25], v253 offset:16384
    ds_read_b64_tr_b16 a[26:27], v253 offset:16640
    v_accvgpr_mov_b32 a164, a68
    v_accvgpr_mov_b32 a165, a68
    v_accvgpr_mov_b32 a166, a68
    v_dot2_f32_bf16 v16, v96, v96, v16
    v_dot2_f32_bf16 v17, v97, v97, v17
    v_dot2_f32_bf16 v18, v98, v98, v18
    v_dot2_f32_bf16 v19, v99, v99, v19
    v_dot2_f32_bf16 v16, v100, v100, v16
    v_dot2_f32_bf16 v17, v101, v101, v17
    v_dot2_f32_bf16 v18, v102, v102, v18
    v_dot2_f32_bf16 v19, v103, v103, v19
    v_dot2_f32_bf16 v16, v104, v104, v16
    v_dot2_f32_bf16 v17, v105, v105, v17
    v_dot2_f32_bf16 v18, v106, v106, v18
    v_dot2_f32_bf16 v19, v107, v107, v19
    v_dot2_f32_bf16 v16, v108, v108, v16
    v_dot2_f32_bf16 v17, v109, v109, v17
    v_dot2_f32_bf16 v18, v110, v110, v18
    v_dot2_f32_bf16 v19, v111, v111, v19
    v_smfmac_f32_16x16x64_bf16 a[212:215], a[224:227], v[96:103], v30
    v_smfmac_f32_16x16x64_bf16 a[212:215], a[224:227], v[104:111], v30
    v_mfma_f32_32x32x16_bf16 a[48:63], v[88:91], a[4:7], a[48:63]
    ds_read_b64_tr_b16 a[28:29], v253 offset:17408
    ds_read_b64_tr_b16 a[30:31], v253 offset:17664
    buffer_load_dwordx4 v231, s[28:31], s76 offen offset:3072 lds
    s_add_u32 m0, s73, 30720
    v_accvgpr_mov_b32 a167, a68
    s_waitcnt lgkmcnt(8)
    v_mfma_f32_32x32x16_bf16 v[192:207], a[8:11], v[88:91], v[192:207]
    s_waitcnt vmcnt(21)
    s_barrier
    ds_read_b64_tr_b16 a[0:1], v7 offset:18432
    ds_read_b64_tr_b16 a[2:3], v7 offset:18944
    buffer_load_dwordx4 v3, s[32:35], s63 offen lds
    v_mfma_f32_32x32x16_bf16 v[208:223], a[12:15], v[88:91], v[208:223]
    ds_read_b64_tr_b16 a[4:5], v8 offset:18432
    ds_read_b64_tr_b16 a[6:7], v8 offset:18944
    s_waitcnt vmcnt(18)
    ds_read_b128 v[112:115], v224 offset:4096
    s_waitcnt lgkmcnt(9)
    v_mfma_f32_32x32x16_bf16 a[32:47], v[92:95], a[16:19], a[32:47]
    ds_read_b64_tr_b16 a[8:9], v7 offset:20480
    ds_read_b64_tr_b16 a[10:11], v7 offset:20992
    buffer_load_dwordx4 v4, s[32:35], s63 offen offset:1024 lds
    s_add_u32 m0, s73, 0
    v_accvgpr_mov_b32 a168, a68
    v_mfma_f32_32x32x16_bf16 a[48:63], v[92:95], a[20:23], a[48:63]
    ds_read_b64_tr_b16 a[12:13], v8 offset:20480
    ds_read_b64_tr_b16 a[14:15], v8 offset:20992
    buffer_load_dwordx4 v3, s[36:39], s63 offen lds
    ds_read_b128 v[116:119], v225 offset:4096
    s_waitcnt lgkmcnt(10)
    v_mfma_f32_32x32x16_bf16 v[192:207], a[24:27], v[92:95], v[192:207]
    ds_read_b64_tr_b16 a[16:17], v9 offset:18432
    ds_read_b64_tr_b16 a[18:19], v9 offset:18944
    ds_read_b128 v[120:123], v226 offset:4096
    v_accvgpr_mov_b32 a169, a68
    v_mfma_f32_32x32x16_bf16 v[208:223], a[28:31], v[92:95], v[208:223]
    ds_read_b64_tr_b16 a[20:21], v10 offset:18432
    ds_read_b64_tr_b16 a[22:23], v10 offset:18944
    buffer_load_dwordx4 v4, s[36:39], s63 offen offset:1024 lds
    s_add_u32 m0, s73, 2048
    v_accvgpr_mov_b32 a170, a68
    s_waitcnt lgkmcnt(11)
    v_mfma_f32_32x32x16_bf16 v[160:175], a[0:3], v[96:99], v[160:175]
    ds_read_b64_tr_b16 a[24:25], v9 offset:20480
    ds_read_b64_tr_b16 a[26:27], v9 offset:20992
    ds_read_b128 v[124:127], v227 offset:4096
    v_accvgpr_mov_b32 a171, a68
    v_mfma_f32_32x32x16_bf16 v[176:191], a[4:7], v[96:99], v[176:191]
    ds_read_b64_tr_b16 a[28:29], v10 offset:20480
    ds_read_b64_tr_b16 a[30:31], v10 offset:20992
    buffer_load_dwordx4 v15, s[40:43], s68 offen lds
    s_add_u32 m0, s73, 3072
    v_accvgpr_mov_b32 a176, a68
    v_smfmac_f32_16x16x64_bf16 a[192:195], a[224:227], a[0:7], v30
    s_waitcnt lgkmcnt(11)
    v_mfma_f32_32x32x16_bf16 a[32:47], v[96:99], a[8:11], a[32:47]
    ds_read_b64_tr_b16 a[0:1], v11 offset:18432
    ds_read_b64_tr_b16 a[2:3], v11 offset:18944
    buffer_load_dwordx4 v15, s[44:47], s68 offen lds
    s_add_u32 m0, s73, 32768
    v_accvgpr_mov_b32 a177, a68
    v_mfma_f32_32x32x16_bf16 a[48:63], v[96:99], a[12:15], a[48:63]
    ds_read_b64_tr_b16 a[4:5], v12 offset:18432
    ds_read_b64_tr_b16 a[6:7], v12 offset:18944
    v_accvgpr_mov_b32 a178, a68
    v_accvgpr_mov_b32 a179, a68
    v_accvgpr_mov_b32 a180, a68
    v_smfmac_f32_16x16x64_bf16 a[196:199], a[224:227], a[8:15], v30
    s_waitcnt lgkmcnt(9)
    v_mfma_f32_32x32x16_bf16 v[160:175], a[16:19], v[100:103], v[160:175]
    ds_read_b64_tr_b16 a[8:9], v11 offset:20480
    ds_read_b64_tr_b16 a[10:11], v11 offset:20992
    buffer_load_dwordx4 v15, s[40:43], s69 offen lds
    s_add_u32 m0, s73, 33792
    v_accvgpr_mov_b32 a181, a68
    v_mfma_f32_32x32x16_bf16 v[176:191], a[20:23], v[100:103], v[176:191]
    ds_read_b64_tr_b16 a[12:13], v12 offset:20480
    ds_read_b64_tr_b16 a[14:15], v12 offset:20992
    buffer_load_dwordx4 v15, s[44:47], s69 offen lds
    v_accvgpr_mov_b32 a182, a68
    v_accvgpr_mov_b32 a183, a68
    s_waitcnt lgkmcnt(8)
    v_mfma_f32_32x32x16_bf16 a[32:47], v[100:103], a[24:27], a[32:47]
    ds_read_b64_tr_b16 a[16:17], v13 offset:18432
    ds_read_b64_tr_b16 a[18:19], v13 offset:18944
    v_dot2_f32_bf16 v16, v112, v112, v16
    v_dot2_f32_bf16 v17, v113, v113, v17
    v_dot2_f32_bf16 v18, v114, v114, v18
    v_dot2_f32_bf16 v19, v115, v115, v19
    v_dot2_f32_bf16 v16, v116, v116, v16
    v_dot2_f32_bf16 v17, v117, v117, v17
    v_dot2_f32_bf16 v18, v118, v118, v18
    v_dot2_f32_bf16 v19, v119, v119, v19
    v_dot2_f32_bf16 v16, v120, v120, v16
    v_dot2_f32_bf16 v17, v121, v121, v17
    v_dot2_f32_bf16 v18, v122, v122, v18
    v_dot2_f32_bf16 v19, v123, v123, v19
    v_dot2_f32_bf16 v16, v124, v124, v16
    v_dot2_f32_bf16 v17, v125, v125, v17
    v_dot2_f32_bf16 v18, v126, v126, v18
    v_dot2_f32_bf16 v19, v127, v127, v19
    v_smfmac_f32_16x16x64_bf16 a[212:215], a[224:227], v[112:119], v30
    v_smfmac_f32_16x16x64_bf16 a[212:215], a[224:227], v[120:127], v30
    v_mfma_f32_32x32x16_bf16 a[48:63], v[100:103], a[28:31], a[48:63]
    ds_read_b64_tr_b16 a[20:21], v14 offset:18432
    ds_read_b64_tr_b16 a[22:23], v14 offset:18944
    s_waitcnt lgkmcnt(8)
    v_mfma_f32_32x32x16_bf16 v[160:175], a[0:3], v[104:107], v[160:175]
    ds_read_b64_tr_b16 a[24:25], v13 offset:20480
    ds_read_b64_tr_b16 a[26:27], v13 offset:20992
    v_mfma_f32_32x32x16_bf16 v[176:191], a[4:7], v[104:107], v[176:191]
    ds_read_b64_tr_b16 a[28:29], v14 offset:20480
    ds_read_b64_tr_b16 a[30:31], v14 offset:20992
    s_waitcnt vmcnt(17)
    ds_read_b128 v[128:131], v224 offset:8192
    s_waitcnt lgkmcnt(9)
    v_mfma_f32_32x32x16_bf16 a[32:47], v[104:107], a[8:11], a[32:47]
    s_barrier
    ds_read_b64_tr_b16 a[0:1], v7 offset:22528
    ds_read_b64_tr_b16 a[2:3], v7 offset:23040
    s_add_u32 m0, s73, 34816
    ds_read_b128 v[132:135], v225 offset:8192
    v_mfma_f32_32x32x16_bf16 a[48:63], v[104:107], a[12:15], a[48:63]
    ds_read_b64_tr_b16 a[4:5], v8 offset:22528
    ds_read_b64_tr_b16 a[6:7], v8 offset:23040
    buffer_load_dwordx4 v15, s[40:43], s70 offen lds
    s_add_u32 m0, s73, 35840
    s_waitcnt lgkmcnt(10)
    v_mfma_f32_32x32x16_bf16 v[160:175], a[16:19], v[108:111], v[160:175]
    ds_read_b64_tr_b16 a[8:9], v7 offset:24576
    ds_read_b64_tr_b16 a[10:11], v7 offset:25088
    buffer_load_dwordx4 v15, s[44:47], s70 offen lds
    s_add_u32 m0, s73, 4096
    v_mfma_f32_32x32x16_bf16 v[176:191], a[20:23], v[108:111], v[176:191]
    ds_read_b64_tr_b16 a[12:13], v8 offset:24576
    ds_read_b64_tr_b16 a[14:15], v8 offset:25088
    ds_read_b128 v[136:139], v226 offset:8192
    s_waitcnt lgkmcnt(11)
    v_mfma_f32_32x32x16_bf16 a[32:47], v[108:111], a[24:27], a[32:47]
    ds_read_b64_tr_b16 a[16:17], v9 offset:22528
    ds_read_b64_tr_b16 a[18:19], v9 offset:23040
    buffer_load_dwordx4 v15, s[40:43], s71 offen lds
    s_add_u32 m0, s73, 5120
    v_mfma_f32_32x32x16_bf16 a[48:63], v[108:111], a[28:31], a[48:63]
    ds_read_b64_tr_b16 a[20:21], v10 offset:22528
    ds_read_b64_tr_b16 a[22:23], v10 offset:23040
    buffer_load_dwordx4 v15, s[44:47], s71 offen lds
    ds_read_b128 v[140:143], v227 offset:8192
    s_waitcnt lgkmcnt(10)
    v_mfma_f32_32x32x16_bf16 v[160:175], a[0:3], v[112:115], v[160:175]
    ds_read_b64_tr_b16 a[24:25], v9 offset:24576
    ds_read_b64_tr_b16 a[26:27], v9 offset:25088
    v_mfma_f32_32x32x16_bf16 v[176:191], a[4:7], v[112:115], v[176:191]
    ds_read_b64_tr_b16 a[28:29], v10 offset:24576
    ds_read_b64_tr_b16 a[30:31], v10 offset:25088
    buffer_load_dwordx2 v[28:29], off, s[24:27], 0 sc1
    v_smfmac_f32_16x16x64_bf16 a[192:195], a[224:227], a[0:7], v30
    s_waitcnt lgkmcnt(10)
    v_mfma_f32_32x32x16_bf16 a[32:47], v[112:115], a[8:11], a[32:47]
    ds_read_b64_tr_b16 a[0:1], v11 offset:22528
    ds_read_b64_tr_b16 a[2:3], v11 offset:23040
    v_mfma_f32_32x32x16_bf16 a[48:63], v[112:115], a[12:15], a[48:63]
    ds_read_b64_tr_b16 a[4:5], v12 offset:22528
    ds_read_b64_tr_b16 a[6:7], v12 offset:23040
    v_smfmac_f32_16x16x64_bf16 a[196:199], a[224:227], a[8:15], v30
    s_waitcnt lgkmcnt(9)
    v_mfma_f32_32x32x16_bf16 v[160:175], a[16:19], v[116:119], v[160:175]
    ds_read_b64_tr_b16 a[8:9], v11 offset:24576
    ds_read_b64_tr_b16 a[10:11], v11 offset:25088
    s_waitcnt lgkmcnt(10)
    v_dot2_f32_bf16 v16, v128, v128, v16
    v_dot2_f32_bf16 v17, v129, v129, v17
    v_dot2_f32_bf16 v18, v130, v130, v18
    v_dot2_f32_bf16 v19, v131, v131, v19
    v_dot2_f32_bf16 v16, v132, v132, v16
    v_dot2_f32_bf16 v17, v133, v133, v17
    v_dot2_f32_bf16 v18, v134, v134, v18
    v_dot2_f32_bf16 v19, v135, v135, v19
    v_dot2_f32_bf16 v16, v136, v136, v16
    v_dot2_f32_bf16 v17, v137, v137, v17
    v_dot2_f32_bf16 v18, v138, v138, v18
    v_dot2_f32_bf16 v19, v139, v139, v19
    v_dot2_f32_bf16 v16, v140, v140, v16
    v_dot2_f32_bf16 v17, v141, v141, v17
    v_dot2_f32_bf16 v18, v142, v142, v18
    v_dot2_f32_bf16 v19, v143, v143, v19
    v_smfmac_f32_16x16x64_bf16 a[212:215], a[224:227], v[128:135], v30
    v_smfmac_f32_16x16x64_bf16 a[212:215], a[224:227], v[136:143], v30
    v_mfma_f32_32x32x16_bf16 v[176:191], a[20:23], v[116:119], v[176:191]
    ds_read_b64_tr_b16 a[12:13], v12 offset:24576
    ds_read_b64_tr_b16 a[14:15], v12 offset:25088
    s_waitcnt lgkmcnt(8)
    v_mfma_f32_32x32x16_bf16 a[32:47], v[116:119], a[24:27], a[32:47]
    ds_read_b64_tr_b16 a[16:17], v13 offset:22528
    ds_read_b64_tr_b16 a[18:19], v13 offset:23040
    v_mfma_f32_32x32x16_bf16 a[48:63], v[116:119], a[28:31], a[48:63]
    ds_read_b64_tr_b16 a[20:21], v14 offset:22528
    ds_read_b64_tr_b16 a[22:23], v14 offset:23040
    s_waitcnt vmcnt(13)
    ds_read_b128 v[144:147], v224 offset:12288
    s_waitcnt lgkmcnt(9)
    v_mfma_f32_32x32x16_bf16 v[160:175], a[0:3], v[120:123], v[160:175]
    ds_read_b64_tr_b16 a[24:25], v13 offset:24576
    ds_read_b64_tr_b16 a[26:27], v13 offset:25088
    ds_read_b128 v[148:151], v225 offset:12288
    v_mfma_f32_32x32x16_bf16 v[176:191], a[4:7], v[120:123], v[176:191]
    ds_read_b64_tr_b16 a[28:29], v14 offset:24576
    ds_read_b64_tr_b16 a[30:31], v14 offset:25088
    ds_read_b128 v[152:155], v226 offset:12288
    s_waitcnt lgkmcnt(11)
    v_mfma_f32_32x32x16_bf16 a[32:47], v[120:123], a[8:11], a[32:47]
    s_barrier
    ds_read_b64_tr_b16 a[0:1], v7 offset:26624
    ds_read_b64_tr_b16 a[2:3], v7 offset:27136
    s_add_u32 m0, s73, 6144
    ds_read_b128 v[156:159], v227 offset:12288
    v_mfma_f32_32x32x16_bf16 a[48:63], v[120:123], a[12:15], a[48:63]
    ds_read_b64_tr_b16 a[4:5], v8 offset:26624
    ds_read_b64_tr_b16 a[6:7], v8 offset:27136
    buffer_load_dwordx4 v5, s[40:43], s64 offen lds
    s_waitcnt lgkmcnt(12)
    v_mfma_f32_32x32x16_bf16 v[160:175], a[16:19], v[124:127], v[160:175]
    ds_read_b64_tr_b16 a[8:9], v7 offset:28672
    ds_read_b64_tr_b16 a[10:11], v7 offset:29184
    buffer_load_dwordx4 v6, s[40:43], s64 offen offset:1024 lds
    s_add_u32 m0, s73, 36864
    v_mfma_f32_32x32x16_bf16 v[176:191], a[20:23], v[124:127], v[176:191]
    ds_read_b64_tr_b16 a[12:13], v8 offset:28672
    ds_read_b64_tr_b16 a[14:15], v8 offset:29184
    s_waitcnt lgkmcnt(10)
    v_mfma_f32_32x32x16_bf16 a[32:47], v[124:127], a[24:27], a[32:47]
    ds_read_b64_tr_b16 a[16:17], v9 offset:26624
    ds_read_b64_tr_b16 a[18:19], v9 offset:27136
    buffer_load_dwordx4 v5, s[40:43], s65 offen lds
    v_mfma_f32_32x32x16_bf16 a[48:63], v[124:127], a[28:31], a[48:63]
    ds_read_b64_tr_b16 a[20:21], v10 offset:26624
    ds_read_b64_tr_b16 a[22:23], v10 offset:27136
    buffer_load_dwordx4 v6, s[40:43], s65 offen offset:1024 lds
    s_waitcnt lgkmcnt(8)
    v_mfma_f32_32x32x16_bf16 v[160:175], a[0:3], v[128:131], v[160:175]
    ds_read_b64_tr_b16 a[24:25], v9 offset:28672
    ds_read_b64_tr_b16 a[26:27], v9 offset:29184
    v_mfma_f32_32x32x16_bf16 v[176:191], a[4:7], v[128:131], v[176:191]
    ds_read_b64_tr_b16 a[28:29], v10 offset:28672
    ds_read_b64_tr_b16 a[30:31], v10 offset:29184
    v_smfmac_f32_16x16x64_bf16 a[192:195], a[224:227], a[0:7], v30
    s_waitcnt lgkmcnt(8)
    v_mfma_f32_32x32x16_bf16 a[32:47], v[128:131], a[8:11], a[32:47]
    ds_read_b64_tr_b16 a[0:1], v11 offset:26624
    ds_read_b64_tr_b16 a[2:3], v11 offset:27136
    v_dot2_f32_bf16 v16, v144, v144, v16
    v_dot2_f32_bf16 v17, v145, v145, v17
    v_dot2_f32_bf16 v18, v146, v146, v18
    v_dot2_f32_bf16 v19, v147, v147, v19
    v_dot2_f32_bf16 v16, v148, v148, v16
    v_dot2_f32_bf16 v17, v149, v149, v17
    v_dot2_f32_bf16 v18, v150, v150, v18
    v_dot2_f32_bf16 v19, v151, v151, v19
    v_dot2_f32_bf16 v16, v152, v152, v16
    v_dot2_f32_bf16 v17, v153, v153, v17
    v_dot2_f32_bf16 v18, v154, v154, v18
    v_dot2_f32_bf16 v19, v155, v155, v19
    v_dot2_f32_bf16 v16, v156, v156, v16
    v_dot2_f32_bf16 v17, v157, v157, v17
    v_dot2_f32_bf16 v18, v158, v158, v18
    v_dot2_f32_bf16 v19, v159, v159, v19
    v_smfmac_f32_16x16x64_bf16 a[212:215], a[224:227], v[144:151], v30
    v_smfmac_f32_16x16x64_bf16 a[212:215], a[224:227], v[152:159], v30
    v_mfma_f32_32x32x16_bf16 a[48:63], v[128:131], a[12:15], a[48:63]
    ds_read_b64_tr_b16 a[4:5], v12 offset:26624
    ds_read_b64_tr_b16 a[6:7], v12 offset:27136
    v_smfmac_f32_16x16x64_bf16 a[196:199], a[224:227], a[8:15], v30
    s_waitcnt lgkmcnt(8)
    v_mfma_f32_32x32x16_bf16 v[160:175], a[16:19], v[132:135], v[160:175]
    ds_read_b64_tr_b16 a[8:9], v11 offset:28672
    ds_read_b64_tr_b16 a[10:11], v11 offset:29184
    v_accvgpr_read_b32 v20, a212
    v_accvgpr_read_b32 v21, a213
    v_add_f32 v16, v16, v17
    v_mfma_f32_32x32x16_bf16 v[176:191], a[20:23], v[132:135], v[176:191]
    ds_read_b64_tr_b16 a[12:13], v12 offset:28672
    ds_read_b64_tr_b16 a[14:15], v12 offset:29184
    v_add_f32 v18, v18, v19
    v_add_f32 v20, v20, v21
    v_add_f32 v16, v16, v18
    s_waitcnt lgkmcnt(8)
    v_mfma_f32_32x32x16_bf16 a[32:47], v[132:135], a[24:27], a[32:47]
    ds_read_b64_tr_b16 a[16:17], v13 offset:26624
    ds_read_b64_tr_b16 a[18:19], v13 offset:27136
    v_mov_b32 v21, v20
    v_mov_b32 v17, v16
    v_cmp_gt_u32 vcc, 32, v0
    v_mfma_f32_32x32x16_bf16 a[48:63], v[132:135], a[28:31], a[48:63]
    ds_read_b64_tr_b16 a[20:21], v14 offset:26624
    ds_read_b64_tr_b16 a[22:23], v14 offset:27136
    v_lshlrev_b32 v19, 2, v0
    v_permlane32_swap_b32 v20, v21
    v_permlane32_swap_b32 v16, v17
    s_waitcnt lgkmcnt(8)
    v_mfma_f32_32x32x16_bf16 v[160:175], a[0:3], v[136:139], v[160:175]
    ds_read_b64_tr_b16 a[24:25], v13 offset:28672
    ds_read_b64_tr_b16 a[26:27], v13 offset:29184
    v_add_f32 v20, v20, v21
    v_add_f32 v16, v16, v17
    v_mul_f32 v20, 0x3b000000, v20
    v_mfma_f32_32x32x16_bf16 v[176:191], a[4:7], v[136:139], v[176:191]
    ds_read_b64_tr_b16 a[28:29], v14 offset:28672
    ds_read_b64_tr_b16 a[30:31], v14 offset:29184
    v_mul_f32 v16, 0x3b000000, v16
    v_cvt_pk_bf16_f32 v21, -v20, -v20
    v_fma_f32 v16, -v20, v20, v16
    s_waitcnt lgkmcnt(8)
    v_mfma_f32_32x32x16_bf16 a[32:47], v[136:139], a[8:11], a[32:47]
    s_waitcnt vmcnt(13)
    s_barrier
    ds_read_b64_tr_b16 a[0:1], v7 offset:30720
    ds_read_b64_tr_b16 a[2:3], v7 offset:31232
    s_add_u32 m0, s73, 16384
    v_mfma_f32_32x32x16_bf16 a[48:63], v[136:139], a[12:15], a[48:63]
    ds_read_b64_tr_b16 a[4:5], v8 offset:30720
    ds_read_b64_tr_b16 a[6:7], v8 offset:31232
    buffer_load_dwordx4 v5, s[40:43], s66 offen lds
    v_cndmask_b32 v20, 0, v21, vcc
    v_max_f32 v16, 0, v16
    s_waitcnt lgkmcnt(8)
    v_mfma_f32_32x32x16_bf16 v[160:175], a[16:19], v[140:143], v[160:175]
    ds_read_b64_tr_b16 a[8:9], v7 offset:0
    ds_read_b64_tr_b16 a[10:11], v7 offset:512
    buffer_load_dwordx4 v6, s[40:43], s66 offen offset:1024 lds
    s_add_u32 m0, s73, 8192
    v_xor_b32 v21, v21, v20
    v_mfma_f32_32x32x16_bf16 v[176:191], a[20:23], v[140:143], v[176:191]
    ds_read_b64_tr_b16 a[12:13], v8 offset:0
    ds_read_b64_tr_b16 a[14:15], v8 offset:512
    v_cvt_pk_bf16_f32 v17, v16, v16
    v_lshlrev_b32 v16, 16, v17
    v_accvgpr_write_b32 a240, v20
    s_waitcnt lgkmcnt(8)
    v_mfma_f32_32x32x16_bf16 a[32:47], v[140:143], a[24:27], a[32:47]
    ds_read_b64_tr_b16 a[16:17], v9 offset:30720
    ds_read_b64_tr_b16 a[18:19], v9 offset:31232
    buffer_load_dwordx4 v5, s[40:43], s67 offen lds
    v_add_f32 v16, 0x3727c5ac, v16
    v_accvgpr_write_b32 a241, v20
    v_mfma_f32_32x32x16_bf16 a[48:63], v[140:143], a[28:31], a[48:63]
    ds_read_b64_tr_b16 a[20:21], v10 offset:30720
    ds_read_b64_tr_b16 a[22:23], v10 offset:31232
    buffer_load_dwordx4 v6, s[40:43], s67 offen offset:1024 lds
    v_cvt_pk_bf16_f32 v17, v16, v16
    v_accvgpr_write_b32 a242, v20
    s_waitcnt lgkmcnt(8)
    v_mfma_f32_32x32x16_bf16 v[160:175], a[0:3], v[144:147], v[160:175]
    ds_read_b64_tr_b16 a[24:25], v11 offset:30720
    ds_read_b64_tr_b16 a[26:27], v11 offset:31232
    v_lshlrev_b32 v16, 16, v17
    v_accvgpr_write_b32 a243, v20
    v_sqrt_f32 v16, v16
    v_mfma_f32_32x32x16_bf16 v[176:191], a[4:7], v[144:147], v[176:191]
    ds_read_b64_tr_b16 a[28:29], v12 offset:30720
    ds_read_b64_tr_b16 a[30:31], v12 offset:31232
    v_accvgpr_write_b32 a244, v21
    v_cvt_pk_bf16_f32 v17, v16, v16
    v_accvgpr_write_b32 a245, v21
    v_smfmac_f32_16x16x64_bf16 a[192:195], a[224:227], a[0:7], v30
    s_waitcnt lgkmcnt(8)
    v_mfma_f32_32x32x16_bf16 a[32:47], v[144:147], a[8:11], a[32:47]
    ds_read_b64_tr_b16 a[0:1], v13 offset:30720
    ds_read_b64_tr_b16 a[2:3], v13 offset:31232
    v_lshlrev_b32 v16, 16, v17
    v_accvgpr_write_b32 a246, v21
    v_rcp_f32 v31, v16
    v_mfma_f32_32x32x16_bf16 a[48:63], v[144:147], a[12:15], a[48:63]
    ds_read_b64_tr_b16 a[4:5], v14 offset:30720
    ds_read_b64_tr_b16 a[6:7], v14 offset:31232
    v_accvgpr_write_b32 a247, v21
    v_lshrrev_b32 v16, 5, v0
    s_lshl_b32 s76, s72, 8
    v_smfmac_f32_16x16x64_bf16 a[196:199], a[224:227], a[8:15], v30
    s_waitcnt lgkmcnt(8)
    v_mfma_f32_32x32x16_bf16 v[160:175], a[16:19], v[148:151], v[160:175]
    ds_read_b64_tr_b16 a[8:9], v9 offset:0
    ds_read_b64_tr_b16 a[10:11], v9 offset:512
    s_lshl_b32 s101, s72, 2
    v_add_u32 v244, s101, v1
    v_accvgpr_read_b32 v240, a192
    s_nop 0
    v_accvgpr_read_b32 v242, a196
    v_accvgpr_read_b32 v241, a193
    v_accvgpr_read_b32 v243, a197
    v_mfma_f32_32x32x16_bf16 v[176:191], a[20:23], v[148:151], v[176:191]
    ds_read_b64_tr_b16 a[12:13], v10 offset:0
    ds_read_b64_tr_b16 a[14:15], v10 offset:512
    v_add_f32 v240, v240, v241
    v_add_f32 v242, v242, v243
    v_cvt_pk_bf16_f32 v241, v240, v240
    v_cvt_pk_bf16_f32 v243, v242, v242
    v_lshlrev_b32 v241, 16, v241
    v_lshlrev_b32 v243, 16, v243
    s_waitcnt lgkmcnt(8)
    v_mfma_f32_32x32x16_bf16 v[160:175], a[24:27], v[152:155], v[160:175]
    ds_read_b64_tr_b16 a[16:17], v11 offset:0
    ds_read_b64_tr_b16 a[18:19], v11 offset:512
    v_sub_f32 v241, v240, v241
    v_sub_f32 v243, v242, v243
    v_cvt_pk_bf16_f32 v240, v240, v241
    v_cvt_pk_bf16_f32 v242, v242, v243
    ds_write_b32 v244, v240 offset:38912
    ds_write_b32 v244, v242 offset:39936
    v_mfma_f32_32x32x16_bf16 v[176:191], a[28:31], v[152:155], v[176:191]
    ds_read_b64_tr_b16 a[20:21], v12 offset:0
    ds_read_b64_tr_b16 a[22:23], v12 offset:512
    s_add_u32 s76, s76, 40960
    v_add_u32 v19, s76, v19
    v_lshl_add_u32 v16, v16, 4, s76
    s_waitcnt lgkmcnt(10)
    v_mfma_f32_32x32x16_bf16 v[160:175], a[0:3], v[156:159], v[160:175]
    ds_read_b64_tr_b16 a[24:25], v13 offset:0
    ds_read_b64_tr_b16 a[26:27], v13 offset:512
    ds_write_b32 v19, v31 offset:38912
    v_mov_b32 v18, v31
    v_mov_b32 v19, v31
    v_mfma_f32_32x32x16_bf16 v[176:191], a[4:7], v[156:159], v[176:191]
    ds_read_b64_tr_b16 a[28:29], v14 offset:0
    ds_read_b64_tr_b16 a[30:31], v14 offset:512
    s_waitcnt lgkmcnt(11)
    v_mfma_f32_32x32x16_bf16 a[32:47], v[148:151], a[8:11], a[32:47]
    s_waitcnt vmcnt(13) lgkmcnt(7)
    s_barrier
    ds_read_b128 a[232:235], v1 offset:38912
    ds_read_b128 a[236:239], v1 offset:39936
    ds_read_b64_tr_b16 a[0:1], v250 offset:2048
    ds_read_b64_tr_b16 a[2:3], v250 offset:2304
    s_add_u32 m0, s73, 10240
    v_mfma_f32_32x32x16_bf16 a[48:63], v[148:151], a[12:15], a[48:63]
    ds_read_b64_tr_b16 a[4:5], v250 offset:3072
    ds_read_b64_tr_b16 a[6:7], v250 offset:3328
    buffer_load_dwordx4 v5, s[40:43], s68 offen lds
    s_waitcnt lgkmcnt(11)
    v_mfma_f32_32x32x16_bf16 a[32:47], v[152:155], a[16:19], a[32:47]
    ds_read_b64_tr_b16 a[8:9], v251 offset:2048
    ds_read_b64_tr_b16 a[10:11], v251 offset:2304
    s_waitcnt vmcnt(9)
    v_cmp_eq_u64 vcc, 0, v[28:29]
    s_cbranch_vccz eok_7
    s_movk_i32 s101, 30000
elp_8:
    buffer_load_dwordx2 v[28:29], off, s[24:27], 0 sc1
    s_waitcnt vmcnt(0)
    v_cmp_eq_u64 vcc, 0, v[28:29]
    s_cbranch_vccz eok_7
    s_sub_u32 s101, s101, 1
    s_cbranch_scc0 elp_8
eok_7:
    v_mfma_f32_32x32x16_bf16 a[48:63], v[152:155], a[20:23], a[48:63]
    ds_read_b64_tr_b16 a[12:13], v251 offset:3072
    ds_read_b64_tr_b16 a[14:15], v251 offset:3328
    buffer_load_dwordx4 v6, s[40:43], s68 offen offset:1024 lds
    s_add_u32 m0, s73, 18432
    s_waitcnt lgkmcnt(10)
    v_mfma_f32_32x32x16_bf16 a[32:47], v[156:159], a[24:27], a[32:47]
    ds_read_b64_tr_b16 a[16:17], v252 offset:2048
    ds_read_b64_tr_b16 a[18:19], v252 offset:2304
    buffer_load_dwordx4 v5, s[40:43], s69 offen lds
    v_mfma_f32_32x32x16_bf16 a[48:63], v[156:159], a[28:31], a[48:63]
    ds_read_b64_tr_b16 a[20:21], v252 offset:3072
    ds_read_b64_tr_b16 a[22:23], v252 offset:3328
    s_waitcnt lgkmcnt(12)
    v_mfma_f32_32x32x16_bf16 v[160:175], a[232:235], a[240:243], v[160:175]
    v_mfma_f32_32x32x16_bf16 v[176:191], a[232:235], a[244:247], v[176:191]
    v_mfma_f32_32x32x16_bf16 a[32:47], a[240:243], a[236:239], a[32:47]
    v_mfma_f32_32x32x16_bf16 a[48:63], a[244:247], a[236:239], a[48:63]
    s_waitcnt lgkmcnt(8)
    v_mfma_f32_32x32x16_bf16 v[192:207], a[0:3], v[96:99], v[192:207]
    ds_read_b64_tr_b16 a[24:25], v253 offset:2048
    ds_read_b64_tr_b16 a[26:27], v253 offset:2304
    buffer_load_dwordx4 v6, s[40:43], s69 offen offset:1024 lds
    v_mfma_f32_32x32x16_bf16 v[208:223], a[4:7], v[96:99], v[208:223]
    ds_read_b64_tr_b16 a[28:29], v253 offset:3072
    ds_read_b64_tr_b16 a[30:31], v253 offset:3328
    v_smfmac_f32_16x16x64_bf16 a[200:203], a[224:227], a[0:7], v30
    s_waitcnt lgkmcnt(8)
    v_mfma_f32_32x32x16_bf16 v[192:207], a[8:11], v[100:103], v[192:207]
    ds_read_b64_tr_b16 a[0:1], v250 offset:32768
    ds_read_b64_tr_b16 a[2:3], v250 offset:33024
    v_mfma_f32_32x32x16_bf16 v[208:223], a[12:15], v[100:103], v[208:223]
    ds_read_b64_tr_b16 a[4:5], v250 offset:33792
    ds_read_b64_tr_b16 a[6:7], v250 offset:34048
    v_mul_f32 v160, v160, v18
    v_mul_f32 v161, v161, v18
    v_mul_f32 v162, v162, v18
    v_mul_f32 v163, v163, v18
    v_mul_f32 v164, v164, v18
    v_mul_f32 v165, v165, v18
    v_mul_f32 v166, v166, v18
    v_mul_f32 v167, v167, v18
    v_mul_f32 v168, v168, v18
    v_mul_f32 v169, v169, v18
    v_mul_f32 v170, v170, v18
    v_mul_f32 v171, v171, v18
    s_waitcnt lgkmcnt(8)
    v_mfma_f32_32x32x16_bf16 v[192:207], a[16:19], v[104:107], v[192:207]
    ds_read_b64_tr_b16 a[8:9], v251 offset:32768
    ds_read_b64_tr_b16 a[10:11], v251 offset:33024
    v_mul_f32 v172, v172, v18
    v_mul_f32 v173, v173, v18
    v_mul_f32 v174, v174, v18
    v_mul_f32 v175, v175, v18
    v_cvt_pk_bf16_f32 v160, v160, v161
    v_cvt_pk_bf16_f32 v161, v162, v163
    v_cvt_pk_bf16_f32 v162, v164, v165
    v_cvt_pk_bf16_f32 v163, v166, v167
    v_cvt_pk_bf16_f32 v164, v168, v169
    v_cvt_pk_bf16_f32 v165, v170, v171
    v_cvt_pk_bf16_f32 v166, v172, v173
    v_cvt_pk_bf16_f32 v167, v174, v175
    v_mfma_f32_32x32x16_bf16 v[208:223], a[20:23], v[104:107], v[208:223]
    ds_read_b64_tr_b16 a[12:13], v251 offset:33792
    ds_read_b64_tr_b16 a[14:15], v251 offset:34048
    buffer_store_dwordx4 v[160:163], v1, s[52:55], s80 offen offset:0 sc1
    ds_read_b128 v[168:171], v16 offset:38912
    ds_read_b128 v[172:175], v16 offset:38944
    v_mul_f32 v176, v176, v18
    v_mul_f32 v177, v177, v18
    v_mul_f32 v178, v178, v18
    v_mul_f32 v179, v179, v18
    v_mul_f32 v180, v180, v18
    v_mul_f32 v181, v181, v18
    v_mul_f32 v182, v182, v18
    s_waitcnt lgkmcnt(10)
    v_mfma_f32_32x32x16_bf16 v[192:207], a[24:27], v[108:111], v[192:207]
    ds_read_b64_tr_b16 a[16:17], v252 offset:32768
    ds_read_b64_tr_b16 a[18:19], v252 offset:33024
    buffer_store_dwordx4 v[164:167], v1, s[52:55], s80 offen offset:1024 sc1
    v_mul_f32 v183, v183, v18
    v_mul_f32 v184, v184, v18
    v_mul_f32 v185, v185, v18
    v_mul_f32 v186, v186, v18
    v_mul_f32 v187, v187, v18
    v_mul_f32 v188, v188, v18
    v_mul_f32 v189, v189, v18
    v_mul_f32 v190, v190, v18
    v_mul_f32 v191, v191, v18
    v_cvt_pk_bf16_f32 v176, v176, v177
    v_cvt_pk_bf16_f32 v177, v178, v179
    v_mfma_f32_32x32x16_bf16 v[208:223], a[28:31], v[108:111], v[208:223]
    ds_read_b64_tr_b16 a[20:21], v252 offset:33792
    ds_read_b64_tr_b16 a[22:23], v252 offset:34048
    v_cvt_pk_bf16_f32 v178, v180, v181
    v_cvt_pk_bf16_f32 v179, v182, v183
    v_cvt_pk_bf16_f32 v180, v184, v185
    v_cvt_pk_bf16_f32 v181, v186, v187
    v_cvt_pk_bf16_f32 v182, v188, v189
    v_cvt_pk_bf16_f32 v183, v190, v191
    ds_read_b128 v[184:187], v16 offset:38976
    ds_read_b128 v[188:191], v16 offset:39008
    v_accvgpr_read_b32 v160, a32
    v_accvgpr_read_b32 v161, a33
    s_waitcnt lgkmcnt(12)
    v_mfma_f32_32x32x16_bf16 v[192:207], a[0:3], v[112:115], v[192:207]
    ds_read_b64_tr_b16 a[24:25], v253 offset:32768
    ds_read_b64_tr_b16 a[26:27], v253 offset:33024
    buffer_store_dwordx4 v[176:179], v1, s[52:55], s80 offen offset:2048 sc1
    v_accvgpr_read_b32 v162, a34
    v_accvgpr_read_b32 v163, a35
    v_accvgpr_read_b32 v164, a36
    v_accvgpr_read_b32 v165, a37
    v_accvgpr_read_b32 v166, a38
    v_accvgpr_read_b32 v167, a39
    s_waitcnt lgkmcnt(2)
    v_mul_f32 v160, v160, v168
    v_mul_f32 v161, v161, v169
    v_mul_f32 v162, v162, v170
    v_mul_f32 v163, v163, v171
    v_mfma_f32_32x32x16_bf16 v[208:223], a[4:7], v[112:115], v[208:223]
    ds_read_b64_tr_b16 a[28:29], v253 offset:33792
    ds_read_b64_tr_b16 a[30:31], v253 offset:34048
    buffer_store_dwordx4 v[180:183], v1, s[52:55], s80 offen offset:3072 sc1
    v_mul_f32 v164, v164, v172
    v_mul_f32 v165, v165, v173
    v_mul_f32 v166, v166, v174
    v_mul_f32 v167, v167, v175
    v_cvt_pk_bf16_f32 v160, v160, v161
    v_cvt_pk_bf16_f32 v161, v162, v163
    v_cvt_pk_bf16_f32 v162, v164, v165
    v_cvt_pk_bf16_f32 v163, v166, v167
    v_accvgpr_read_b32 v176, a40
    v_accvgpr_read_b32 v177, a41
    v_accvgpr_read_b32 v178, a42
    v_smfmac_f32_16x16x64_bf16 a[200:203], a[224:227], a[0:7], v30
    v_mfma_f32_32x32x16_bf16 v[192:207], a[8:11], v[116:119], v[192:207]
    s_barrier
    ds_read_b64_tr_b16 a[0:1], v250 offset:34816
    ds_read_b64_tr_b16 a[2:3], v250 offset:35072
    s_add_u32 m0, s73, 20480
    v_accvgpr_read_b32 v179, a43
    v_accvgpr_read_b32 v180, a44
    v_accvgpr_read_b32 v181, a45
    v_accvgpr_read_b32 v182, a46
    v_accvgpr_read_b32 v183, a47
    v_mul_f32 v176, v176, v184
    v_mul_f32 v177, v177, v185
    v_mul_f32 v178, v178, v186
    v_mul_f32 v179, v179, v187
    v_mul_f32 v180, v180, v188
    v_mfma_f32_32x32x16_bf16 v[208:223], a[12:15], v[116:119], v[208:223]
    ds_read_b64_tr_b16 a[4:5], v250 offset:35840
    ds_read_b64_tr_b16 a[6:7], v250 offset:36096
    buffer_store_dwordx4 v[160:163], v2, s[52:55], s50 offen offset:0 sc1
    v_mul_f32 v181, v181, v189
    v_mul_f32 v182, v182, v190
    v_mul_f32 v183, v183, v191
    v_cvt_pk_bf16_f32 v176, v176, v177
    v_cvt_pk_bf16_f32 v177, v178, v179
    v_cvt_pk_bf16_f32 v178, v180, v181
    v_cvt_pk_bf16_f32 v179, v182, v183
    v_accvgpr_read_b32 v160, a48
    v_accvgpr_read_b32 v161, a49
    v_accvgpr_read_b32 v162, a50
    v_accvgpr_read_b32 v163, a51
    v_mfma_f32_32x32x16_bf16 v[192:207], a[16:19], v[120:123], v[192:207]
    ds_read_b64_tr_b16 a[8:9], v250 offset:4096
    ds_read_b64_tr_b16 a[10:11], v250 offset:4352
    v_accvgpr_read_b32 v164, a52
    v_accvgpr_read_b32 v165, a53
    v_accvgpr_read_b32 v166, a54
    v_accvgpr_read_b32 v167, a55
    v_mul_f32 v160, v160, v168
    v_mul_f32 v161, v161, v169
    v_mul_f32 v162, v162, v170
    v_mul_f32 v163, v163, v171
    v_mul_f32 v164, v164, v172
    v_mul_f32 v165, v165, v173
    v_mul_f32 v166, v166, v174
    v_mul_f32 v167, v167, v175
    v_mfma_f32_32x32x16_bf16 v[208:223], a[20:23], v[120:123], v[208:223]
    ds_read_b64_tr_b16 a[12:13], v250 offset:5120
    ds_read_b64_tr_b16 a[14:15], v250 offset:5376
    buffer_store_dwordx4 v[176:179], v2, s[52:55], s50 offen offset:512 sc1
    v_cvt_pk_bf16_f32 v160, v160, v161
    v_cvt_pk_bf16_f32 v161, v162, v163
    v_cvt_pk_bf16_f32 v162, v164, v165
    v_cvt_pk_bf16_f32 v163, v166, v167
    v_accvgpr_read_b32 v176, a56
    v_accvgpr_read_b32 v177, a57
    v_accvgpr_read_b32 v178, a58
    v_accvgpr_read_b32 v179, a59
    v_accvgpr_read_b32 v180, a60
    v_accvgpr_read_b32 v181, a61
    v_accvgpr_read_b32 v182, a62
    s_waitcnt lgkmcnt(8)
    v_mfma_f32_32x32x16_bf16 v[192:207], a[24:27], v[124:127], v[192:207]
    ds_read_b64_tr_b16 a[16:17], v251 offset:34816
    ds_read_b64_tr_b16 a[18:19], v251 offset:35072
    buffer_store_dwordx4 v[160:163], v2, s[52:55], s50 offen offset:2048 sc1
    v_accvgpr_read_b32 v183, a63
    v_mul_f32 v176, v176, v184
    v_mul_f32 v177, v177, v185
    v_mul_f32 v178, v178, v186
    v_mul_f32 v179, v179, v187
    v_mul_f32 v180, v180, v188
    v_mul_f32 v181, v181, v189
    v_mul_f32 v182, v182, v190
    v_mul_f32 v183, v183, v191
    v_cvt_pk_bf16_f32 v176, v176, v177
    v_cvt_pk_bf16_f32 v177, v178, v179
    v_mfma_f32_32x32x16_bf16 v[208:223], a[28:31], v[124:127], v[208:223]
    ds_read_b64_tr_b16 a[20:21], v251 offset:35840
    ds_read_b64_tr_b16 a[22:23], v251 offset:36096
    v_cvt_pk_bf16_f32 v178, v180, v181
    v_cvt_pk_bf16_f32 v179, v182, v183
    v_mul_f32 v18, v31, v31
    v_mul_f32 v19, v31, v31
    s_waitcnt lgkmcnt(8)
    v_mfma_f32_32x32x16_bf16 v[192:207], a[0:3], v[128:131], v[192:207]
    ds_read_b64_tr_b16 a[24:25], v252 offset:34816
    ds_read_b64_tr_b16 a[26:27], v252 offset:35072
    buffer_store_dwordx4 v[176:179], v2, s[52:55], s50 offen offset:2560 sc1
    s_lshl2_add_u32 s74, s3, s72
    s_lshl_b32 s74, s74, 10
    s_mul_i32 s38, s100, 327680
    v_mfma_f32_32x32x16_bf16 v[208:223], a[4:7], v[128:131], v[208:223]
    ds_read_b64_tr_b16 a[28:29], v252 offset:35840
    ds_read_b64_tr_b16 a[30:31], v252 offset:36096
    buffer_load_dwordx4 v5, s[40:43], s70 offen lds
    s_add_u32 s38, s38, s74
    s_add_u32 s38, s38, 0x820000
    s_add_u32 s39, s38, 163840
    v_smfmac_f32_16x16x64_bf16 a[200:203], a[224:227], a[0:7], v30
    s_waitcnt lgkmcnt(8)
    v_mfma_f32_32x32x16_bf16 v[192:207], a[8:11], v[144:147], v[192:207]
    ds_read_b64_tr_b16 a[0:1], v253 offset:34816
    ds_read_b64_tr_b16 a[2:3], v253 offset:35072
    v_mov_b32 v188, -1
    v_mov_b32 v189, -1
    v_mov_b32 v190, -1
    v_mov_b32 v191, -1
    v_mfma_f32_32x32x16_bf16 v[208:223], a[12:15], v[144:147], v[208:223]
    ds_read_b64_tr_b16 a[4:5], v253 offset:35840
    ds_read_b64_tr_b16 a[6:7], v253 offset:36096
    buffer_store_dwordx4 v[188:191], v1, s[52:55], s38 offen offset:0 sc1
    s_mul_i32 s75, s100, 196608
    s_add_i32 s28, s75, -786432
    s_max_i32 s28, s28, 0
    v_smfmac_f32_16x16x64_bf16 a[200:203], a[224:227], a[8:15], v30
    s_waitcnt lgkmcnt(8)
    v_mfma_f32_32x32x16_bf16 v[192:207], a[16:19], v[132:135], v[192:207]
    ds_read_b64_tr_b16 a[8:9], v251 offset:4096
    ds_read_b64_tr_b16 a[10:11], v251 offset:4352
    s_add_u32 s28, s28, s74
    s_add_i32 s29, s75, -688128
    s_max_i32 s29, s29, 0
    s_add_u32 s29, s29, s74
    v_mfma_f32_32x32x16_bf16 v[208:223], a[20:23], v[132:135], v[208:223]
    ds_read_b64_tr_b16 a[12:13], v251 offset:5120
    ds_read_b64_tr_b16 a[14:15], v251 offset:5376
    s_lshl_b32 s101, s72, 2
    v_add_u32 v244, s101, v1
    v_accvgpr_read_b32 v240, a200
    v_accvgpr_read_b32 v241, a201
    v_add_f32 v240, v240, v241
    v_cvt_pk_bf16_f32 v241, v240, v240
    v_lshlrev_b32 v241, 16, v241
    s_waitcnt lgkmcnt(8)
    v_mfma_f32_32x32x16_bf16 v[192:207], a[24:27], v[136:139], v[192:207]
    ds_read_b64_tr_b16 a[16:17], v252 offset:4096
    ds_read_b64_tr_b16 a[18:19], v252 offset:4352
    v_sub_f32 v241, v240, v241
    v_cvt_pk_bf16_f32 v240, v240, v241
    ds_write_b32 v244, v240 offset:38912
    s_add_i32 s30, s75, -589824
    s_max_i32 s30, s30, 0
    s_add_u32 s30, s30, s74
    s_add_i32 s31, s75, -491520
    v_mfma_f32_32x32x16_bf16 v[208:223], a[28:31], v[136:139], v[208:223]
    ds_read_b64_tr_b16 a[20:21], v252 offset:5120
    ds_read_b64_tr_b16 a[22:23], v252 offset:5376
    buffer_store_dwordx4 v[188:191], v1, s[52:55], s39 offen offset:0 sc1
    s_max_i32 s31, s31, 0
    s_add_u32 s31, s31, s74
    s_add_i32 s32, s75, -393216
    s_waitcnt lgkmcnt(9)
    v_mfma_f32_32x32x16_bf16 v[192:207], a[0:3], v[140:143], v[192:207]
    ds_read_b64_tr_b16 a[24:25], v253 offset:4096
    ds_read_b64_tr_b16 a[26:27], v253 offset:4352
    buffer_load_dwordx4 v6, s[40:43], s70 offen offset:1024 lds
    s_add_u32 m0, s73, 12288
    s_max_i32 s32, s32, 0
    s_add_u32 s32, s32, s74
    v_mfma_f32_32x32x16_bf16 v[208:223], a[4:7], v[140:143], v[208:223]
    ds_read_b64_tr_b16 a[28:29], v253 offset:5120
    ds_read_b64_tr_b16 a[30:31], v253 offset:5376
    s_add_i32 s33, s75, -294912
    s_max_i32 s33, s33, 0
    s_add_u32 s33, s33, s74
    s_add_i32 s34, s75, -196608
    s_waitcnt lgkmcnt(9)
    v_mfma_f32_32x32x16_bf16 v[192:207], a[8:11], v[148:151], v[192:207]
    s_waitcnt vmcnt(20) lgkmcnt(6)
    s_barrier
    ds_read_b128 a[232:235], v1 offset:38912
    ds_read_b64_tr_b16 a[0:1], v7 offset:6144
    ds_read_b64_tr_b16 a[2:3], v7 offset:6656
    v_mfma_f32_32x32x16_bf16 v[208:223], a[12:15], v[148:151], v[208:223]
    ds_read_b64_tr_b16 a[4:5], v8 offset:6144
    ds_read_b64_tr_b16 a[6:7], v8 offset:6656
    buffer_load_dwordx4 v5, s[40:43], s71 offen lds
    s_max_i32 s34, s34, 0
    s_add_u32 s34, s34, s74
    s_add_i32 s35, s75, -98304
    s_waitcnt lgkmcnt(9)
    v_mfma_f32_32x32x16_bf16 v[192:207], a[16:19], v[152:155], v[192:207]
    ds_read_b64_tr_b16 a[8:9], v9 offset:6144
    ds_read_b64_tr_b16 a[10:11], v9 offset:6656
    buffer_load_dwordx4 v6, s[40:43], s71 offen offset:1024 lds
    s_add_u32 m0, s73, 14336
    s_max_i32 s35, s35, 0
    s_add_u32 s35, s35, s74
    v_mfma_f32_32x32x16_bf16 v[208:223], a[20:23], v[152:155], v[208:223]
    ds_read_b64_tr_b16 a[12:13], v10 offset:6144
    ds_read_b64_tr_b16 a[14:15], v10 offset:6656
    s_add_i32 s36, s75, 0
    s_add_u32 s36, s36, s74
    s_add_i32 s37, s75, 98304
    s_add_u32 s37, s37, s74
    s_waitcnt lgkmcnt(9)
    v_mfma_f32_32x32x16_bf16 v[192:207], a[24:27], v[156:159], v[192:207]
    ds_read_b64_tr_b16 a[16:17], v11 offset:6144
    ds_read_b64_tr_b16 a[18:19], v11 offset:6656
    buffer_load_dwordx4 v5, s[44:47], s64 offen lds
    s_mov_b32 s78, 0xffff
    s_mov_b32 s79, 0xffff
    v_accvgpr_read_b32 v3, a248
    v_mfma_f32_32x32x16_bf16 v[208:223], a[28:31], v[156:159], v[208:223]
    ds_read_b64_tr_b16 a[20:21], v12 offset:6144
    ds_read_b64_tr_b16 a[22:23], v12 offset:6656
    buffer_load_dwordx4 v6, s[44:47], s64 offen offset:1024 lds
    s_add_u32 m0, s73, 22528
    v_accvgpr_read_b32 v4, a249
    v_accvgpr_read_b32 v20, a250
    s_waitcnt lgkmcnt(12)
    v_mfma_f32_32x32x16_bf16 v[192:207], a[232:235], a[240:243], v[192:207]
    v_mfma_f32_32x32x16_bf16 v[208:223], a[232:235], a[244:247], v[208:223]
    s_waitcnt lgkmcnt(8)
    v_mfma_f32_32x32x16_bf16 v[224:239], a[0:3], v[32:35], 0
    ds_read_b64_tr_b16 a[24:25], v13 offset:6144
    ds_read_b64_tr_b16 a[26:27], v13 offset:6656
    v_mov_b32 v21, 0xf149f2ca
    v_mfma_f32_32x32x16_bf16 v[240:255], a[4:7], v[32:35], 0
    ds_read_b64_tr_b16 a[28:29], v14 offset:6144
    ds_read_b64_tr_b16 a[30:31], v14 offset:6656
    buffer_load_dwordx4 v5, s[44:47], s65 offen lds
    v_smfmac_f32_16x16x64_bf16 a[204:207], a[224:227], a[0:7], v30
    s_waitcnt lgkmcnt(8)
    v_mfma_f32_32x32x16_bf16 v[224:239], a[8:11], v[36:39], v[224:239]
    ds_read_b64_tr_b16 a[0:1], v7 offset:36864
    ds_read_b64_tr_b16 a[2:3], v7 offset:37376
    v_mfma_f32_32x32x16_bf16 v[240:255], a[12:15], v[36:39], v[240:255]
    ds_read_b64_tr_b16 a[4:5], v8 offset:36864
    ds_read_b64_tr_b16 a[6:7], v8 offset:37376
    buffer_load_dwordx4 v6, s[44:47], s65 offen offset:1024 lds
    v_mul_f32 v192, v192, v18
    v_mul_f32 v193, v193, v18
    v_mul_f32 v194, v194, v18
    s_waitcnt lgkmcnt(8)
    v_mfma_f32_32x32x16_bf16 v[224:239], a[16:19], v[40:43], v[224:239]
    ds_read_b64_tr_b16 a[8:9], v9 offset:36864
    ds_read_b64_tr_b16 a[10:11], v9 offset:37376
    v_mul_f32 v195, v195, v18
    v_mul_f32 v196, v196, v18
    v_mul_f32 v197, v197, v18
    v_mul_f32 v198, v198, v18
    v_mfma_f32_32x32x16_bf16 v[240:255], a[20:23], v[40:43], v[240:255]
    ds_read_b64_tr_b16 a[12:13], v10 offset:36864
    ds_read_b64_tr_b16 a[14:15], v10 offset:37376
    v_mul_f32 v199, v199, v18
    v_mul_f32 v200, v200, v18
    v_mul_f32 v201, v201, v18
    v_mul_f32 v202, v202, v18
    s_waitcnt lgkmcnt(8)
    v_mfma_f32_32x32x16_bf16 v[224:239], a[24:27], v[44:47], v[224:239]
    ds_read_b64_tr_b16 a[16:17], v11 offset:36864
    ds_read_b64_tr_b16 a[18:19], v11 offset:37376
    v_mul_f32 v203, v203, v18
    v_mul_f32 v204, v204, v18
    v_mul_f32 v205, v205, v18
    v_mul_f32 v206, v206, v18
    v_mfma_f32_32x32x16_bf16 v[240:255], a[28:31], v[44:47], v[240:255]
    ds_read_b64_tr_b16 a[20:21], v12 offset:36864
    ds_read_b64_tr_b16 a[22:23], v12 offset:37376
    v_mul_f32 v207, v207, v18
    v_mul_f32 v192, v192, v208
    v_mul_f32 v193, v193, v209
    v_mul_f32 v194, v194, v210
    s_waitcnt lgkmcnt(8)
    v_mfma_f32_32x32x16_bf16 v[224:239], a[0:3], v[48:51], v[224:239]
    ds_read_b64_tr_b16 a[24:25], v13 offset:36864
    ds_read_b64_tr_b16 a[26:27], v13 offset:37376
    s_waitcnt vmcnt(10)
    s_add_u32 s83, s0, 0x1800000
    s_mov_b64 exec, 1
    buffer_store_dwordx2 v[28:29], off, s[52:55], s83 sc1
    s_mov_b64 exec, -1
    v_mfma_f32_32x32x16_bf16 v[240:255], a[4:7], v[48:51], v[240:255]
    ds_read_b64_tr_b16 a[28:29], v14 offset:36864
    ds_read_b64_tr_b16 a[30:31], v14 offset:37376
    v_mul_f32 v195, v195, v211
    v_mul_f32 v196, v196, v212
    v_mul_f32 v197, v197, v213
    v_mul_f32 v198, v198, v214
    v_smfmac_f32_16x16x64_bf16 a[204:207], a[224:227], a[0:7], v30
    s_waitcnt lgkmcnt(8)
    v_mfma_f32_32x32x16_bf16 v[224:239], a[8:11], v[52:55], v[224:239]
    s_barrier
    ds_read_b64_tr_b16 a[0:1], v7 offset:16384
    ds_read_b64_tr_b16 a[2:3], v7 offset:16896
    s_add_u32 m0, s73, 24576
    v_mul_f32 v199, v199, v215
    v_mul_f32 v200, v200, v216
    v_mfma_f32_32x32x16_bf16 v[240:255], a[12:15], v[52:55], v[240:255]
    ds_read_b64_tr_b16 a[4:5], v8 offset:16384
    ds_read_b64_tr_b16 a[6:7], v8 offset:16896
    buffer_load_dwordx4 v5, s[44:47], s66 offen lds
    v_mul_f32 v201, v201, v217
    v_mul_f32 v202, v202, v218
    v_mul_f32 v203, v203, v219
    s_waitcnt lgkmcnt(8)
    v_mfma_f32_32x32x16_bf16 v[224:239], a[16:19], v[56:59], v[224:239]
    ds_read_b64_tr_b16 a[8:9], v9 offset:16384
    ds_read_b64_tr_b16 a[10:11], v9 offset:16896
    buffer_load_dwordx4 v6, s[44:47], s66 offen offset:1024 lds
    s_add_u32 m0, s73, 26624
    v_mul_f32 v204, v204, v220
    v_mul_f32 v205, v205, v221
    v_mfma_f32_32x32x16_bf16 v[240:255], a[20:23], v[56:59], v[240:255]
    ds_read_b64_tr_b16 a[12:13], v10 offset:16384
    ds_read_b64_tr_b16 a[14:15], v10 offset:16896
    v_mul_f32 v206, v206, v222
    v_mul_f32 v207, v207, v223
    v_cvt_pk_bf16_f32 v192, v192, v193
    v_cvt_pk_bf16_f32 v193, v194, v195
    s_waitcnt lgkmcnt(8)
    v_mfma_f32_32x32x16_bf16 v[224:239], a[24:27], v[60:63], v[224:239]
    ds_read_b64_tr_b16 a[16:17], v11 offset:16384
    ds_read_b64_tr_b16 a[18:19], v11 offset:16896
    buffer_load_dwordx4 v5, s[44:47], s67 offen lds
    v_cvt_pk_bf16_f32 v194, v196, v197
    v_cvt_pk_bf16_f32 v195, v198, v199
    v_cvt_pk_bf16_f32 v196, v200, v201
    v_mfma_f32_32x32x16_bf16 v[240:255], a[28:31], v[60:63], v[240:255]
    ds_read_b64_tr_b16 a[20:21], v12 offset:16384
    ds_read_b64_tr_b16 a[22:23], v12 offset:16896
    buffer_store_dwordx4 v[192:195], v1, s[52:55], s82 offen offset:0 sc1
    v_cvt_pk_bf16_f32 v197, v202, v203
    v_cvt_pk_bf16_f32 v198, v204, v205
    v_cvt_pk_bf16_f32 v199, v206, v207
    s_waitcnt lgkmcnt(8)
    v_mfma_f32_32x32x16_bf16 v[224:239], a[0:3], v[64:67], v[224:239]
    ds_read_b64_tr_b16 a[24:25], v13 offset:16384
    ds_read_b64_tr_b16 a[26:27], v13 offset:16896
    v_mfma_f32_32x32x16_bf16 v[240:255], a[4:7], v[64:67], v[240:255]
    ds_read_b64_tr_b16 a[28:29], v14 offset:16384
    ds_read_b64_tr_b16 a[30:31], v14 offset:16896
    buffer_store_dwordx4 v[196:199], v1, s[52:55], s82 offen offset:1024 sc1
    v_cmp_le_i32 s[56:57], 0, v20
    v_cmp_le_i32 s[58:59], 1, v20
    v_cmp_le_i32 s[60:61], 2, v20
    v_smfmac_f32_16x16x64_bf16 a[204:207], a[224:227], a[0:7], v30
    s_waitcnt lgkmcnt(8)
    v_mfma_f32_32x32x16_bf16 v[224:239], a[8:11], v[68:71], v[224:239]
    ds_read_b64_tr_b16 a[0:1], v7 offset:8192
    ds_read_b64_tr_b16 a[2:3], v7 offset:8704
    v_cndmask_b32 v192, v21, 0, s[56:57]
    v_cndmask_b32 v208, 0, v21, s[56:57]
    v_cmp_le_i32 s[62:63], 3, v20
    v_cndmask_b32 v193, v21, 0, s[58:59]
    v_mfma_f32_32x32x16_bf16 v[240:255], a[12:15], v[68:71], v[240:255]
    ds_read_b64_tr_b16 a[4:5], v8 offset:8192
    ds_read_b64_tr_b16 a[6:7], v8 offset:8704
    buffer_load_dwordx4 v6, s[44:47], s67 offen offset:1024 lds
    v_cndmask_b32 v209, 0, v21, s[58:59]
    v_cmp_le_i32 s[56:57], 8, v20
    v_cndmask_b32 v194, v21, 0, s[60:61]
    s_waitcnt lgkmcnt(8)
    v_mfma_f32_32x32x16_bf16 v[224:239], a[16:19], v[72:75], v[224:239]
    ds_read_b64_tr_b16 a[8:9], v9 offset:8192
    ds_read_b64_tr_b16 a[10:11], v9 offset:8704
    v_cndmask_b32 v210, 0, v21, s[60:61]
    v_cmp_le_i32 s[58:59], 9, v20
    v_cndmask_b32 v195, v21, 0, s[62:63]
    v_cndmask_b32 v211, 0, v21, s[62:63]
    v_mfma_f32_32x32x16_bf16 v[240:255], a[20:23], v[72:75], v[240:255]
    ds_read_b64_tr_b16 a[12:13], v10 offset:8192
    ds_read_b64_tr_b16 a[14:15], v10 offset:8704
    v_cmp_le_i32 s[60:61], 10, v20
    v_cndmask_b32 v196, v21, 0, s[56:57]
    v_cndmask_b32 v212, 0, v21, s[56:57]
    v_cmp_le_i32 s[62:63], 11, v20
    s_waitcnt lgkmcnt(8)
    v_mfma_f32_32x32x16_bf16 v[224:239], a[24:27], v[76:79], v[224:239]
    ds_read_b64_tr_b16 a[16:17], v11 offset:8192
    ds_read_b64_tr_b16 a[18:19], v11 offset:8704
    v_cndmask_b32 v197, v21, 0, s[58:59]
    v_cndmask_b32 v213, 0, v21, s[58:59]
    v_cmp_le_i32 s[56:57], 16, v20
    v_cndmask_b32 v198, v21, 0, s[60:61]
    v_mfma_f32_32x32x16_bf16 v[240:255], a[28:31], v[76:79], v[240:255]
    ds_read_b64_tr_b16 a[20:21], v12 offset:8192
    ds_read_b64_tr_b16 a[22:23], v12 offset:8704
    v_cndmask_b32 v214, 0, v21, s[60:61]
    v_cmp_le_i32 s[58:59], 17, v20
    v_cndmask_b32 v199, v21, 0, s[62:63]
    v_cndmask_b32 v215, 0, v21, s[62:63]
    s_waitcnt lgkmcnt(8)
    v_mfma_f32_32x32x16_bf16 v[224:239], a[0:3], v[80:83], v[224:239]
    ds_read_b64_tr_b16 a[24:25], v13 offset:8192
    ds_read_b64_tr_b16 a[26:27], v13 offset:8704
    v_cmp_le_i32 s[60:61], 18, v20
    v_cndmask_b32 v200, v21, 0, s[56:57]
    v_cndmask_b32 v216, 0, v21, s[56:57]
    v_cmp_le_i32 s[62:63], 19, v20
    v_mfma_f32_32x32x16_bf16 v[240:255], a[4:7], v[80:83], v[240:255]
    ds_read_b64_tr_b16 a[28:29], v14 offset:8192
    ds_read_b64_tr_b16 a[30:31], v14 offset:8704
    v_cndmask_b32 v201, v21, 0, s[58:59]
    v_cndmask_b32 v217, 0, v21, s[58:59]
    v_cmp_le_i32 s[56:57], 24, v20
    v_cndmask_b32 v202, v21, 0, s[60:61]
    v_smfmac_f32_16x16x64_bf16 a[204:207], a[224:227], a[0:7], v30
    s_waitcnt lgkmcnt(8)
    v_mfma_f32_32x32x16_bf16 v[224:239], a[8:11], v[84:87], v[224:239]
    s_barrier
    ds_read_b64_tr_b16 a[0:1], v7 offset:10240
    ds_read_b64_tr_b16 a[2:3], v7 offset:10752
    s_add_u32 m0, s73, 28672
    v_cndmask_b32 v218, 0, v21, s[60:61]
    v_cmp_le_i32 s[58:59], 25, v20
    v_mfma_f32_32x32x16_bf16 v[240:255], a[12:15], v[84:87], v[240:255]
    ds_read_b64_tr_b16 a[4:5], v8 offset:10240
    ds_read_b64_tr_b16 a[6:7], v8 offset:10752
    buffer_load_dwordx4 v5, s[44:47], s68 offen lds
    v_cndmask_b32 v203, v21, 0, s[62:63]
    v_cndmask_b32 v219, 0, v21, s[62:63]
    v_cmp_le_i32 s[60:61], 26, v20
    s_waitcnt lgkmcnt(8)
    v_mfma_f32_32x32x16_bf16 v[224:239], a[16:19], v[88:91], v[224:239]
    ds_read_b64_tr_b16 a[8:9], v9 offset:10240
    ds_read_b64_tr_b16 a[10:11], v9 offset:10752
    buffer_load_dwordx4 v6, s[44:47], s68 offen offset:1024 lds
    s_add_u32 m0, s73, 30720
    v_cndmask_b32 v204, v21, 0, s[56:57]
    v_cndmask_b32 v220, 0, v21, s[56:57]
    v_mfma_f32_32x32x16_bf16 v[240:255], a[20:23], v[88:91], v[240:255]
    ds_read_b64_tr_b16 a[12:13], v10 offset:10240
    ds_read_b64_tr_b16 a[14:15], v10 offset:10752
    v_cmp_le_i32 s[62:63], 27, v20
    v_cndmask_b32 v205, v21, 0, s[58:59]
    v_cndmask_b32 v221, 0, v21, s[58:59]
    v_cndmask_b32 v206, v21, 0, s[60:61]
    s_waitcnt lgkmcnt(8)
    v_mfma_f32_32x32x16_bf16 v[224:239], a[24:27], v[92:95], v[224:239]
    ds_read_b64_tr_b16 a[16:17], v11 offset:10240
    ds_read_b64_tr_b16 a[18:19], v11 offset:10752
    buffer_load_dwordx4 v5, s[44:47], s69 offen lds
    v_cndmask_b32 v222, 0, v21, s[60:61]
    v_cndmask_b32 v207, v21, 0, s[62:63]
    v_cndmask_b32 v223, 0, v21, s[62:63]
    v_mfma_f32_32x32x16_bf16 v[240:255], a[28:31], v[92:95], v[240:255]
    ds_read_b64_tr_b16 a[20:21], v12 offset:10240
    ds_read_b64_tr_b16 a[22:23], v12 offset:10752
    buffer_load_dwordx4 v6, s[44:47], s69 offen offset:1024 lds
    s_waitcnt lgkmcnt(8)
    v_mfma_f32_32x32x16_bf16 v[224:239], a[0:3], v[96:99], v[224:239]
    ds_read_b64_tr_b16 a[24:25], v13 offset:10240
    ds_read_b64_tr_b16 a[26:27], v13 offset:10752
    v_mfma_f32_32x32x16_bf16 v[240:255], a[4:7], v[96:99], v[240:255]
    ds_read_b64_tr_b16 a[28:29], v14 offset:10240
    ds_read_b64_tr_b16 a[30:31], v14 offset:10752
    v_smfmac_f32_16x16x64_bf16 a[204:207], a[224:227], a[0:7], v30
    s_waitcnt lgkmcnt(8)
    v_mfma_f32_32x32x16_bf16 v[224:239], a[8:11], v[100:103], v[224:239]
    ds_read_b64_tr_b16 a[0:1], v7 offset:18432
    ds_read_b64_tr_b16 a[2:3], v7 offset:18944
    v_mfma_f32_32x32x16_bf16 v[240:255], a[12:15], v[100:103], v[240:255]
    ds_read_b64_tr_b16 a[4:5], v8 offset:18432
    ds_read_b64_tr_b16 a[6:7], v8 offset:18944
    s_waitcnt lgkmcnt(8)
    v_mfma_f32_32x32x16_bf16 v[224:239], a[16:19], v[104:107], v[224:239]
    ds_read_b64_tr_b16 a[8:9], v9 offset:18432
    ds_read_b64_tr_b16 a[10:11], v9 offset:18944
    v_mfma_f32_32x32x16_bf16 v[240:255], a[20:23], v[104:107], v[240:255]
    ds_read_b64_tr_b16 a[12:13], v10 offset:18432
    ds_read_b64_tr_b16 a[14:15], v10 offset:18944
    s_waitcnt lgkmcnt(8)
    v_mfma_f32_32x32x16_bf16 v[224:239], a[24:27], v[108:111], v[224:239]
    ds_read_b64_tr_b16 a[16:17], v11 offset:18432
    ds_read_b64_tr_b16 a[18:19], v11 offset:18944
    v_mfma_f32_32x32x16_bf16 v[240:255], a[28:31], v[108:111], v[240:255]
    ds_read_b64_tr_b16 a[20:21], v12 offset:18432
    ds_read_b64_tr_b16 a[22:23], v12 offset:18944
    s_waitcnt lgkmcnt(8)
    v_mfma_f32_32x32x16_bf16 v[224:239], a[0:3], v[112:115], v[224:239]
    ds_read_b64_tr_b16 a[24:25], v13 offset:18432
    ds_read_b64_tr_b16 a[26:27], v13 offset:18944
    v_mfma_f32_32x32x16_bf16 v[240:255], a[4:7], v[112:115], v[240:255]
    ds_read_b64_tr_b16 a[28:29], v14 offset:18432
    ds_read_b64_tr_b16 a[30:31], v14 offset:18944
    v_smfmac_f32_16x16x64_bf16 a[204:207], a[224:227], a[0:7], v30
    s_waitcnt lgkmcnt(8)
    v_mfma_f32_32x32x16_bf16 v[224:239], a[8:11], v[116:119], v[224:239]
    s_waitcnt vmcnt(15)
    s_barrier
    ds_read_b64_tr_b16 a[0:1], v7 offset:20480
    ds_read_b64_tr_b16 a[2:3], v7 offset:20992
    s_add_u32 m0, s73, 0
    v_mfma_f32_32x32x16_bf16 v[240:255], a[12:15], v[116:119], v[240:255]
    ds_read_b64_tr_b16 a[4:5], v8 offset:20480
    ds_read_b64_tr_b16 a[6:7], v8 offset:20992
    buffer_load_dwordx4 v5, s[44:47], s70 offen lds
    s_waitcnt lgkmcnt(8)
    v_mfma_f32_32x32x16_bf16 v[224:239], a[16:19], v[120:123], v[224:239]
    ds_read_b64_tr_b16 a[8:9], v7 offset:12288
    ds_read_b64_tr_b16 a[10:11], v7 offset:12800
    buffer_load_dwordx4 v6, s[44:47], s70 offen offset:1024 lds
    s_add_u32 m0, s73, 2048
    v_mfma_f32_32x32x16_bf16 v[240:255], a[20:23], v[120:123], v[240:255]
    ds_read_b64_tr_b16 a[12:13], v8 offset:12288
    ds_read_b64_tr_b16 a[14:15], v8 offset:12800
    s_waitcnt lgkmcnt(8)
    v_mfma_f32_32x32x16_bf16 v[224:239], a[24:27], v[124:127], v[224:239]
    ds_read_b64_tr_b16 a[16:17], v9 offset:20480
    ds_read_b64_tr_b16 a[18:19], v9 offset:20992
    buffer_load_dwordx4 v5, s[44:47], s71 offen lds
    v_mfma_f32_32x32x16_bf16 v[240:255], a[28:31], v[124:127], v[240:255]
    ds_read_b64_tr_b16 a[20:21], v10 offset:20480
    ds_read_b64_tr_b16 a[22:23], v10 offset:20992
    buffer_load_dwordx4 v6, s[44:47], s71 offen offset:1024 lds
    s_waitcnt lgkmcnt(8)
    v_mfma_f32_32x32x16_bf16 v[224:239], a[0:3], v[128:131], v[224:239]
    ds_read_b64_tr_b16 a[24:25], v11 offset:20480
    ds_read_b64_tr_b16 a[26:27], v11 offset:20992
    v_mfma_f32_32x32x16_bf16 v[240:255], a[4:7], v[128:131], v[240:255]
    ds_read_b64_tr_b16 a[28:29], v12 offset:20480
    ds_read_b64_tr_b16 a[30:31], v12 offset:20992
    v_smfmac_f32_16x16x64_bf16 a[204:207], a[224:227], a[0:7], v30
    s_waitcnt lgkmcnt(8)
    v_mfma_f32_32x32x16_bf16 v[224:239], a[8:11], v[144:147], v[224:239]
    ds_read_b64_tr_b16 a[0:1], v13 offset:20480
    ds_read_b64_tr_b16 a[2:3], v13 offset:20992
    v_mfma_f32_32x32x16_bf16 v[240:255], a[12:15], v[144:147], v[240:255]
    ds_read_b64_tr_b16 a[4:5], v14 offset:20480
    ds_read_b64_tr_b16 a[6:7], v14 offset:20992
    v_smfmac_f32_16x16x64_bf16 a[204:207], a[224:227], a[8:15], v30
    s_waitcnt lgkmcnt(8)
    v_mfma_f32_32x32x16_bf16 v[224:239], a[16:19], v[132:135], v[224:239]
    ds_read_b64_tr_b16 a[8:9], v9 offset:12288
    ds_read_b64_tr_b16 a[10:11], v9 offset:12800
    v_mfma_f32_32x32x16_bf16 v[240:255], a[20:23], v[132:135], v[240:255]
    ds_read_b64_tr_b16 a[12:13], v10 offset:12288
    ds_read_b64_tr_b16 a[14:15], v10 offset:12800
    s_lshl_b32 s101, s72, 2
    v_add_u32 v15, s101, v1
    v_accvgpr_read_b32 v16, a204
    v_accvgpr_read_b32 v17, a205
    v_add_f32 v16, v16, v17
    v_cvt_pk_bf16_f32 v17, v16, v16
    v_lshlrev_b32 v17, 16, v17
    s_waitcnt lgkmcnt(8)
    v_mfma_f32_32x32x16_bf16 v[224:239], a[24:27], v[136:139], v[224:239]
    ds_read_b64_tr_b16 a[16:17], v11 offset:12288
    ds_read_b64_tr_b16 a[18:19], v11 offset:12800
    v_sub_f32 v17, v16, v17
    v_cvt_pk_bf16_f32 v16, v16, v17
    ds_write_b32 v15, v16 offset:38912
    v_mfma_f32_32x32x16_bf16 v[240:255], a[28:31], v[136:139], v[240:255]
    ds_read_b64_tr_b16 a[20:21], v12 offset:12288
    ds_read_b64_tr_b16 a[22:23], v12 offset:12800
    s_waitcnt lgkmcnt(9)
    v_mfma_f32_32x32x16_bf16 v[224:239], a[0:3], v[140:143], v[224:239]
    ds_read_b64_tr_b16 a[24:25], v13 offset:12288
    ds_read_b64_tr_b16 a[26:27], v13 offset:12800
    v_mfma_f32_32x32x16_bf16 v[240:255], a[4:7], v[140:143], v[240:255]
    ds_read_b64_tr_b16 a[28:29], v14 offset:12288
    ds_read_b64_tr_b16 a[30:31], v14 offset:12800
    s_waitcnt vmcnt(9)
    s_add_u32 s83, s0, 0x1820000
    s_mov_b64 exec, 1
    buffer_store_dwordx2 v[28:29], off, s[52:55], s83 sc1
    s_mov_b64 exec, -1
    s_waitcnt lgkmcnt(9)
    v_mfma_f32_32x32x16_bf16 v[224:239], a[8:11], v[148:151], v[224:239]
    s_waitcnt lgkmcnt(6)
    s_barrier
    ds_read_b128 a[232:235], v1 offset:38912
    ds_read_b64_tr_b16 a[0:1], v7 offset:14336
    ds_read_b64_tr_b16 a[2:3], v7 offset:14848
    v_mfma_f32_32x32x16_bf16 v[240:255], a[12:15], v[148:151], v[240:255]
    ds_read_b64_tr_b16 a[4:5], v8 offset:14336
    ds_read_b64_tr_b16 a[6:7], v8 offset:14848
    s_waitcnt lgkmcnt(9)
    v_mfma_f32_32x32x16_bf16 v[224:239], a[16:19], v[152:155], v[224:239]
    ds_read_b64_tr_b16 a[8:9], v9 offset:14336
    ds_read_b64_tr_b16 a[10:11], v9 offset:14848
    v_mfma_f32_32x32x16_bf16 v[240:255], a[20:23], v[152:155], v[240:255]
    ds_read_b64_tr_b16 a[12:13], v10 offset:14336
    ds_read_b64_tr_b16 a[14:15], v10 offset:14848
    s_waitcnt lgkmcnt(9)
    v_mfma_f32_32x32x16_bf16 v[224:239], a[24:27], v[156:159], v[224:239]
    ds_read_b64_tr_b16 a[16:17], v11 offset:14336
    ds_read_b64_tr_b16 a[18:19], v11 offset:14848
    v_mfma_f32_32x32x16_bf16 v[240:255], a[28:31], v[156:159], v[240:255]
    ds_read_b64_tr_b16 a[20:21], v12 offset:14336
    ds_read_b64_tr_b16 a[22:23], v12 offset:14848
    s_waitcnt lgkmcnt(12)
    v_mfma_f32_32x32x16_bf16 v[224:239], a[232:235], a[240:243], v[224:239]
    v_mfma_f32_32x32x16_bf16 v[240:255], a[232:235], a[244:247], v[240:255]
    s_waitcnt lgkmcnt(8)
    v_mfma_f32_32x32x16_bf16 v[160:175], a[0:3], v[32:35], 0
    ds_read_b64_tr_b16 a[24:25], v13 offset:14336
    ds_read_b64_tr_b16 a[26:27], v13 offset:14848
    s_mov_b32 s83, 0x1800000
    buffer_load_dwordx2 v[26:27], v3, s[52:55], s83 offen
    v_mfma_f32_32x32x16_bf16 v[176:191], a[4:7], v[32:35], 0
    ds_read_b64_tr_b16 a[28:29], v14 offset:14336
    ds_read_b64_tr_b16 a[30:31], v14 offset:14848
    v_smfmac_f32_16x16x64_bf16 a[208:211], a[224:227], a[0:7], v30
    s_waitcnt lgkmcnt(8)
    v_mfma_f32_32x32x16_bf16 v[160:175], a[8:11], v[36:39], v[160:175]
    ds_read_b64_tr_b16 a[0:1], v7 offset:22528
    ds_read_b64_tr_b16 a[2:3], v7 offset:23040
    v_mfma_f32_32x32x16_bf16 v[176:191], a[12:15], v[36:39], v[176:191]
    ds_read_b64_tr_b16 a[4:5], v8 offset:22528
    ds_read_b64_tr_b16 a[6:7], v8 offset:23040
    v_mul_f32 v224, v224, v18
    v_mul_f32 v225, v225, v18
    v_mul_f32 v226, v226, v18
    s_waitcnt lgkmcnt(8)
    v_mfma_f32_32x32x16_bf16 v[160:175], a[16:19], v[40:43], v[160:175]
    ds_read_b64_tr_b16 a[8:9], v9 offset:22528
    ds_read_b64_tr_b16 a[10:11], v9 offset:23040
    v_mul_f32 v227, v227, v18
    v_mul_f32 v228, v228, v18
    v_mul_f32 v229, v229, v18
    v_mfma_f32_32x32x16_bf16 v[176:191], a[20:23], v[40:43], v[176:191]
    ds_read_b64_tr_b16 a[12:13], v10 offset:22528
    ds_read_b64_tr_b16 a[14:15], v10 offset:23040
    v_mul_f32 v230, v230, v18
    v_mul_f32 v231, v231, v18
    v_mul_f32 v232, v232, v18
    s_waitcnt lgkmcnt(8)
    v_mfma_f32_32x32x16_bf16 v[160:175], a[24:27], v[44:47], v[160:175]
    ds_read_b64_tr_b16 a[16:17], v11 offset:22528
    ds_read_b64_tr_b16 a[18:19], v11 offset:23040
    v_mul_f32 v233, v233, v18
    v_mul_f32 v234, v234, v18
    v_mul_f32 v235, v235, v18
    v_mfma_f32_32x32x16_bf16 v[176:191], a[28:31], v[44:47], v[176:191]
    ds_read_b64_tr_b16 a[20:21], v12 offset:22528
    ds_read_b64_tr_b16 a[22:23], v12 offset:23040
    v_mul_f32 v236, v236, v18
    v_mul_f32 v237, v237, v18
    v_mul_f32 v238, v238, v18
    s_waitcnt lgkmcnt(8)
    v_mfma_f32_32x32x16_bf16 v[160:175], a[0:3], v[48:51], v[160:175]
    ds_read_b64_tr_b16 a[24:25], v13 offset:22528
    ds_read_b64_tr_b16 a[26:27], v13 offset:23040
    v_mul_f32 v239, v239, v18
    v_mul_f32 v240, v240, v18
    v_mul_f32 v241, v241, v18
    v_mfma_f32_32x32x16_bf16 v[176:191], a[4:7], v[48:51], v[176:191]
    ds_read_b64_tr_b16 a[28:29], v14 offset:22528
    ds_read_b64_tr_b16 a[30:31], v14 offset:23040
    v_mul_f32 v242, v242, v18
    v_mul_f32 v243, v243, v18
    v_mul_f32 v244, v244, v18
    v_smfmac_f32_16x16x64_bf16 a[208:211], a[224:227], a[0:7], v30
    s_waitcnt lgkmcnt(8)
    v_mfma_f32_32x32x16_bf16 v[160:175], a[8:11], v[52:55], v[160:175]
    s_waitcnt vmcnt(10)
    s_barrier
    ds_read_b64_tr_b16 a[0:1], v7 offset:24576
    ds_read_b64_tr_b16 a[2:3], v7 offset:25088
    v_mul_f32 v245, v245, v18
    v_mfma_f32_32x32x16_bf16 v[176:191], a[12:15], v[52:55], v[176:191]
    ds_read_b64_tr_b16 a[4:5], v8 offset:24576
    ds_read_b64_tr_b16 a[6:7], v8 offset:25088
    v_mul_f32 v246, v246, v18
    v_mul_f32 v247, v247, v18
    v_mul_f32 v248, v248, v18
    s_waitcnt lgkmcnt(8)
    v_mfma_f32_32x32x16_bf16 v[160:175], a[16:19], v[56:59], v[160:175]
    ds_read_b64_tr_b16 a[8:9], v9 offset:24576
    ds_read_b64_tr_b16 a[10:11], v9 offset:25088
    v_mul_f32 v249, v249, v18
    v_mul_f32 v250, v250, v18
    v_mul_f32 v251, v251, v18
    v_mfma_f32_32x32x16_bf16 v[176:191], a[20:23], v[56:59], v[176:191]
    ds_read_b64_tr_b16 a[12:13], v10 offset:24576
    ds_read_b64_tr_b16 a[14:15], v10 offset:25088
    v_mul_f32 v252, v252, v18
    v_mul_f32 v253, v253, v18
    v_mul_f32 v254, v254, v18
    s_waitcnt lgkmcnt(8)
    v_mfma_f32_32x32x16_bf16 v[160:175], a[24:27], v[60:63], v[160:175]
    ds_read_b64_tr_b16 a[16:17], v11 offset:24576
    ds_read_b64_tr_b16 a[18:19], v11 offset:25088
    v_mul_f32 v255, v255, v18
    s_lshl2_add_u32 s80, s2, s72
    s_lshl_b32 s80, s80, 13
    v_mfma_f32_32x32x16_bf16 v[176:191], a[28:31], v[60:63], v[176:191]
    ds_read_b64_tr_b16 a[20:21], v12 offset:24576
    ds_read_b64_tr_b16 a[22:23], v12 offset:25088
    s_add_u32 s80, s80, 0x2800000
    s_waitcnt lgkmcnt(8)
    v_mfma_f32_32x32x16_bf16 v[160:175], a[0:3], v[64:67], v[160:175]
    ds_read_b64_tr_b16 a[24:25], v13 offset:24576
    ds_read_b64_tr_b16 a[26:27], v13 offset:25088
    v_mfma_f32_32x32x16_bf16 v[176:191], a[4:7], v[64:67], v[176:191]
    ds_read_b64_tr_b16 a[28:29], v14 offset:24576
    ds_read_b64_tr_b16 a[30:31], v14 offset:25088
    v_smfmac_f32_16x16x64_bf16 a[208:211], a[224:227], a[0:7], v30
    s_waitcnt lgkmcnt(8)
    v_mfma_f32_32x32x16_bf16 v[160:175], a[8:11], v[68:71], v[160:175]
    ds_read_b64_tr_b16 a[0:1], v7 offset:26624
    ds_read_b64_tr_b16 a[2:3], v7 offset:27136
    v_mfma_f32_32x32x16_bf16 v[176:191], a[12:15], v[68:71], v[176:191]
    ds_read_b64_tr_b16 a[4:5], v8 offset:26624
    ds_read_b64_tr_b16 a[6:7], v8 offset:27136
    s_waitcnt lgkmcnt(8)
    v_mfma_f32_32x32x16_bf16 v[160:175], a[16:19], v[72:75], v[160:175]
    ds_read_b64_tr_b16 a[8:9], v9 offset:26624
    ds_read_b64_tr_b16 a[10:11], v9 offset:27136
    s_waitcnt vmcnt(0)
    v_cmp_ne_u64 vcc, v[26:27], v[28:29]
    s_cbranch_vccz pok_9
    s_movk_i32 s101, 30000
    s_mov_b32 s83, 0x1800000
plp_10:
    s_mov_b64 exec, vcc
    buffer_load_dwordx2 v[26:27], v3, s[52:55], s83 offen sc1
    s_mov_b64 exec, -1
    s_waitcnt vmcnt(0)
    v_cmp_ne_u64 vcc, v[26:27], v[28:29]
    s_cbranch_vccz pok_9
    s_sub_u32 s101, s101, 1
    s_cbranch_scc0 plp_10
pok_9:
    v_mfma_f32_32x32x16_bf16 v[176:191], a[20:23], v[72:75], v[176:191]
    ds_read_b64_tr_b16 a[12:13], v10 offset:26624
    ds_read_b64_tr_b16 a[14:15], v10 offset:27136
    s_waitcnt lgkmcnt(8)
    v_mfma_f32_32x32x16_bf16 v[160:175], a[24:27], v[76:79], v[160:175]
    ds_read_b64_tr_b16 a[16:17], v11 offset:26624
    ds_read_b64_tr_b16 a[18:19], v11 offset:27136
    buffer_load_dwordx4 a[184:187], v1, s[52:55], s36 offen
    v_mfma_f32_32x32x16_bf16 v[176:191], a[28:31], v[76:79], v[176:191]
    ds_read_b64_tr_b16 a[20:21], v12 offset:26624
    ds_read_b64_tr_b16 a[22:23], v12 offset:27136
    s_waitcnt lgkmcnt(8)
    v_mfma_f32_32x32x16_bf16 v[160:175], a[0:3], v[80:83], v[160:175]
    ds_read_b64_tr_b16 a[24:25], v13 offset:26624
    ds_read_b64_tr_b16 a[26:27], v13 offset:27136
    buffer_load_dwordx4 a[188:191], v1, s[52:55], s37 offen
    v_mfma_f32_32x32x16_bf16 v[176:191], a[4:7], v[80:83], v[176:191]
    ds_read_b64_tr_b16 a[28:29], v14 offset:26624
    ds_read_b64_tr_b16 a[30:31], v14 offset:27136
    v_smfmac_f32_16x16x64_bf16 a[208:211], a[224:227], a[0:7], v30
    s_waitcnt lgkmcnt(8)
    v_mfma_f32_32x32x16_bf16 v[160:175], a[8:11], v[84:87], v[160:175]
    s_barrier
    ds_read_b64_tr_b16 a[0:1], v7 offset:28672
    ds_read_b64_tr_b16 a[2:3], v7 offset:29184
    buffer_load_dwordx4 a[64:67], v22, s[52:55], s28 offen
    v_mfma_f32_32x32x16_bf16 v[176:191], a[12:15], v[84:87], v[176:191]
    ds_read_b64_tr_b16 a[4:5], v8 offset:28672
    ds_read_b64_tr_b16 a[6:7], v8 offset:29184
    s_waitcnt lgkmcnt(8)
    v_mfma_f32_32x32x16_bf16 v[160:175], a[16:19], v[88:91], v[160:175]
    ds_read_b64_tr_b16 a[8:9], v9 offset:28672
    ds_read_b64_tr_b16 a[10:11], v9 offset:29184
    buffer_load_dwordx4 a[76:79], v22, s[52:55], s29 offen
    v_mfma_f32_32x32x16_bf16 v[176:191], a[20:23], v[88:91], v[176:191]
    ds_read_b64_tr_b16 a[12:13], v10 offset:28672
    ds_read_b64_tr_b16 a[14:15], v10 offset:29184
    s_waitcnt lgkmcnt(8)
    v_mfma_f32_32x32x16_bf16 v[160:175], a[24:27], v[92:95], v[160:175]
    ds_read_b64_tr_b16 a[16:17], v11 offset:28672
    ds_read_b64_tr_b16 a[18:19], v11 offset:29184
    buffer_load_dwordx4 a[88:91], v22, s[52:55], s30 offen
    v_mfma_f32_32x32x16_bf16 v[176:191], a[28:31], v[92:95], v[176:191]
    ds_read_b64_tr_b16 a[20:21], v12 offset:28672
    ds_read_b64_tr_b16 a[22:23], v12 offset:29184
    s_waitcnt lgkmcnt(8)
    v_mfma_f32_32x32x16_bf16 v[160:175], a[0:3], v[96:99], v[160:175]
    ds_read_b64_tr_b16 a[24:25], v13 offset:28672
    ds_read_b64_tr_b16 a[26:27], v13 offset:29184
    buffer_load_dwordx4 a[100:103], v22, s[52:55], s31 offen
    v_mfma_f32_32x32x16_bf16 v[176:191], a[4:7], v[96:99], v[176:191]
    ds_read_b64_tr_b16 a[28:29], v14 offset:28672
    ds_read_b64_tr_b16 a[30:31], v14 offset:29184
    v_smfmac_f32_16x16x64_bf16 a[208:211], a[224:227], a[0:7], v30
    s_waitcnt lgkmcnt(8)
    v_mfma_f32_32x32x16_bf16 v[160:175], a[8:11], v[100:103], v[160:175]
    ds_read_b64_tr_b16 a[0:1], v7 offset:30720
    ds_read_b64_tr_b16 a[2:3], v7 offset:31232
    buffer_load_dwordx4 a[112:115], v22, s[52:55], s32 offen
    v_mfma_f32_32x32x16_bf16 v[176:191], a[12:15], v[100:103], v[176:191]
    ds_read_b64_tr_b16 a[4:5], v8 offset:30720
    ds_read_b64_tr_b16 a[6:7], v8 offset:31232
    s_waitcnt lgkmcnt(8)
    v_mfma_f32_32x32x16_bf16 v[160:175], a[16:19], v[104:107], v[160:175]
    ds_read_b64_tr_b16 a[8:9], v9 offset:30720
    ds_read_b64_tr_b16 a[10:11], v9 offset:31232
    buffer_load_dwordx4 a[124:127], v22, s[52:55], s33 offen
    v_mfma_f32_32x32x16_bf16 v[176:191], a[20:23], v[104:107], v[176:191]
    ds_read_b64_tr_b16 a[12:13], v10 offset:30720
    ds_read_b64_tr_b16 a[14:15], v10 offset:31232
    s_waitcnt lgkmcnt(8)
    v_mfma_f32_32x32x16_bf16 v[160:175], a[24:27], v[108:111], v[160:175]
    ds_read_b64_tr_b16 a[16:17], v11 offset:30720
    ds_read_b64_tr_b16 a[18:19], v11 offset:31232
    buffer_load_dwordx4 a[136:139], v22, s[52:55], s34 offen
    v_mfma_f32_32x32x16_bf16 v[176:191], a[28:31], v[108:111], v[176:191]
    ds_read_b64_tr_b16 a[20:21], v12 offset:30720
    ds_read_b64_tr_b16 a[22:23], v12 offset:31232
    s_waitcnt lgkmcnt(8)
    v_mfma_f32_32x32x16_bf16 v[160:175], a[0:3], v[112:115], v[160:175]
    ds_read_b64_tr_b16 a[24:25], v13 offset:30720
    ds_read_b64_tr_b16 a[26:27], v13 offset:31232
    buffer_load_dwordx4 a[148:151], v22, s[52:55], s35 offen
    v_mfma_f32_32x32x16_bf16 v[176:191], a[4:7], v[112:115], v[176:191]
    ds_read_b64_tr_b16 a[28:29], v14 offset:30720
    ds_read_b64_tr_b16 a[30:31], v14 offset:31232
    v_smfmac_f32_16x16x64_bf16 a[208:211], a[224:227], a[0:7], v30
    s_waitcnt lgkmcnt(8)
    v_mfma_f32_32x32x16_bf16 v[160:175], a[8:11], v[116:119], v[160:175]
    s_barrier
    ds_read_b64_tr_b16 a[0:1], v7 offset:0
    ds_read_b64_tr_b16 a[2:3], v7 offset:512
    buffer_load_dwordx4 a[160:163], v22, s[52:55], s36 offen
    v_mfma_f32_32x32x16_bf16 v[176:191], a[12:15], v[116:119], v[176:191]
    ds_read_b64_tr_b16 a[4:5], v8 offset:0
    ds_read_b64_tr_b16 a[6:7], v8 offset:512
    s_waitcnt lgkmcnt(8)
    v_mfma_f32_32x32x16_bf16 v[160:175], a[16:19], v[120:123], v[160:175]
    ds_read_b64_tr_b16 a[8:9], v7 offset:2048
    ds_read_b64_tr_b16 a[10:11], v7 offset:2560
    buffer_load_dwordx4 a[172:175], v22, s[52:55], s37 offen
    v_mfma_f32_32x32x16_bf16 v[176:191], a[20:23], v[120:123], v[176:191]
    ds_read_b64_tr_b16 a[12:13], v8 offset:2048
    ds_read_b64_tr_b16 a[14:15], v8 offset:2560
    s_waitcnt lgkmcnt(8)
    v_mfma_f32_32x32x16_bf16 v[160:175], a[24:27], v[124:127], v[160:175]
    ds_read_b64_tr_b16 a[16:17], v9 offset:0
    ds_read_b64_tr_b16 a[18:19], v9 offset:512
    s_mov_b64 exec, s[78:79]
    buffer_load_dwordx4 a[68:71], v23, s[52:55], s28 offen offset:0
    buffer_load_dwordx4 a[72:75], v23, s[52:55], s28 offen offset:512
    s_mov_b64 exec, -1
    v_mfma_f32_32x32x16_bf16 v[176:191], a[28:31], v[124:127], v[176:191]
    ds_read_b64_tr_b16 a[20:21], v10 offset:0
    ds_read_b64_tr_b16 a[22:23], v10 offset:512
    s_waitcnt lgkmcnt(8)
    v_mfma_f32_32x32x16_bf16 v[160:175], a[0:3], v[128:131], v[160:175]
    ds_read_b64_tr_b16 a[24:25], v11 offset:0
    ds_read_b64_tr_b16 a[26:27], v11 offset:512
    s_mov_b64 exec, s[78:79]
    buffer_load_dwordx4 a[80:83], v23, s[52:55], s29 offen offset:0
    buffer_load_dwordx4 a[84:87], v23, s[52:55], s29 offen offset:512
    s_mov_b64 exec, -1
    v_mfma_f32_32x32x16_bf16 v[176:191], a[4:7], v[128:131], v[176:191]
    ds_read_b64_tr_b16 a[28:29], v12 offset:0
    ds_read_b64_tr_b16 a[30:31], v12 offset:512
    v_smfmac_f32_16x16x64_bf16 a[208:211], a[224:227], a[0:7], v30
    s_waitcnt lgkmcnt(8)
    v_mfma_f32_32x32x16_bf16 v[160:175], a[8:11], v[144:147], v[160:175]
    ds_read_b64_tr_b16 a[0:1], v13 offset:0
    ds_read_b64_tr_b16 a[2:3], v13 offset:512
    v_mfma_f32_32x32x16_bf16 v[176:191], a[12:15], v[144:147], v[176:191]
    ds_read_b64_tr_b16 a[4:5], v14 offset:0
    ds_read_b64_tr_b16 a[6:7], v14 offset:512
    v_smfmac_f32_16x16x64_bf16 a[208:211], a[224:227], a[8:15], v30
    s_waitcnt lgkmcnt(8)
    v_mfma_f32_32x32x16_bf16 v[160:175], a[16:19], v[132:135], v[160:175]
    ds_read_b64_tr_b16 a[8:9], v9 offset:2048
    ds_read_b64_tr_b16 a[10:11], v9 offset:2560
    v_mfma_f32_32x32x16_bf16 v[176:191], a[20:23], v[132:135], v[176:191]
    ds_read_b64_tr_b16 a[12:13], v10 offset:2048
    ds_read_b64_tr_b16 a[14:15], v10 offset:2560
    s_lshl_b32 s101, s72, 2
    v_add_u32 v15, s101, v1
    v_accvgpr_read_b32 v16, a208
    v_accvgpr_read_b32 v17, a209
    v_add_f32 v16, v16, v17
    v_cvt_pk_bf16_f32 v17, v16, v16
    s_waitcnt lgkmcnt(8)
    v_mfma_f32_32x32x16_bf16 v[160:175], a[24:27], v[136:139], v[160:175]
    ds_read_b64_tr_b16 a[16:17], v11 offset:2048
    ds_read_b64_tr_b16 a[18:19], v11 offset:2560
    v_lshlrev_b32 v17, 16, v17
    v_sub_f32 v17, v16, v17
    v_cvt_pk_bf16_f32 v16, v16, v17
    ds_write_b32 v15, v16 offset:38912
    v_mfma_f32_32x32x16_bf16 v[176:191], a[28:31], v[136:139], v[176:191]
    ds_read_b64_tr_b16 a[20:21], v12 offset:2048
    ds_read_b64_tr_b16 a[22:23], v12 offset:2560
    s_waitcnt lgkmcnt(9)
    v_mfma_f32_32x32x16_bf16 v[160:175], a[0:3], v[140:143], v[160:175]
    ds_read_b64_tr_b16 a[24:25], v13 offset:2048
    ds_read_b64_tr_b16 a[26:27], v13 offset:2560
    v_mfma_f32_32x32x16_bf16 v[176:191], a[4:7], v[140:143], v[176:191]
    ds_read_b64_tr_b16 a[28:29], v14 offset:2048
    ds_read_b64_tr_b16 a[30:31], v14 offset:2560
    s_waitcnt lgkmcnt(9)
    v_mfma_f32_32x32x16_bf16 v[160:175], a[8:11], v[148:151], v[160:175]
    s_waitcnt lgkmcnt(6)
    s_barrier
    ds_read_b128 a[232:235], v1 offset:38912
    v_mfma_f32_32x32x16_bf16 v[176:191], a[12:15], v[148:151], v[176:191]
    s_waitcnt lgkmcnt(5)
    v_mfma_f32_32x32x16_bf16 v[160:175], a[16:19], v[152:155], v[160:175]
    v_mfma_f32_32x32x16_bf16 v[176:191], a[20:23], v[152:155], v[176:191]
    s_waitcnt lgkmcnt(1)
    v_mfma_f32_32x32x16_bf16 v[160:175], a[24:27], v[156:159], v[160:175]
    v_mfma_f32_32x32x16_bf16 v[176:191], a[28:31], v[156:159], v[176:191]
    s_waitcnt lgkmcnt(0)
    v_mfma_f32_32x32x16_bf16 v[160:175], a[232:235], a[240:243], v[160:175]
    v_mfma_f32_32x32x16_bf16 v[176:191], a[232:235], a[244:247], v[176:191]
    s_mul_i32 s74, s51, 163840
    s_add_u32 s74, s74, 0x800000
    v_add_u32 v30, s74, v1
    s_nop 7
    v_pk_mul_f32 v[160:161], v[160:161], v[224:225]
    v_pk_mul_f32 v[162:163], v[162:163], v[226:227]
    v_pk_mul_f32 v[164:165], v[164:165], v[228:229]
    v_pk_mul_f32 v[166:167], v[166:167], v[230:231]
    v_pk_mul_f32 v[168:169], v[168:169], v[232:233]
    v_pk_mul_f32 v[170:171], v[170:171], v[234:235]
    v_pk_mul_f32 v[172:173], v[172:173], v[236:237]
    v_pk_mul_f32 v[174:175], v[174:175], v[238:239]
    v_cvt_pk_bf16_f32 v160, v160, v161
    v_cvt_pk_bf16_f32 v161, v162, v163
    v_cvt_pk_bf16_f32 v162, v164, v165
    v_cvt_pk_bf16_f32 v163, v166, v167
    buffer_store_dwordx4 v[160:163], v1, s[52:55], s81 offen offset:0 sc1
    v_cvt_pk_bf16_f32 v164, v168, v169
    v_cvt_pk_bf16_f32 v165, v170, v171
    v_cvt_pk_bf16_f32 v166, v172, v173
    v_cvt_pk_bf16_f32 v167, v174, v175
    buffer_store_dwordx4 v[164:167], v1, s[52:55], s81 offen offset:1024 sc1
    v_pk_mul_f32 v[176:177], v[176:177], v[240:241]
    v_pk_mul_f32 v[178:179], v[178:179], v[242:243]
    v_pk_mul_f32 v[180:181], v[180:181], v[244:245]
    v_pk_mul_f32 v[182:183], v[182:183], v[246:247]
    v_pk_mul_f32 v[184:185], v[184:185], v[248:249]
    v_pk_mul_f32 v[186:187], v[186:187], v[250:251]
    v_pk_mul_f32 v[188:189], v[188:189], v[252:253]
    v_pk_mul_f32 v[190:191], v[190:191], v[254:255]
    v_cvt_pk_bf16_f32 v176, v176, v177
    v_cvt_pk_bf16_f32 v177, v178, v179
    v_cvt_pk_bf16_f32 v178, v180, v181
    v_cvt_pk_bf16_f32 v179, v182, v183
    buffer_store_dwordx4 v[176:179], v1, s[52:55], s81 offen offset:2048 sc1
    v_cvt_pk_bf16_f32 v180, v184, v185
    v_cvt_pk_bf16_f32 v181, v186, v187
    v_cvt_pk_bf16_f32 v182, v188, v189
    v_cvt_pk_bf16_f32 v183, v190, v191
    buffer_store_dwordx4 v[180:183], v1, s[52:55], s81 offen offset:3072 sc1
    s_barrier
k_att:
    s_cmp_eq_u32 s100, 0
    s_cbranch_scc1 k_r0
    s_cmp_eq_u32 s100, 1
    s_cbranch_scc1 k_r1
    s_cmp_eq_u32 s100, 2
    s_cbranch_scc1 k_r2
    s_cmp_eq_u32 s100, 3
    s_cbranch_scc1 k_r3
    v_cmp_gt_u32 vcc, 32, v0
    v_mov_b32 v16, 0x3f80
    v_mov_b32 v145, 0
    v_mov_b32 v146, 0
    v_mov_b32 v147, 0
    v_cndmask_b32 v144, 0, v16, vcc
    v_mov_b32 v149, 0
    v_mov_b32 v150, 0
    v_mov_b32 v151, 0
    v_mov_b32 v153, 0
    v_mov_b32 v154, 0
    v_mov_b32 v155, 0
    v_mov_b32 v156, 0xf149f2ca
    v_mov_b32 v157, 0xf149f2ca
    v_mov_b32 v158, 0xf149f2ca
    v_mov_b32 v159, 0xf149f2ca
    s_waitcnt vmcnt(17)
    v_mfma_f32_32x32x16_bf16 v[32:47], a[64:67], a[184:187], v[208:223]
    s_waitcnt vmcnt(16)
    v_mfma_f32_32x32x16_bf16 v[48:63], a[76:79], a[184:187], 0
    v_mfma_f32_32x32x16_bf16 v[64:79], a[76:79], a[188:191], v[208:223]
    s_nop 8
    v_max3_f32 v156, v32, v33, v156
    v_max3_f32 v157, v34, v35, v157
    v_max3_f32 v156, v36, v37, v156
    v_max3_f32 v157, v38, v39, v157
    s_mov_b64 exec, s[78:79]
    buffer_load_dwordx4 a[92:95], v23, s[52:55], s30 offen offset:0
    buffer_load_dwordx4 a[96:99], v23, s[52:55], s30 offen offset:512
    s_mov_b64 exec, -1
    v_max3_f32 v156, v40, v41, v156
    v_max3_f32 v157, v42, v43, v157
    v_max3_f32 v156, v44, v45, v156
    v_max3_f32 v157, v46, v47, v157
    s_waitcnt vmcnt(17)
    v_mfma_f32_32x32x16_bf16 v[80:95], a[88:91], a[184:187], 0
    v_max3_f32 v156, v48, v49, v156
    v_max3_f32 v157, v50, v51, v157
    v_max3_f32 v156, v52, v53, v156
    v_max3_f32 v157, v54, v55, v157
    v_max3_f32 v156, v56, v57, v156
    v_max3_f32 v157, v58, v59, v157
    v_max3_f32 v156, v60, v61, v156
    v_max3_f32 v157, v62, v63, v157
    v_mfma_f32_32x32x16_bf16 v[96:111], a[88:91], a[188:191], 0
    v_max3_f32 v158, v64, v65, v158
    v_max3_f32 v159, v66, v67, v159
    v_max3_f32 v158, v68, v69, v158
    v_max3_f32 v159, v70, v71, v159
    s_mov_b64 exec, s[78:79]
    buffer_load_dwordx4 a[104:107], v23, s[52:55], s31 offen offset:0
    buffer_load_dwordx4 a[108:111], v23, s[52:55], s31 offen offset:512
    s_mov_b64 exec, -1
    v_max3_f32 v158, v72, v73, v158
    v_max3_f32 v159, v74, v75, v159
    v_max3_f32 v158, v76, v77, v158
    v_max3_f32 v159, v78, v79, v159
    s_waitcnt vmcnt(18)
    v_mfma_f32_32x32x16_bf16 v[32:47], a[100:103], a[184:187], 0
    v_max3_f32 v156, v80, v81, v156
    v_max3_f32 v157, v82, v83, v157
    v_max3_f32 v156, v84, v85, v156
    v_max3_f32 v157, v86, v87, v157
    v_max3_f32 v156, v88, v89, v156
    v_max3_f32 v157, v90, v91, v157
    v_max3_f32 v156, v92, v93, v156
    v_max3_f32 v157, v94, v95, v157
    v_mfma_f32_32x32x16_bf16 v[48:63], a[100:103], a[188:191], 0
    v_max3_f32 v158, v96, v97, v158
    v_max3_f32 v159, v98, v99, v159
    v_max3_f32 v158, v100, v101, v158
    v_max3_f32 v159, v102, v103, v159
    s_mov_b64 exec, s[78:79]
    buffer_load_dwordx4 a[116:119], v23, s[52:55], s32 offen offset:0
    buffer_load_dwordx4 a[120:123], v23, s[52:55], s32 offen offset:512
    s_mov_b64 exec, -1
    v_max3_f32 v158, v104, v105, v158
    v_max3_f32 v159, v106, v107, v159
    v_max3_f32 v158, v108, v109, v158
    v_max3_f32 v159, v110, v111, v159
    s_waitcnt vmcnt(19)
    v_mfma_f32_32x32x16_bf16 v[64:79], a[112:115], a[184:187], 0
    v_max3_f32 v156, v32, v33, v156
    v_max3_f32 v157, v34, v35, v157
    v_max3_f32 v156, v36, v37, v156
    v_max3_f32 v157, v38, v39, v157
    v_max3_f32 v156, v40, v41, v156
    v_max3_f32 v157, v42, v43, v157
    v_max3_f32 v156, v44, v45, v156
    v_max3_f32 v157, v46, v47, v157
    v_mfma_f32_32x32x16_bf16 v[80:95], a[112:115], a[188:191], 0
    v_max3_f32 v158, v48, v49, v158
    v_max3_f32 v159, v50, v51, v159
    v_max3_f32 v158, v52, v53, v158
    v_max3_f32 v159, v54, v55, v159
    s_mov_b64 exec, s[78:79]
    buffer_load_dwordx4 a[128:131], v23, s[52:55], s33 offen offset:0
    buffer_load_dwordx4 a[132:135], v23, s[52:55], s33 offen offset:512
    s_mov_b64 exec, -1
    v_max3_f32 v158, v56, v57, v158
    v_max3_f32 v159, v58, v59, v159
    v_max3_f32 v158, v60, v61, v158
    v_max3_f32 v159, v62, v63, v159
    s_waitcnt vmcnt(20)
    v_mfma_f32_32x32x16_bf16 v[96:111], a[124:127], a[184:187], 0
    v_max3_f32 v156, v64, v65, v156
    v_max3_f32 v157, v66, v67, v157
    v_max3_f32 v156, v68, v69, v156
    v_max3_f32 v157, v70, v71, v157
    v_max3_f32 v156, v72, v73, v156
    v_max3_f32 v157, v74, v75, v157
    v_max3_f32 v156, v76, v77, v156
    v_max3_f32 v157, v78, v79, v157
    v_mfma_f32_32x32x16_bf16 v[32:47], a[124:127], a[188:191], 0
    v_max3_f32 v158, v80, v81, v158
    v_max3_f32 v159, v82, v83, v159
    v_max3_f32 v158, v84, v85, v158
    v_max3_f32 v159, v86, v87, v159
    s_mov_b64 exec, s[78:79]
    buffer_load_dwordx4 a[140:143], v23, s[52:55], s34 offen offset:0
    buffer_load_dwordx4 a[144:147], v23, s[52:55], s34 offen offset:512
    s_mov_b64 exec, -1
    v_max3_f32 v158, v88, v89, v158
    v_max3_f32 v159, v90, v91, v159
    v_max3_f32 v158, v92, v93, v158
    v_max3_f32 v159, v94, v95, v159
    s_waitcnt vmcnt(21)
    v_mfma_f32_32x32x16_bf16 v[48:63], a[136:139], a[184:187], 0
    v_max3_f32 v156, v96, v97, v156
    v_max3_f32 v157, v98, v99, v157
    v_max3_f32 v156, v100, v101, v156
    v_max3_f32 v157, v102, v103, v157
    v_max3_f32 v156, v104, v105, v156
    v_max3_f32 v157, v106, v107, v157
    v_max3_f32 v156, v108, v109, v156
    v_max3_f32 v157, v110, v111, v157
    v_mfma_f32_32x32x16_bf16 v[64:79], a[136:139], a[188:191], 0
    v_max3_f32 v158, v32, v33, v158
    v_max3_f32 v159, v34, v35, v159
    v_max3_f32 v158, v36, v37, v158
    v_max3_f32 v159, v38, v39, v159
    s_mov_b64 exec, s[78:79]
    buffer_load_dwordx4 a[152:155], v23, s[52:55], s35 offen offset:0
    buffer_load_dwordx4 a[156:159], v23, s[52:55], s35 offen offset:512
    s_mov_b64 exec, -1
    v_max3_f32 v158, v40, v41, v158
    v_max3_f32 v159, v42, v43, v159
    v_max3_f32 v158, v44, v45, v158
    v_max3_f32 v159, v46, v47, v159
    s_waitcnt vmcnt(22)
    v_mfma_f32_32x32x16_bf16 v[80:95], a[148:151], a[184:187], 0
    v_max3_f32 v156, v48, v49, v156
    v_max3_f32 v157, v50, v51, v157
    v_max3_f32 v156, v52, v53, v156
    v_max3_f32 v157, v54, v55, v157
    v_max3_f32 v156, v56, v57, v156
    v_max3_f32 v157, v58, v59, v157
    v_max3_f32 v156, v60, v61, v156
    v_max3_f32 v157, v62, v63, v157
    v_mfma_f32_32x32x16_bf16 v[96:111], a[148:151], a[188:191], 0
    v_max3_f32 v158, v64, v65, v158
    v_max3_f32 v159, v66, v67, v159
    v_max3_f32 v158, v68, v69, v158
    v_max3_f32 v159, v70, v71, v159
    s_mov_b64 exec, s[78:79]
    buffer_load_dwordx4 a[164:167], v23, s[52:55], s36 offen offset:0
    buffer_load_dwordx4 a[168:171], v23, s[52:55], s36 offen offset:512
    s_mov_b64 exec, -1
    v_max3_f32 v158, v72, v73, v158
    v_max3_f32 v159, v74, v75, v159
    v_max3_f32 v158, v76, v77, v158
    v_max3_f32 v159, v78, v79, v159
    s_waitcnt vmcnt(23)
    v_mfma_f32_32x32x16_bf16 v[32:47], a[160:163], a[184:187], v[192:207]
    v_max3_f32 v156, v80, v81, v156
    v_max3_f32 v157, v82, v83, v157
    v_max3_f32 v156, v84, v85, v156
    v_max3_f32 v157, v86, v87, v157
    v_max3_f32 v156, v88, v89, v156
    v_max3_f32 v157, v90, v91, v157
    v_max3_f32 v156, v92, v93, v156
    v_max3_f32 v157, v94, v95, v157
    v_mfma_f32_32x32x16_bf16 v[48:63], a[160:163], a[188:191], 0
    v_max3_f32 v158, v96, v97, v158
    v_max3_f32 v159, v98, v99, v159
    v_max3_f32 v158, v100, v101, v158
    v_max3_f32 v159, v102, v103, v159
    s_mov_b64 exec, s[78:79]
    buffer_load_dwordx4 a[176:179], v23, s[52:55], s37 offen offset:0
    buffer_load_dwordx4 a[180:183], v23, s[52:55], s37 offen offset:512
    s_mov_b64 exec, -1
    v_max3_f32 v158, v104, v105, v158
    v_max3_f32 v159, v106, v107, v159
    v_max3_f32 v158, v108, v109, v158
    v_max3_f32 v159, v110, v111, v159
    s_waitcnt vmcnt(24)
    v_mfma_f32_32x32x16_bf16 v[64:79], a[172:175], a[188:191], v[192:207]
    v_max3_f32 v156, v32, v33, v156
    v_max3_f32 v157, v34, v35, v157
    v_max3_f32 v156, v36, v37, v156
    v_max3_f32 v157, v38, v39, v157
    v_max3_f32 v156, v40, v41, v156
    v_max3_f32 v157, v42, v43, v157
    v_max3_f32 v156, v44, v45, v156
    v_max3_f32 v157, v46, v47, v157
    v_max3_f32 v158, v48, v49, v158
    v_max3_f32 v159, v50, v51, v159
    v_max3_f32 v158, v52, v53, v158
    v_max3_f32 v159, v54, v55, v159
    v_max3_f32 v158, v56, v57, v158
    v_max3_f32 v159, v58, v59, v159
    v_max3_f32 v158, v60, v61, v158
    v_max3_f32 v159, v62, v63, v159
    v_max3_f32 v158, v64, v65, v158
    v_max3_f32 v159, v66, v67, v159
    v_max3_f32 v158, v68, v69, v158
    v_max3_f32 v159, v70, v71, v159
    v_max3_f32 v158, v72, v73, v158
    v_max3_f32 v159, v74, v75, v159
    v_max3_f32 v158, v76, v77, v158
    v_max3_f32 v159, v78, v79, v159
    v_max_f32 v156, v156, v157
    v_max_f32 v158, v158, v159
    v_mov_b32 v157, v156
    v_mov_b32 v159, v158
    s_nop 0
    v_permlane32_swap_b32 v156, v157
    v_permlane32_swap_b32 v158, v159
    v_max_f32 v156, v156, v157
    v_max_f32 v158, v158, v159
    v_cvt_pk_bf16_f32 v148, -v156, 0
    v_cvt_pk_bf16_f32 v152, -v158, 0
    s_nop 0
    v_mfma_f32_32x32x16_bf16 v[32:47], v[144:147], v[148:151], v[208:223]
    v_mfma_f32_32x32x16_bf16 v[32:47], a[64:67], a[184:187], v[32:47]
    v_mfma_f32_32x32x16_bf16 v[80:95], v[144:147], v[148:151], 0
    v_mfma_f32_32x32x16_bf16 v[48:63], a[76:79], a[184:187], v[80:95]
    s_nop 9
    v_exp_f32 v32, v32
    v_exp_f32 v33, v33
    v_exp_f32 v34, v34
    v_exp_f32 v35, v35
    v_exp_f32 v36, v36
    v_exp_f32 v37, v37
    v_exp_f32 v38, v38
    v_exp_f32 v39, v39
    v_mfma_f32_32x32x16_bf16 v[64:79], v[144:147], v[152:155], v[208:223]
    v_mfma_f32_32x32x16_bf16 v[64:79], a[76:79], a[188:191], v[64:79]
    v_exp_f32 v40, v40
    v_cvt_pk_bf16_f32 v32, v32, v33
    v_cvt_pk_bf16_f32 v33, v34, v35
    v_cvt_pk_bf16_f32 v34, v36, v37
    v_cvt_pk_bf16_f32 v35, v38, v39
    v_exp_f32 v41, v41
    v_exp_f32 v42, v42
    v_exp_f32 v43, v43
    s_waitcnt vmcnt(22)
    v_mfma_f32_32x32x16_bf16 v[112:127], a[68:71], v[32:35], 0
    v_exp_f32 v44, v44
    s_waitcnt vmcnt(16)
    s_add_u32 s83, s0, 0x1840000
    s_mov_b64 exec, 1
    buffer_store_dwordx2 v[28:29], off, s[52:55], s83 sc1
    s_mov_b64 exec, -1
    v_exp_f32 v45, v45
    v_exp_f32 v46, v46
    v_exp_f32 v47, v47
    v_cvt_pk_bf16_f32 v36, v40, v41
    v_cvt_pk_bf16_f32 v37, v42, v43
    v_cvt_pk_bf16_f32 v38, v44, v45
    v_cvt_pk_bf16_f32 v39, v46, v47
    v_exp_f32 v48, v48
    v_exp_f32 v49, v49
    v_exp_f32 v50, v50
    v_exp_f32 v51, v51
    v_mfma_f32_32x32x16_bf16 v[112:127], a[72:75], v[36:39], v[112:127]
    v_exp_f32 v52, v52
    v_exp_f32 v53, v53
    v_exp_f32 v54, v54
    v_exp_f32 v55, v55
    v_mfma_f32_32x32x16_bf16 v[32:47], a[88:91], a[184:187], v[80:95]
    v_exp_f32 v56, v56
    v_cvt_pk_bf16_f32 v48, v48, v49
    v_cvt_pk_bf16_f32 v49, v50, v51
    v_cvt_pk_bf16_f32 v50, v52, v53
    v_cvt_pk_bf16_f32 v51, v54, v55
    v_exp_f32 v57, v57
    v_exp_f32 v58, v58
    v_exp_f32 v59, v59
    v_mfma_f32_32x32x16_bf16 v[112:127], a[80:83], v[48:51], v[112:127]
    v_exp_f32 v60, v60
    v_exp_f32 v61, v61
    v_exp_f32 v62, v62
    v_exp_f32 v63, v63
    v_cvt_pk_bf16_f32 v52, v56, v57
    v_cvt_pk_bf16_f32 v53, v58, v59
    v_cvt_pk_bf16_f32 v54, v60, v61
    v_cvt_pk_bf16_f32 v55, v62, v63
    v_exp_f32 v64, v64
    v_exp_f32 v65, v65
    v_exp_f32 v66, v66
    v_exp_f32 v67, v67
    v_mfma_f32_32x32x16_bf16 v[112:127], a[84:87], v[52:55], v[112:127]
    v_exp_f32 v68, v68
    v_exp_f32 v69, v69
    v_exp_f32 v70, v70
    v_exp_f32 v71, v71
    v_mfma_f32_32x32x16_bf16 v[96:111], v[144:147], v[152:155], 0
    v_mfma_f32_32x32x16_bf16 v[48:63], a[88:91], a[188:191], v[96:111]
    v_exp_f32 v72, v72
    v_cvt_pk_bf16_f32 v64, v64, v65
    v_cvt_pk_bf16_f32 v65, v66, v67
    v_cvt_pk_bf16_f32 v66, v68, v69
    v_cvt_pk_bf16_f32 v67, v70, v71
    v_exp_f32 v73, v73
    v_exp_f32 v74, v74
    v_exp_f32 v75, v75
    v_mfma_f32_32x32x16_bf16 v[128:143], a[80:83], v[64:67], 0
    v_exp_f32 v76, v76
    s_mov_b32 s83, 0x1820000
    buffer_load_dwordx2 v[26:27], v4, s[52:55], s83 offen
    v_exp_f32 v77, v77
    s_add_u32 m0, s73, 0
    s_xor_b32 s77, s48, 0x100080
    buffer_load_dwordx4 v24, s[4:7], s77 offen lds
    buffer_load_dwordx4 v25, s[4:7], s77 offen offset:1024 lds
    v_exp_f32 v78, v78
    s_add_u32 m0, s73, 2048
    s_xor_b32 s77, s48, 0x110080
    buffer_load_dwordx4 v24, s[4:7], s77 offen lds
    buffer_load_dwordx4 v25, s[4:7], s77 offen offset:1024 lds
    v_exp_f32 v79, v79
    v_cvt_pk_bf16_f32 v68, v72, v73
    v_cvt_pk_bf16_f32 v69, v74, v75
    v_cvt_pk_bf16_f32 v70, v76, v77
    v_cvt_pk_bf16_f32 v71, v78, v79
    v_exp_f32 v32, v32
    v_exp_f32 v33, v33
    v_exp_f32 v34, v34
    v_exp_f32 v35, v35
    v_mfma_f32_32x32x16_bf16 v[128:143], a[84:87], v[68:71], v[128:143]
    v_exp_f32 v36, v36
    v_exp_f32 v37, v37
    v_exp_f32 v38, v38
    v_exp_f32 v39, v39
    v_mfma_f32_32x32x16_bf16 v[64:79], a[100:103], a[184:187], v[80:95]
    v_exp_f32 v40, v40
    v_cvt_pk_bf16_f32 v32, v32, v33
    v_cvt_pk_bf16_f32 v33, v34, v35
    v_cvt_pk_bf16_f32 v34, v36, v37
    v_cvt_pk_bf16_f32 v35, v38, v39
    v_exp_f32 v41, v41
    v_exp_f32 v42, v42
    v_exp_f32 v43, v43
    s_waitcnt vmcnt(20)
    v_mfma_f32_32x32x16_bf16 v[112:127], a[92:95], v[32:35], v[112:127]
    v_exp_f32 v44, v44
    s_add_u32 m0, s73, 4096
    s_xor_b32 s77, s49, 0x180080
    buffer_load_dwordx4 v24, s[4:7], s77 offen lds
    buffer_load_dwordx4 v25, s[4:7], s77 offen offset:1024 lds
    v_exp_f32 v45, v45
    s_add_u32 m0, s73, 6144
    s_xor_b32 s77, s19, 0x80
    buffer_load_dwordx4 v24, s[4:7], s77 offen lds
    buffer_load_dwordx4 v25, s[4:7], s77 offen offset:1024 lds
    v_exp_f32 v46, v46
    v_exp_f32 v47, v47
    v_cvt_pk_bf16_f32 v36, v40, v41
    v_cvt_pk_bf16_f32 v37, v42, v43
    v_cvt_pk_bf16_f32 v38, v44, v45
    v_cvt_pk_bf16_f32 v39, v46, v47
    v_exp_f32 v48, v48
    v_exp_f32 v49, v49
    v_exp_f32 v50, v50
    v_exp_f32 v51, v51
    v_mfma_f32_32x32x16_bf16 v[112:127], a[96:99], v[36:39], v[112:127]
    v_exp_f32 v52, v52
    v_exp_f32 v53, v53
    v_exp_f32 v54, v54
    v_exp_f32 v55, v55
    v_mfma_f32_32x32x16_bf16 v[32:47], a[100:103], a[188:191], v[96:111]
    v_exp_f32 v56, v56
    v_cvt_pk_bf16_f32 v48, v48, v49
    v_cvt_pk_bf16_f32 v49, v50, v51
    v_cvt_pk_bf16_f32 v50, v52, v53
    v_cvt_pk_bf16_f32 v51, v54, v55
    v_exp_f32 v57, v57
    v_exp_f32 v58, v58
    v_exp_f32 v59, v59
    v_mfma_f32_32x32x16_bf16 v[128:143], a[92:95], v[48:51], v[128:143]
    v_exp_f32 v60, v60
    s_waitcnt vmcnt(8)
    v_cmp_ne_u64 vcc, v[26:27], v[28:29]
    s_cbranch_vccz pok_11
    s_movk_i32 s101, 30000
    s_mov_b32 s83, 0x1820000
plp_12:
    s_mov_b64 exec, vcc
    buffer_load_dwordx2 v[26:27], v4, s[52:55], s83 offen sc1
    s_mov_b64 exec, -1
    s_waitcnt vmcnt(0)
    v_cmp_ne_u64 vcc, v[26:27], v[28:29]
    s_cbranch_vccz pok_11
    s_sub_u32 s101, s101, 1
    s_cbranch_scc0 plp_12
pok_11:
    v_exp_f32 v61, v61
    s_xor_b32 s76, s17, 0x10000
    buffer_load_dwordx4 a[0:3], v30, s[52:55], s76 offen offset:0
    buffer_load_dwordx4 a[4:7], v30, s[52:55], s76 offen offset:1024
    v_exp_f32 v62, v62
    buffer_load_dwordx4 a[8:11], v30, s[52:55], s76 offen offset:2048
    buffer_load_dwordx4 a[12:15], v30, s[52:55], s76 offen offset:3072
    v_exp_f32 v63, v63
    v_cvt_pk_bf16_f32 v52, v56, v57
    v_cvt_pk_bf16_f32 v53, v58, v59
    v_cvt_pk_bf16_f32 v54, v60, v61
    v_cvt_pk_bf16_f32 v55, v62, v63
    v_exp_f32 v64, v64
    v_exp_f32 v65, v65
    v_exp_f32 v66, v66
    v_exp_f32 v67, v67
    v_mfma_f32_32x32x16_bf16 v[128:143], a[96:99], v[52:55], v[128:143]
    v_exp_f32 v68, v68
    v_exp_f32 v69, v69
    v_exp_f32 v70, v70
    v_exp_f32 v71, v71
    v_mfma_f32_32x32x16_bf16 v[48:63], a[112:115], a[184:187], v[80:95]
    v_exp_f32 v72, v72
    v_cvt_pk_bf16_f32 v64, v64, v65
    v_cvt_pk_bf16_f32 v65, v66, v67
    v_cvt_pk_bf16_f32 v66, v68, v69
    v_cvt_pk_bf16_f32 v67, v70, v71
    v_exp_f32 v73, v73
    v_exp_f32 v74, v74
    v_exp_f32 v75, v75
    v_mfma_f32_32x32x16_bf16 v[112:127], a[104:107], v[64:67], v[112:127]
    v_exp_f32 v76, v76
    s_xor_b32 s76, s17, 0x11000
    buffer_load_dwordx4 a[16:19], v30, s[52:55], s76 offen offset:0
    buffer_load_dwordx4 a[20:23], v30, s[52:55], s76 offen offset:1024
    v_exp_f32 v77, v77
    buffer_load_dwordx4 a[24:27], v30, s[52:55], s76 offen offset:2048
    buffer_load_dwordx4 a[28:31], v30, s[52:55], s76 offen offset:3072
    v_exp_f32 v78, v78
    s_xor_b32 s76, s18, 0x18000
    buffer_load_dwordx4 a[32:35], v30, s[52:55], s76 offen offset:0
    buffer_load_dwordx4 a[36:39], v30, s[52:55], s76 offen offset:1024
    v_exp_f32 v79, v79
    v_cvt_pk_bf16_f32 v68, v72, v73
    v_cvt_pk_bf16_f32 v69, v74, v75
    v_cvt_pk_bf16_f32 v70, v76, v77
    v_cvt_pk_bf16_f32 v71, v78, v79
    v_exp_f32 v32, v32
    v_exp_f32 v33, v33
    v_exp_f32 v34, v34
    v_exp_f32 v35, v35
    v_mfma_f32_32x32x16_bf16 v[112:127], a[108:111], v[68:71], v[112:127]
    v_exp_f32 v36, v36
    v_exp_f32 v37, v37
    v_exp_f32 v38, v38
    v_exp_f32 v39, v39
    v_mfma_f32_32x32x16_bf16 v[64:79], a[112:115], a[188:191], v[96:111]
    v_exp_f32 v40, v40
    v_cvt_pk_bf16_f32 v32, v32, v33
    v_cvt_pk_bf16_f32 v33, v34, v35
    v_cvt_pk_bf16_f32 v34, v36, v37
    v_cvt_pk_bf16_f32 v35, v38, v39
    v_exp_f32 v41, v41
    v_exp_f32 v42, v42
    v_exp_f32 v43, v43
    v_mfma_f32_32x32x16_bf16 v[128:143], a[104:107], v[32:35], v[128:143]
    v_exp_f32 v44, v44
    buffer_load_dwordx4 a[40:43], v30, s[52:55], s76 offen offset:2048
    buffer_load_dwordx4 a[44:47], v30, s[52:55], s76 offen offset:3072
    v_exp_f32 v45, v45
    s_add_u32 m0, s73, 8192
    s_xor_b32 s77, s19, 0x10080
    buffer_load_dwordx4 v24, s[4:7], s77 offen lds
    buffer_load_dwordx4 v25, s[4:7], s77 offen offset:1024 lds
    v_exp_f32 v46, v46
    v_exp_f32 v47, v47
    v_cvt_pk_bf16_f32 v36, v40, v41
    v_cvt_pk_bf16_f32 v37, v42, v43
    v_cvt_pk_bf16_f32 v38, v44, v45
    v_cvt_pk_bf16_f32 v39, v46, v47
    v_exp_f32 v48, v48
    v_exp_f32 v49, v49
    v_exp_f32 v50, v50
    v_exp_f32 v51, v51
    v_mfma_f32_32x32x16_bf16 v[128:143], a[108:111], v[36:39], v[128:143]
    v_exp_f32 v52, v52
    v_exp_f32 v53, v53
    v_exp_f32 v54, v54
    v_exp_f32 v55, v55
    v_mfma_f32_32x32x16_bf16 v[32:47], a[124:127], a[184:187], v[80:95]
    v_exp_f32 v56, v56
    v_cvt_pk_bf16_f32 v48, v48, v49
    v_cvt_pk_bf16_f32 v49, v50, v51
    v_cvt_pk_bf16_f32 v50, v52, v53
    v_cvt_pk_bf16_f32 v51, v54, v55
    v_exp_f32 v57, v57
    v_exp_f32 v58, v58
    v_exp_f32 v59, v59
    v_mfma_f32_32x32x16_bf16 v[112:127], a[116:119], v[48:51], v[112:127]
    v_exp_f32 v60, v60
    v_exp_f32 v61, v61
    v_exp_f32 v62, v62
    v_exp_f32 v63, v63
    v_cvt_pk_bf16_f32 v52, v56, v57
    v_cvt_pk_bf16_f32 v53, v58, v59
    v_cvt_pk_bf16_f32 v54, v60, v61
    v_cvt_pk_bf16_f32 v55, v62, v63
    v_exp_f32 v64, v64
    v_exp_f32 v65, v65
    v_exp_f32 v66, v66
    v_exp_f32 v67, v67
    v_mfma_f32_32x32x16_bf16 v[112:127], a[120:123], v[52:55], v[112:127]
    v_exp_f32 v68, v68
    v_exp_f32 v69, v69
    v_exp_f32 v70, v70
    v_exp_f32 v71, v71
    v_mfma_f32_32x32x16_bf16 v[48:63], a[124:127], a[188:191], v[96:111]
    v_exp_f32 v72, v72
    v_cvt_pk_bf16_f32 v64, v64, v65
    v_cvt_pk_bf16_f32 v65, v66, v67
    v_cvt_pk_bf16_f32 v66, v68, v69
    v_cvt_pk_bf16_f32 v67, v70, v71
    v_exp_f32 v73, v73
    v_exp_f32 v74, v74
    v_exp_f32 v75, v75
    v_mfma_f32_32x32x16_bf16 v[128:143], a[116:119], v[64:67], v[128:143]
    v_exp_f32 v76, v76
    s_mov_b32 s83, 0x1840000
    buffer_load_dwordx2 v[26:27], v4, s[52:55], s83 offen
    v_exp_f32 v77, v77
    s_add_u32 m0, s73, 10240
    s_xor_b32 s77, s19, 0x80080
    buffer_load_dwordx4 v24, s[4:7], s77 offen lds
    buffer_load_dwordx4 v25, s[4:7], s77 offen offset:1024 lds
    v_exp_f32 v78, v78
    s_add_u32 m0, s73, 12288
    s_xor_b32 s77, s19, 0x90080
    buffer_load_dwordx4 v24, s[4:7], s77 offen lds
    buffer_load_dwordx4 v25, s[4:7], s77 offen offset:1024 lds
    v_exp_f32 v79, v79
    v_cvt_pk_bf16_f32 v68, v72, v73
    v_cvt_pk_bf16_f32 v69, v74, v75
    v_cvt_pk_bf16_f32 v70, v76, v77
    v_cvt_pk_bf16_f32 v71, v78, v79
    v_exp_f32 v32, v32
    v_exp_f32 v33, v33
    v_exp_f32 v34, v34
    v_exp_f32 v35, v35
    v_mfma_f32_32x32x16_bf16 v[128:143], a[120:123], v[68:71], v[128:143]
    v_exp_f32 v36, v36
    v_exp_f32 v37, v37
    v_exp_f32 v38, v38
    v_exp_f32 v39, v39
    v_mfma_f32_32x32x16_bf16 v[64:79], a[136:139], a[184:187], v[80:95]
    v_exp_f32 v40, v40
    v_cvt_pk_bf16_f32 v32, v32, v33
    v_cvt_pk_bf16_f32 v33, v34, v35
    v_cvt_pk_bf16_f32 v34, v36, v37
    v_cvt_pk_bf16_f32 v35, v38, v39
    v_exp_f32 v41, v41
    v_exp_f32 v42, v42
    v_exp_f32 v43, v43
    v_mfma_f32_32x32x16_bf16 v[112:127], a[128:131], v[32:35], v[112:127]
    v_exp_f32 v44, v44
    s_add_u32 m0, s73, 14336
    s_xor_b32 s77, s48, 0x80
    buffer_load_dwordx4 v24, s[12:15], s77 offen lds
    buffer_load_dwordx4 v25, s[12:15], s77 offen offset:1024 lds
    v_exp_f32 v45, v45
    s_add_u32 m0, s73, 16384
    s_xor_b32 s77, s48, 0x10080
    buffer_load_dwordx4 v24, s[12:15], s77 offen lds
    buffer_load_dwordx4 v25, s[12:15], s77 offen offset:1024 lds
    v_exp_f32 v46, v46
    v_exp_f32 v47, v47
    v_cvt_pk_bf16_f32 v36, v40, v41
    v_cvt_pk_bf16_f32 v37, v42, v43
    v_cvt_pk_bf16_f32 v38, v44, v45
    v_cvt_pk_bf16_f32 v39, v46, v47
    v_exp_f32 v48, v48
    v_exp_f32 v49, v49
    v_exp_f32 v50, v50
    v_exp_f32 v51, v51
    v_mfma_f32_32x32x16_bf16 v[112:127], a[132:135], v[36:39], v[112:127]
    v_exp_f32 v52, v52
    v_exp_f32 v53, v53
    v_exp_f32 v54, v54
    v_exp_f32 v55, v55
    v_mfma_f32_32x32x16_bf16 v[32:47], a[136:139], a[188:191], v[96:111]
    v_exp_f32 v56, v56
    v_cvt_pk_bf16_f32 v48, v48, v49
    v_cvt_pk_bf16_f32 v49, v50, v51
    v_cvt_pk_bf16_f32 v50, v52, v53
    v_cvt_pk_bf16_f32 v51, v54, v55
    v_exp_f32 v57, v57
    v_exp_f32 v58, v58
    v_exp_f32 v59, v59
    v_mfma_f32_32x32x16_bf16 v[128:143], a[128:131], v[48:51], v[128:143]
    v_exp_f32 v60, v60
    v_exp_f32 v61, v61
    v_exp_f32 v62, v62
    v_exp_f32 v63, v63
    v_cvt_pk_bf16_f32 v52, v56, v57
    v_cvt_pk_bf16_f32 v53, v58, v59
    v_cvt_pk_bf16_f32 v54, v60, v61
    v_cvt_pk_bf16_f32 v55, v62, v63
    v_exp_f32 v64, v64
    v_exp_f32 v65, v65
    v_exp_f32 v66, v66
    v_exp_f32 v67, v67
    v_mfma_f32_32x32x16_bf16 v[128:143], a[132:135], v[52:55], v[128:143]
    v_exp_f32 v68, v68
    v_exp_f32 v69, v69
    v_exp_f32 v70, v70
    v_exp_f32 v71, v71
    v_mfma_f32_32x32x16_bf16 v[48:63], a[148:151], a[184:187], v[80:95]
    v_exp_f32 v72, v72
    v_cvt_pk_bf16_f32 v64, v64, v65
    v_cvt_pk_bf16_f32 v65, v66, v67
    v_cvt_pk_bf16_f32 v66, v68, v69
    v_cvt_pk_bf16_f32 v67, v70, v71
    v_exp_f32 v73, v73
    v_exp_f32 v74, v74
    v_exp_f32 v75, v75
    v_mfma_f32_32x32x16_bf16 v[112:127], a[140:143], v[64:67], v[112:127]
    v_exp_f32 v76, v76
    v_exp_f32 v77, v77
    v_exp_f32 v78, v78
    v_exp_f32 v79, v79
    v_cvt_pk_bf16_f32 v68, v72, v73
    v_cvt_pk_bf16_f32 v69, v74, v75
    v_cvt_pk_bf16_f32 v70, v76, v77
    v_cvt_pk_bf16_f32 v71, v78, v79
    v_exp_f32 v32, v32
    v_exp_f32 v33, v33
    v_exp_f32 v34, v34
    v_exp_f32 v35, v35
    v_mfma_f32_32x32x16_bf16 v[112:127], a[144:147], v[68:71], v[112:127]
    v_exp_f32 v36, v36
    v_exp_f32 v37, v37
    v_exp_f32 v38, v38
    v_exp_f32 v39, v39
    v_mfma_f32_32x32x16_bf16 v[64:79], a[148:151], a[188:191], v[96:111]
    v_exp_f32 v40, v40
    v_cvt_pk_bf16_f32 v32, v32, v33
    v_cvt_pk_bf16_f32 v33, v34, v35
    v_cvt_pk_bf16_f32 v34, v36, v37
    v_cvt_pk_bf16_f32 v35, v38, v39
    v_exp_f32 v41, v41
    v_exp_f32 v42, v42
    v_exp_f32 v43, v43
    v_mfma_f32_32x32x16_bf16 v[128:143], a[140:143], v[32:35], v[128:143]
    v_exp_f32 v44, v44
    s_waitcnt vmcnt(8)
    v_cmp_ne_u64 vcc, v[26:27], v[28:29]
    s_cbranch_vccz pok_13
    s_movk_i32 s101, 30000
    s_mov_b32 s83, 0x1840000
plp_14:
    s_mov_b64 exec, vcc
    buffer_load_dwordx2 v[26:27], v4, s[52:55], s83 offen sc1
    s_mov_b64 exec, -1
    s_waitcnt vmcnt(0)
    v_cmp_ne_u64 vcc, v[26:27], v[28:29]
    s_cbranch_vccz pok_13
    s_sub_u32 s101, s101, 1
    s_cbranch_scc0 plp_14
pok_13:
    v_exp_f32 v45, v45
    s_xor_b32 s76, s16, 0x1000
    buffer_load_dwordx4 a[48:51], v30, s[52:55], s76 offen offset:0
    buffer_load_dwordx4 a[52:55], v30, s[52:55], s76 offen offset:1024
    v_exp_f32 v46, v46
    buffer_load_dwordx4 a[56:59], v30, s[52:55], s76 offen offset:2048
    buffer_load_dwordx4 a[60:63], v30, s[52:55], s76 offen offset:3072
    v_exp_f32 v47, v47
    v_cvt_pk_bf16_f32 v36, v40, v41
    v_cvt_pk_bf16_f32 v37, v42, v43
    v_cvt_pk_bf16_f32 v38, v44, v45
    v_cvt_pk_bf16_f32 v39, v46, v47
    v_exp_f32 v48, v48
    v_exp_f32 v49, v49
    v_exp_f32 v50, v50
    v_exp_f32 v51, v51
    v_mfma_f32_32x32x16_bf16 v[128:143], a[144:147], v[36:39], v[128:143]
    v_exp_f32 v52, v52
    v_exp_f32 v53, v53
    v_exp_f32 v54, v54
    v_exp_f32 v55, v55
    v_mfma_f32_32x32x16_bf16 v[32:47], v[144:147], v[148:151], v[192:207]
    v_mfma_f32_32x32x16_bf16 v[32:47], a[160:163], a[184:187], v[32:47]
    v_exp_f32 v56, v56
    v_cvt_pk_bf16_f32 v48, v48, v49
    v_cvt_pk_bf16_f32 v49, v50, v51
    v_cvt_pk_bf16_f32 v50, v52, v53
    v_cvt_pk_bf16_f32 v51, v54, v55
    v_exp_f32 v57, v57
    v_exp_f32 v58, v58
    v_exp_f32 v59, v59
    v_mfma_f32_32x32x16_bf16 v[112:127], a[152:155], v[48:51], v[112:127]
    v_exp_f32 v60, v60
    s_xor_b32 s76, s16, 0x8000
    buffer_load_dwordx4 a[192:195], v30, s[52:55], s76 offen offset:0
    buffer_load_dwordx4 a[196:199], v30, s[52:55], s76 offen offset:1024
    v_exp_f32 v61, v61
    buffer_load_dwordx4 a[200:203], v30, s[52:55], s76 offen offset:2048
    buffer_load_dwordx4 a[204:207], v30, s[52:55], s76 offen offset:3072
    v_exp_f32 v62, v62
    s_xor_b32 s76, s16, 0x9000
    buffer_load_dwordx4 a[208:211], v30, s[52:55], s76 offen offset:0
    buffer_load_dwordx4 a[212:215], v30, s[52:55], s76 offen offset:1024
    v_exp_f32 v63, v63
    v_cvt_pk_bf16_f32 v52, v56, v57
    v_cvt_pk_bf16_f32 v53, v58, v59
    v_cvt_pk_bf16_f32 v54, v60, v61
    v_cvt_pk_bf16_f32 v55, v62, v63
    v_exp_f32 v64, v64
    v_exp_f32 v65, v65
    v_exp_f32 v66, v66
    v_exp_f32 v67, v67
    v_mfma_f32_32x32x16_bf16 v[112:127], a[156:159], v[52:55], v[112:127]
    v_exp_f32 v68, v68
    v_exp_f32 v69, v69
    v_exp_f32 v70, v70
    v_exp_f32 v71, v71
    v_mfma_f32_32x32x16_bf16 v[48:63], a[160:163], a[188:191], v[96:111]
    v_exp_f32 v72, v72
    v_cvt_pk_bf16_f32 v64, v64, v65
    v_cvt_pk_bf16_f32 v65, v66, v67
    v_cvt_pk_bf16_f32 v66, v68, v69
    v_cvt_pk_bf16_f32 v67, v70, v71
    v_exp_f32 v73, v73
    v_exp_f32 v74, v74
    v_exp_f32 v75, v75
    v_mfma_f32_32x32x16_bf16 v[128:143], a[152:155], v[64:67], v[128:143]
    v_exp_f32 v76, v76
    buffer_load_dwordx4 a[216:219], v30, s[52:55], s76 offen offset:2048
    buffer_load_dwordx4 a[220:223], v30, s[52:55], s76 offen offset:3072
    v_exp_f32 v77, v77
    v_exp_f32 v78, v78
    v_exp_f32 v79, v79
    v_cvt_pk_bf16_f32 v68, v72, v73
    v_cvt_pk_bf16_f32 v69, v74, v75
    v_cvt_pk_bf16_f32 v70, v76, v77
    v_cvt_pk_bf16_f32 v71, v78, v79
    v_exp_f32 v32, v32
    v_exp_f32 v33, v33
    v_exp_f32 v34, v34
    v_exp_f32 v35, v35
    v_mfma_f32_32x32x16_bf16 v[128:143], a[156:159], v[68:71], v[128:143]
    v_exp_f32 v36, v36
    v_exp_f32 v37, v37
    v_exp_f32 v38, v38
    v_exp_f32 v39, v39
    v_mfma_f32_32x32x16_bf16 v[64:79], v[144:147], v[152:155], v[192:207]
    v_mfma_f32_32x32x16_bf16 v[64:79], a[172:175], a[188:191], v[64:79]
    v_exp_f32 v40, v40
    v_cvt_pk_bf16_f32 v32, v32, v33
    v_cvt_pk_bf16_f32 v33, v34, v35
    v_cvt_pk_bf16_f32 v34, v36, v37
    v_cvt_pk_bf16_f32 v35, v38, v39
    v_exp_f32 v41, v41
    v_exp_f32 v42, v42
    v_exp_f32 v43, v43
    v_mfma_f32_32x32x16_bf16 v[112:127], a[164:167], v[32:35], v[112:127]
    v_exp_f32 v44, v44
    v_exp_f32 v45, v45
    v_exp_f32 v46, v46
    v_exp_f32 v47, v47
    v_cvt_pk_bf16_f32 v36, v40, v41
    v_cvt_pk_bf16_f32 v37, v42, v43
    v_cvt_pk_bf16_f32 v38, v44, v45
    v_cvt_pk_bf16_f32 v39, v46, v47
    v_exp_f32 v48, v48
    v_exp_f32 v49, v49
    v_exp_f32 v50, v50
    v_exp_f32 v51, v51
    v_mfma_f32_32x32x16_bf16 v[112:127], a[168:171], v[36:39], v[112:127]
    v_exp_f32 v52, v52
    v_exp_f32 v53, v53
    v_exp_f32 v54, v54
    v_exp_f32 v55, v55
    v_exp_f32 v56, v56
    v_cvt_pk_bf16_f32 v48, v48, v49
    v_cvt_pk_bf16_f32 v49, v50, v51
    v_cvt_pk_bf16_f32 v50, v52, v53
    v_cvt_pk_bf16_f32 v51, v54, v55
    v_exp_f32 v57, v57
    v_exp_f32 v58, v58
    v_exp_f32 v59, v59
    v_mfma_f32_32x32x16_bf16 v[128:143], a[164:167], v[48:51], v[128:143]
    v_exp_f32 v60, v60
    v_exp_f32 v61, v61
    v_exp_f32 v62, v62
    v_exp_f32 v63, v63
    v_cvt_pk_bf16_f32 v52, v56, v57
    v_cvt_pk_bf16_f32 v53, v58, v59
    v_cvt_pk_bf16_f32 v54, v60, v61
    v_cvt_pk_bf16_f32 v55, v62, v63
    v_exp_f32 v64, v64
    v_exp_f32 v65, v65
    v_exp_f32 v66, v66
    v_exp_f32 v67, v67
    v_mfma_f32_32x32x16_bf16 v[128:143], a[168:171], v[52:55], v[128:143]
    v_exp_f32 v68, v68
    v_exp_f32 v69, v69
    v_exp_f32 v70, v70
    v_exp_f32 v71, v71
    v_exp_f32 v72, v72
    v_cvt_pk_bf16_f32 v64, v64, v65
    v_cvt_pk_bf16_f32 v65, v66, v67
    v_cvt_pk_bf16_f32 v66, v68, v69
    v_cvt_pk_bf16_f32 v67, v70, v71
    v_exp_f32 v73, v73
    v_exp_f32 v74, v74
    v_exp_f32 v75, v75
    v_mfma_f32_32x32x16_bf16 v[128:143], a[176:179], v[64:67], v[128:143]
    v_exp_f32 v76, v76
    v_exp_f32 v77, v77
    v_exp_f32 v78, v78
    v_exp_f32 v79, v79
    v_cvt_pk_bf16_f32 v68, v72, v73
    v_cvt_pk_bf16_f32 v69, v74, v75
    v_cvt_pk_bf16_f32 v70, v76, v77
    v_cvt_pk_bf16_f32 v71, v78, v79
    s_nop 1
    v_mfma_f32_32x32x16_bf16 v[128:143], a[180:183], v[68:71], v[128:143]
    v_rcp_f32 v120, v120
    s_nop 0
    v_mul_f32 v112, v112, v120
    v_mul_f32 v113, v113, v120
    v_mul_f32 v114, v114, v120
    v_mul_f32 v115, v115, v120
    v_mul_f32 v116, v116, v120
    v_mul_f32 v117, v117, v120
    v_mul_f32 v118, v118, v120
    v_mul_f32 v119, v119, v120
    v_cvt_pk_bf16_f32 v112, v112, v113
    v_cvt_pk_bf16_f32 v113, v114, v115
    v_cvt_pk_bf16_f32 v114, v116, v117
    v_cvt_pk_bf16_f32 v115, v118, v119
    buffer_store_dwordx4 v[112:115], v1, s[52:55], s38 offen sc1
    v_rcp_f32 v136, v136
    s_nop 0
    v_mul_f32 v128, v128, v136
    v_mul_f32 v129, v129, v136
    v_mul_f32 v130, v130, v136
    v_mul_f32 v131, v131, v136
    v_mul_f32 v132, v132, v136
    v_mul_f32 v133, v133, v136
    v_mul_f32 v134, v134, v136
    v_mul_f32 v135, v135, v136
    v_cvt_pk_bf16_f32 v128, v128, v129
    v_cvt_pk_bf16_f32 v129, v130, v131
    v_cvt_pk_bf16_f32 v130, v132, v133
    v_cvt_pk_bf16_f32 v131, v134, v135
    buffer_store_dwordx4 v[128:131], v1, s[52:55], s39 offen sc1
k_g2:
    v_and_b32 v16, 1, v0
    v_bfe_u32 v17, v0, 1, 1
    v_and_b32 v18, 16, v0
    v_lshl_add_u32 v16, v16, 2, v17
    v_lshrrev_b32 v17, 5, v0
    v_lshl_add_u32 v16, v16, 3, v18
    v_bfe_u32 v18, v0, 2, 2
    v_and_b32 v19, 8, v0
    v_lshl_add_u32 v17, v17, 2, v18
    v_lshl_add_u32 v19, v19, 3, v16
    s_and_b32 s74, s2, 64
    v_lshl_add_u32 v19, v17, 7, v19
    v_xor_b32 v7, s74, v19
    v_xor_b32 v8, 64, v7
    v_add_u32 v9, 0xa000, v7
    v_add_u32 v10, 0xa000, v8
    v_add_u32 v11, 0x14000, v7
    v_add_u32 v12, 0x14000, v8
    v_add_u32 v13, 0x1e000, v7
    v_add_u32 v14, 0x1e000, v8
    s_waitcnt vmcnt(14)
    s_barrier
    ds_read_b64_tr_b16 a[224:225], v7 offset:0
    ds_read_b64_tr_b16 a[226:227], v7 offset:1024
    ds_read_b64_tr_b16 a[228:229], v8 offset:0
    ds_read_b64_tr_b16 a[230:231], v8 offset:1024
    ds_read_b64_tr_b16 a[232:233], v9 offset:0
    ds_read_b64_tr_b16 a[234:235], v9 offset:1024
    ds_read_b64_tr_b16 a[236:237], v10 offset:0
    ds_read_b64_tr_b16 a[238:239], v10 offset:1024
    ds_read_b64_tr_b16 a[240:241], v11 offset:0
    ds_read_b64_tr_b16 a[242:243], v11 offset:1024
    ds_read_b64_tr_b16 a[244:245], v12 offset:0
    ds_read_b64_tr_b16 a[246:247], v12 offset:1024
    s_waitcnt lgkmcnt(8)
    v_mfma_f32_32x32x16_bf16 v[224:239], a[224:227], a[0:3], 0
    ds_read_b64_tr_b16 a[248:249], v13 offset:0
    ds_read_b64_tr_b16 a[250:251], v13 offset:1024
    s_add_u32 m0, s73, 18432
    s_xor_b32 s77, s48, 0x100000
    buffer_load_dwordx4 v24, s[4:7], s77 offen lds
    v_mfma_f32_32x32x16_bf16 v[240:255], a[228:231], a[0:3], 0
    ds_read_b64_tr_b16 a[252:253], v14 offset:0
    ds_read_b64_tr_b16 a[254:255], v14 offset:1024
    v_and_b32 v16, 31, v0
    v_and_b32 v17, 32, v0
    v_lshl_add_u32 v22, v16, 10, v17
    s_waitcnt lgkmcnt(8)
    v_mfma_f32_32x32x16_bf16 v[224:239], a[232:235], a[4:7], v[224:239]
    ds_read_b64_tr_b16 a[224:225], v7 offset:2048
    ds_read_b64_tr_b16 a[226:227], v7 offset:3072
    buffer_load_dwordx4 v25, s[4:7], s77 offen offset:1024 lds
    s_mov_b32 s81, 0x9e3779b1
    v_mul_lo_u32 v16, v28, s81
    v_mfma_f32_32x32x16_bf16 v[240:255], a[236:239], a[4:7], v[240:255]
    ds_read_b64_tr_b16 a[228:229], v8 offset:2048
    ds_read_b64_tr_b16 a[230:231], v8 offset:3072
    v_mul_hi_u32 v17, v28, s81
    s_mov_b32 s56, 0xcccccccc
    s_mov_b32 s57, 0xcccccccc
    s_waitcnt lgkmcnt(8)
    v_mfma_f32_32x32x16_bf16 v[224:239], a[240:243], a[8:11], v[224:239]
    ds_read_b64_tr_b16 a[232:233], v9 offset:2048
    ds_read_b64_tr_b16 a[234:235], v9 offset:3072
    s_add_u32 m0, s73, 20480
    s_xor_b32 s77, s48, 0x110000
    buffer_load_dwordx4 v24, s[4:7], s77 offen lds
    v_mfma_f32_32x32x16_bf16 v[240:255], a[244:247], a[8:11], v[240:255]
    ds_read_b64_tr_b16 a[236:237], v10 offset:2048
    ds_read_b64_tr_b16 a[238:239], v10 offset:3072
    v_xor_b32 v17, v17, v29
    v_lshlrev_b32 v18, 3, v0
    v_cndmask_b32 v16, v16, v17, s[56:57]
    s_waitcnt lgkmcnt(8)
    v_mfma_f32_32x32x16_bf16 v[224:239], a[248:251], a[12:15], v[224:239]
    ds_read_b64_tr_b16 a[240:241], v11 offset:2048
    ds_read_b64_tr_b16 a[242:243], v11 offset:3072
    buffer_load_dwordx4 v25, s[4:7], s77 offen offset:1024 lds
    v_and_b32 v18, 8, v18
    s_mov_b32 s81, 0x30003
    v_mfma_f32_32x32x16_bf16 v[240:255], a[252:255], a[12:15], v[240:255]
    ds_read_b64_tr_b16 a[244:245], v12 offset:2048
    ds_read_b64_tr_b16 a[246:247], v12 offset:3072
    v_lshrrev_b32 v184, v18, v16
    v_lshrrev_b32 v185, 2, v184
    v_lshrrev_b32 v186, 4, v184
    s_waitcnt lgkmcnt(8)
    v_mfma_f32_32x32x16_bf16 v[224:239], a[224:227], a[16:19], v[224:239]
    ds_read_b64_tr_b16 a[248:249], v13 offset:2048
    ds_read_b64_tr_b16 a[250:251], v13 offset:3072
    s_add_u32 m0, s73, 22528
    s_xor_b32 s77, s49, 0x180000
    buffer_load_dwordx4 v24, s[4:7], s77 offen lds
    v_mfma_f32_32x32x16_bf16 v[240:255], a[228:231], a[16:19], v[240:255]
    ds_read_b64_tr_b16 a[252:253], v14 offset:2048
    ds_read_b64_tr_b16 a[254:255], v14 offset:3072
    v_lshrrev_b32 v187, 6, v184
    v_and_b32 v184, s81, v184
    v_and_b32 v185, s81, v185
    s_waitcnt lgkmcnt(8)
    v_mfma_f32_32x32x16_bf16 v[224:239], a[232:235], a[20:23], v[224:239]
    ds_read_b64_tr_b16 a[224:225], v7 offset:4096
    ds_read_b64_tr_b16 a[226:227], v7 offset:5120
    buffer_load_dwordx4 v25, s[4:7], s77 offen offset:1024 lds
    v_and_b32 v186, s81, v186
    v_and_b32 v187, s81, v187
    v_mfma_f32_32x32x16_bf16 v[240:255], a[236:239], a[20:23], v[240:255]
    ds_read_b64_tr_b16 a[228:229], v8 offset:4096
    ds_read_b64_tr_b16 a[230:231], v8 offset:5120
    s_waitcnt lgkmcnt(8)
    v_mfma_f32_32x32x16_bf16 v[224:239], a[240:243], a[24:27], v[224:239]
    ds_read_b64_tr_b16 a[232:233], v9 offset:4096
    ds_read_b64_tr_b16 a[234:235], v9 offset:5120
    s_add_u32 m0, s73, 24576
    s_xor_b32 s77, s19, 0x0
    buffer_load_dwordx4 v24, s[4:7], s77 offen lds
    v_mfma_f32_32x32x16_bf16 v[240:255], a[244:247], a[24:27], v[240:255]
    ds_read_b64_tr_b16 a[236:237], v10 offset:4096
    ds_read_b64_tr_b16 a[238:239], v10 offset:5120
    s_waitcnt lgkmcnt(8)
    v_mfma_f32_32x32x16_bf16 v[224:239], a[248:251], a[28:31], v[224:239]
    ds_read_b64_tr_b16 a[240:241], v11 offset:4096
    ds_read_b64_tr_b16 a[242:243], v11 offset:5120
    buffer_load_dwordx4 v25, s[4:7], s77 offen offset:1024 lds
    v_mfma_f32_32x32x16_bf16 v[240:255], a[252:255], a[28:31], v[240:255]
    ds_read_b64_tr_b16 a[244:245], v12 offset:4096
    ds_read_b64_tr_b16 a[246:247], v12 offset:5120
    s_waitcnt lgkmcnt(8)
    v_mfma_f32_32x32x16_bf16 v[224:239], a[224:227], a[32:35], v[224:239]
    ds_read_b64_tr_b16 a[248:249], v13 offset:4096
    ds_read_b64_tr_b16 a[250:251], v13 offset:5120
    s_add_u32 m0, s73, 26624
    s_xor_b32 s77, s19, 0x10000
    buffer_load_dwordx4 v24, s[4:7], s77 offen lds
    v_mfma_f32_32x32x16_bf16 v[240:255], a[228:231], a[32:35], v[240:255]
    ds_read_b64_tr_b16 a[252:253], v14 offset:4096
    ds_read_b64_tr_b16 a[254:255], v14 offset:5120
    s_waitcnt lgkmcnt(8)
    v_mfma_f32_32x32x16_bf16 v[224:239], a[232:235], a[36:39], v[224:239]
    ds_read_b64_tr_b16 a[224:225], v7 offset:6144
    ds_read_b64_tr_b16 a[226:227], v7 offset:7168
    buffer_load_dwordx4 v25, s[4:7], s77 offen offset:1024 lds
    v_mfma_f32_32x32x16_bf16 v[240:255], a[236:239], a[36:39], v[240:255]
    ds_read_b64_tr_b16 a[228:229], v8 offset:6144
    ds_read_b64_tr_b16 a[230:231], v8 offset:7168
    s_waitcnt lgkmcnt(8)
    v_mfma_f32_32x32x16_bf16 v[224:239], a[240:243], a[40:43], v[224:239]
    ds_read_b64_tr_b16 a[232:233], v9 offset:6144
    ds_read_b64_tr_b16 a[234:235], v9 offset:7168
    s_add_u32 m0, s73, 28672
    s_xor_b32 s77, s19, 0x80000
    buffer_load_dwordx4 v24, s[4:7], s77 offen lds
    v_mfma_f32_32x32x16_bf16 v[240:255], a[244:247], a[40:43], v[240:255]
    ds_read_b64_tr_b16 a[236:237], v10 offset:6144
    ds_read_b64_tr_b16 a[238:239], v10 offset:7168
    s_waitcnt lgkmcnt(8)
    v_mfma_f32_32x32x16_bf16 v[224:239], a[248:251], a[44:47], v[224:239]
    ds_read_b64_tr_b16 a[240:241], v11 offset:6144
    ds_read_b64_tr_b16 a[242:243], v11 offset:7168
    buffer_load_dwordx4 v25, s[4:7], s77 offen offset:1024 lds
    v_mfma_f32_32x32x16_bf16 v[240:255], a[252:255], a[44:47], v[240:255]
    ds_read_b64_tr_b16 a[244:245], v12 offset:6144
    ds_read_b64_tr_b16 a[246:247], v12 offset:7168
    s_waitcnt lgkmcnt(8)
    v_mfma_f32_32x32x16_bf16 v[224:239], a[224:227], v[160:163], v[224:239]
    ds_read_b64_tr_b16 a[248:249], v13 offset:6144
    ds_read_b64_tr_b16 a[250:251], v13 offset:7168
    s_add_u32 m0, s73, 30720
    s_xor_b32 s77, s19, 0x90000
    buffer_load_dwordx4 v24, s[4:7], s77 offen lds
    v_mfma_f32_32x32x16_bf16 v[240:255], a[228:231], v[160:163], v[240:255]
    ds_read_b64_tr_b16 a[252:253], v14 offset:6144
    ds_read_b64_tr_b16 a[254:255], v14 offset:7168
    s_waitcnt lgkmcnt(8)
    v_mfma_f32_32x32x16_bf16 v[224:239], a[232:235], v[164:167], v[224:239]
    ds_read_b64_tr_b16 a[224:225], v7 offset:8192
    ds_read_b64_tr_b16 a[226:227], v7 offset:9216
    buffer_load_dwordx4 v25, s[4:7], s77 offen offset:1024 lds
    v_mfma_f32_32x32x16_bf16 v[240:255], a[236:239], v[164:167], v[240:255]
    ds_read_b64_tr_b16 a[228:229], v8 offset:8192
    ds_read_b64_tr_b16 a[230:231], v8 offset:9216
    s_waitcnt lgkmcnt(8)
    v_mfma_f32_32x32x16_bf16 v[224:239], a[240:243], v[176:179], v[224:239]
    ds_read_b64_tr_b16 a[232:233], v9 offset:8192
    ds_read_b64_tr_b16 a[234:235], v9 offset:9216
    s_add_u32 m0, s73, 32768
    s_xor_b32 s77, s48, 0x0
    buffer_load_dwordx4 v24, s[12:15], s77 offen lds
    v_mfma_f32_32x32x16_bf16 v[240:255], a[244:247], v[176:179], v[240:255]
    ds_read_b64_tr_b16 a[236:237], v10 offset:8192
    ds_read_b64_tr_b16 a[238:239], v10 offset:9216
    s_waitcnt lgkmcnt(8)
    v_mfma_f32_32x32x16_bf16 v[224:239], a[248:251], v[180:183], v[224:239]
    ds_read_b64_tr_b16 a[240:241], v11 offset:8192
    ds_read_b64_tr_b16 a[242:243], v11 offset:9216
    buffer_load_dwordx4 v25, s[12:15], s77 offen offset:1024 lds
    v_mfma_f32_32x32x16_bf16 v[240:255], a[252:255], v[180:183], v[240:255]
    ds_read_b64_tr_b16 a[244:245], v12 offset:8192
    ds_read_b64_tr_b16 a[246:247], v12 offset:9216
    s_waitcnt lgkmcnt(8)
    s_waitcnt vmcnt(26)
    v_mfma_f32_32x32x16_bf16 v[224:239], a[224:227], a[48:51], v[224:239]
    ds_read_b64_tr_b16 a[248:249], v13 offset:8192
    ds_read_b64_tr_b16 a[250:251], v13 offset:9216
    s_add_u32 m0, s73, 34816
    s_xor_b32 s77, s48, 0x10000
    buffer_load_dwordx4 v24, s[12:15], s77 offen lds
    v_mfma_f32_32x32x16_bf16 v[240:255], a[228:231], a[48:51], v[240:255]
    ds_read_b64_tr_b16 a[252:253], v14 offset:8192
    ds_read_b64_tr_b16 a[254:255], v14 offset:9216
    s_waitcnt lgkmcnt(8)
    v_mfma_f32_32x32x16_bf16 v[224:239], a[232:235], a[52:55], v[224:239]
    ds_read_b64_tr_b16 a[224:225], v7 offset:10240
    ds_read_b64_tr_b16 a[226:227], v7 offset:11264
    buffer_load_dwordx4 v25, s[12:15], s77 offen offset:1024 lds
    v_mfma_f32_32x32x16_bf16 v[240:255], a[236:239], a[52:55], v[240:255]
    ds_read_b64_tr_b16 a[228:229], v8 offset:10240
    ds_read_b64_tr_b16 a[230:231], v8 offset:11264
    s_waitcnt lgkmcnt(8)
    v_mfma_f32_32x32x16_bf16 v[224:239], a[240:243], a[56:59], v[224:239]
    ds_read_b64_tr_b16 a[232:233], v9 offset:10240
    ds_read_b64_tr_b16 a[234:235], v9 offset:11264
    s_xor_b32 s76, s17, 0x20000
    buffer_load_dwordx4 v[32:35], v30, s[52:55], s76 offen offset:0
    v_mfma_f32_32x32x16_bf16 v[240:255], a[244:247], a[56:59], v[240:255]
    ds_read_b64_tr_b16 a[236:237], v10 offset:10240
    ds_read_b64_tr_b16 a[238:239], v10 offset:11264
    s_waitcnt lgkmcnt(8)
    v_mfma_f32_32x32x16_bf16 v[224:239], a[248:251], a[60:63], v[224:239]
    ds_read_b64_tr_b16 a[240:241], v11 offset:10240
    ds_read_b64_tr_b16 a[242:243], v11 offset:11264
    buffer_load_dwordx4 v[36:39], v30, s[52:55], s76 offen offset:1024
    v_mfma_f32_32x32x16_bf16 v[240:255], a[252:255], a[60:63], v[240:255]
    ds_read_b64_tr_b16 a[244:245], v12 offset:10240
    ds_read_b64_tr_b16 a[246:247], v12 offset:11264
    s_waitcnt lgkmcnt(8)
    s_waitcnt vmcnt(26)
    v_mfma_f32_32x32x16_bf16 v[224:239], a[224:227], a[192:195], v[224:239]
    ds_read_b64_tr_b16 a[248:249], v13 offset:10240
    ds_read_b64_tr_b16 a[250:251], v13 offset:11264
    buffer_load_dwordx4 v[40:43], v30, s[52:55], s76 offen offset:2048
    v_mfma_f32_32x32x16_bf16 v[240:255], a[228:231], a[192:195], v[240:255]
    ds_read_b64_tr_b16 a[252:253], v14 offset:10240
    ds_read_b64_tr_b16 a[254:255], v14 offset:11264
    s_waitcnt lgkmcnt(8)
    v_mfma_f32_32x32x16_bf16 v[224:239], a[232:235], a[196:199], v[224:239]
    ds_read_b64_tr_b16 a[224:225], v7 offset:12288
    ds_read_b64_tr_b16 a[226:227], v7 offset:13312
    buffer_load_dwordx4 v[44:47], v30, s[52:55], s76 offen offset:3072
    v_mfma_f32_32x32x16_bf16 v[240:255], a[236:239], a[196:199], v[240:255]
    ds_read_b64_tr_b16 a[228:229], v8 offset:12288
    ds_read_b64_tr_b16 a[230:231], v8 offset:13312
    s_waitcnt lgkmcnt(8)
    v_mfma_f32_32x32x16_bf16 v[224:239], a[240:243], a[200:203], v[224:239]
    ds_read_b64_tr_b16 a[232:233], v9 offset:12288
    ds_read_b64_tr_b16 a[234:235], v9 offset:13312
    s_xor_b32 s76, s17, 0x21000
    buffer_load_dwordx4 v[48:51], v30, s[52:55], s76 offen offset:0
    v_mfma_f32_32x32x16_bf16 v[240:255], a[244:247], a[200:203], v[240:255]
    ds_read_b64_tr_b16 a[236:237], v10 offset:12288
    ds_read_b64_tr_b16 a[238:239], v10 offset:13312
    s_waitcnt lgkmcnt(8)
    v_mfma_f32_32x32x16_bf16 v[224:239], a[248:251], a[204:207], v[224:239]
    ds_read_b64_tr_b16 a[240:241], v11 offset:12288
    ds_read_b64_tr_b16 a[242:243], v11 offset:13312
    buffer_load_dwordx4 v[52:55], v30, s[52:55], s76 offen offset:1024
    v_mfma_f32_32x32x16_bf16 v[240:255], a[252:255], a[204:207], v[240:255]
    ds_read_b64_tr_b16 a[244:245], v12 offset:12288
    ds_read_b64_tr_b16 a[246:247], v12 offset:13312
    s_waitcnt lgkmcnt(8)
    s_waitcnt vmcnt(26)
    v_mfma_f32_32x32x16_bf16 v[224:239], a[224:227], a[208:211], v[224:239]
    ds_read_b64_tr_b16 a[248:249], v13 offset:12288
    ds_read_b64_tr_b16 a[250:251], v13 offset:13312
    buffer_load_dwordx4 v[56:59], v30, s[52:55], s76 offen offset:2048
    v_mfma_f32_32x32x16_bf16 v[240:255], a[228:231], a[208:211], v[240:255]
    ds_read_b64_tr_b16 a[252:253], v14 offset:12288
    ds_read_b64_tr_b16 a[254:255], v14 offset:13312
    s_waitcnt lgkmcnt(8)
    v_mfma_f32_32x32x16_bf16 v[224:239], a[232:235], a[212:215], v[224:239]
    ds_read_b64_tr_b16 a[224:225], v7 offset:14336
    ds_read_b64_tr_b16 a[226:227], v7 offset:15360
    buffer_load_dwordx4 v[60:63], v30, s[52:55], s76 offen offset:3072
    v_mfma_f32_32x32x16_bf16 v[240:255], a[236:239], a[212:215], v[240:255]
    ds_read_b64_tr_b16 a[228:229], v8 offset:14336
    ds_read_b64_tr_b16 a[230:231], v8 offset:15360
    s_waitcnt vmcnt(4)
    v_max3_u32 v20, v32, v33, v34
    v_max3_u32 v21, v35, v36, v37
    s_waitcnt lgkmcnt(8)
    v_mfma_f32_32x32x16_bf16 v[224:239], a[240:243], a[216:219], v[224:239]
    ds_read_b64_tr_b16 a[232:233], v9 offset:14336
    ds_read_b64_tr_b16 a[234:235], v9 offset:15360
    v_max3_u32 v20, v38, v39, v20
    v_max3_u32 v21, v40, v41, v21
    v_max3_u32 v20, v42, v43, v20
    v_mfma_f32_32x32x16_bf16 v[240:255], a[244:247], a[216:219], v[240:255]
    ds_read_b64_tr_b16 a[236:237], v10 offset:14336
    ds_read_b64_tr_b16 a[238:239], v10 offset:15360
    v_max3_u32 v21, v44, v45, v21
    v_max3_u32 v20, v46, v47, v20
    v_max_u32 v20, v20, v21
    s_waitcnt lgkmcnt(8)
    v_mfma_f32_32x32x16_bf16 v[224:239], a[248:251], a[220:223], v[224:239]
    ds_read_b64_tr_b16 a[240:241], v11 offset:14336
    ds_read_b64_tr_b16 a[242:243], v11 offset:15360
    v_cmp_eq_u32 vcc, -1, v20
    s_cbranch_vccnz k_rlo7
k_rbo7:
    v_mfma_f32_32x32x16_bf16 v[240:255], a[252:255], a[220:223], v[240:255]
    ds_read_b64_tr_b16 a[244:245], v12 offset:14336
    ds_read_b64_tr_b16 a[246:247], v12 offset:15360
    s_waitcnt lgkmcnt(8)
    v_mfma_f32_32x32x16_bf16 v[224:239], a[224:227], v[32:35], v[224:239]
    ds_read_b64_tr_b16 a[248:249], v13 offset:14336
    ds_read_b64_tr_b16 a[250:251], v13 offset:15360
    v_mfma_f32_32x32x16_bf16 v[240:255], a[228:231], v[32:35], v[240:255]
    ds_read_b64_tr_b16 a[252:253], v14 offset:14336
    ds_read_b64_tr_b16 a[254:255], v14 offset:15360
    s_waitcnt lgkmcnt(8)
    v_mfma_f32_32x32x16_bf16 v[224:239], a[232:235], v[36:39], v[224:239]
    ds_read_b64_tr_b16 a[224:225], v7 offset:16384
    ds_read_b64_tr_b16 a[226:227], v7 offset:17408
    v_mfma_f32_32x32x16_bf16 v[240:255], a[236:239], v[36:39], v[240:255]
    ds_read_b64_tr_b16 a[228:229], v9 offset:16384
    ds_read_b64_tr_b16 a[230:231], v9 offset:17408
    s_waitcnt vmcnt(0)
    v_max3_u32 v20, v48, v49, v50
    v_max3_u32 v21, v51, v52, v53
    s_waitcnt lgkmcnt(8)
    v_mfma_f32_32x32x16_bf16 v[224:239], a[240:243], v[40:43], v[224:239]
    ds_read_b64_tr_b16 a[232:233], v11 offset:16384
    ds_read_b64_tr_b16 a[234:235], v11 offset:17408
    buffer_load_dwordx4 v[168:171], v22, s[8:11], 0 offen offset:0
    v_max3_u32 v20, v54, v55, v20
    v_max3_u32 v21, v56, v57, v21
    v_mfma_f32_32x32x16_bf16 v[240:255], a[244:247], v[40:43], v[240:255]
    ds_read_b64_tr_b16 a[236:237], v13 offset:16384
    ds_read_b64_tr_b16 a[238:239], v13 offset:17408
    v_max3_u32 v20, v58, v59, v20
    v_max3_u32 v21, v60, v61, v21
    v_max3_u32 v20, v62, v63, v20
    s_waitcnt lgkmcnt(8)
    v_mfma_f32_32x32x16_bf16 v[224:239], a[248:251], v[44:47], v[224:239]
    ds_read_b64_tr_b16 a[240:241], v8 offset:16384
    ds_read_b64_tr_b16 a[242:243], v8 offset:17408
    buffer_load_dwordx4 v[172:175], v22, s[8:11], 0 offen offset:16
    v_max_u32 v20, v20, v21
    v_cmp_eq_u32 vcc, -1, v20
    v_mfma_f32_32x32x16_bf16 v[240:255], a[252:255], v[44:47], v[240:255]
    ds_read_b64_tr_b16 a[244:245], v10 offset:16384
    ds_read_b64_tr_b16 a[246:247], v10 offset:17408
    s_cbranch_vccnz k_rlo8
k_rbo8:
    s_waitcnt lgkmcnt(8)
    v_mfma_f32_32x32x16_bf16 v[224:239], a[224:227], v[48:51], v[224:239]
    ds_read_b64_tr_b16 a[248:249], v12 offset:16384
    ds_read_b64_tr_b16 a[250:251], v12 offset:17408
    v_mfma_f32_32x32x16_bf16 v[224:239], a[228:231], v[52:55], v[224:239]
    ds_read_b64_tr_b16 a[252:253], v14 offset:16384
    ds_read_b64_tr_b16 a[254:255], v14 offset:17408
    s_waitcnt lgkmcnt(8)
    v_mfma_f32_32x32x16_bf16 v[224:239], a[232:235], v[56:59], v[224:239]
    s_barrier
    ds_read_b64_tr_b16 a[224:225], v8 offset:18432
    ds_read_b64_tr_b16 a[226:227], v8 offset:19456
    v_mfma_f32_32x32x16_bf16 v[224:239], a[236:239], v[60:63], v[224:239]
    ds_read_b64_tr_b16 a[228:229], v10 offset:18432
    ds_read_b64_tr_b16 a[230:231], v10 offset:19456
    s_waitcnt lgkmcnt(8)
    v_mfma_f32_32x32x16_bf16 v[240:255], a[240:243], v[48:51], v[240:255]
    ds_read_b64_tr_b16 a[232:233], v12 offset:18432
    ds_read_b64_tr_b16 a[234:235], v12 offset:19456
    v_mfma_f32_32x32x16_bf16 v[240:255], a[244:247], v[52:55], v[240:255]
    ds_read_b64_tr_b16 a[236:237], v14 offset:18432
    ds_read_b64_tr_b16 a[238:239], v14 offset:19456
    s_xor_b32 s74, s80, 0x401000
    s_nop 1
    v_cvt_pk_f16_f32 v224, v224, v225
    v_cvt_pk_f16_f32 v225, v226, v227
    v_bfi_b32 v224, s81, v184, v224
    v_bfi_b32 v225, s81, v185, v225
    s_waitcnt lgkmcnt(8)
    v_mfma_f32_32x32x16_bf16 v[240:255], a[248:251], v[56:59], v[240:255]
    ds_read_b64_tr_b16 a[240:241], v8 offset:20480
    ds_read_b64_tr_b16 a[242:243], v8 offset:21504
    v_cvt_pk_f16_f32 v226, v228, v229
    v_cvt_pk_f16_f32 v227, v230, v231
    v_bfi_b32 v226, s81, v186, v226
    v_bfi_b32 v227, s81, v187, v227
    v_cvt_pk_f16_f32 v228, v232, v233
    v_mfma_f32_32x32x16_bf16 v[240:255], a[252:255], v[60:63], v[240:255]
    ds_read_b64_tr_b16 a[244:245], v10 offset:20480
    ds_read_b64_tr_b16 a[246:247], v10 offset:21504
    buffer_store_dwordx4 v[224:227], v1, s[52:55], s74 offen offset:0 sc1
    v_cvt_pk_f16_f32 v229, v234, v235
    v_bfi_b32 v228, s81, v184, v228
    v_bfi_b32 v229, s81, v185, v229
    v_cvt_pk_f16_f32 v230, v236, v237
    s_waitcnt lgkmcnt(8)
    v_mfma_f32_32x32x16_bf16 v[208:223], a[224:227], a[0:3], 0
    ds_read_b64_tr_b16 a[248:249], v12 offset:20480
    ds_read_b64_tr_b16 a[250:251], v12 offset:21504
    v_cvt_pk_f16_f32 v231, v238, v239
    v_bfi_b32 v230, s81, v186, v230
    v_bfi_b32 v231, s81, v187, v231
    v_mfma_f32_32x32x16_bf16 v[208:223], a[228:231], a[4:7], v[208:223]
    ds_read_b64_tr_b16 a[252:253], v14 offset:20480
    ds_read_b64_tr_b16 a[254:255], v14 offset:21504
    buffer_store_dwordx4 v[228:231], v1, s[52:55], s74 offen offset:1024 sc1
    s_xor_b32 s75, s80, 0x601800
    v_cvt_pk_f16_f32 v240, v240, v241
    v_cvt_pk_f16_f32 v241, v242, v243
    v_bfi_b32 v240, s81, v184, v240
    s_waitcnt lgkmcnt(8)
    v_mfma_f32_32x32x16_bf16 v[208:223], a[232:235], a[8:11], v[208:223]
    ds_read_b64_tr_b16 a[224:225], v8 offset:22528
    ds_read_b64_tr_b16 a[226:227], v8 offset:23552
    v_bfi_b32 v241, s81, v185, v241
    v_cvt_pk_f16_f32 v242, v244, v245
    v_cvt_pk_f16_f32 v243, v246, v247
    v_bfi_b32 v242, s81, v186, v242
    v_bfi_b32 v243, s81, v187, v243
    v_mfma_f32_32x32x16_bf16 v[208:223], a[236:239], a[12:15], v[208:223]
    ds_read_b64_tr_b16 a[228:229], v10 offset:22528
    ds_read_b64_tr_b16 a[230:231], v10 offset:23552
    v_cvt_pk_f16_f32 v244, v248, v249
    v_cvt_pk_f16_f32 v245, v250, v251
    v_bfi_b32 v244, s81, v184, v244
    v_bfi_b32 v245, s81, v185, v245
    v_cvt_pk_f16_f32 v246, v252, v253
    s_waitcnt lgkmcnt(8)
    v_mfma_f32_32x32x16_bf16 v[208:223], a[240:243], a[16:19], v[208:223]
    ds_read_b64_tr_b16 a[232:233], v12 offset:22528
    ds_read_b64_tr_b16 a[234:235], v12 offset:23552
    buffer_store_dwordx4 v[240:243], v1, s[52:55], s75 offen offset:0 sc1
    v_cvt_pk_f16_f32 v247, v254, v255
    v_bfi_b32 v246, s81, v186, v246
    v_bfi_b32 v247, s81, v187, v247
    v_mfma_f32_32x32x16_bf16 v[208:223], a[244:247], a[20:23], v[208:223]
    ds_read_b64_tr_b16 a[236:237], v14 offset:22528
    ds_read_b64_tr_b16 a[238:239], v14 offset:23552
    buffer_store_dwordx4 v[244:247], v1, s[52:55], s75 offen offset:1024 sc1
    s_waitcnt lgkmcnt(8)
    v_mfma_f32_32x32x16_bf16 v[208:223], a[248:251], a[24:27], v[208:223]
    s_barrier
    ds_read_b64_tr_b16 a[240:241], v8 offset:24576
    ds_read_b64_tr_b16 a[242:243], v8 offset:25600
    v_mfma_f32_32x32x16_bf16 v[208:223], a[252:255], a[28:31], v[208:223]
    ds_read_b64_tr_b16 a[244:245], v10 offset:24576
    ds_read_b64_tr_b16 a[246:247], v10 offset:25600
    s_waitcnt lgkmcnt(8)
    v_mfma_f32_32x32x16_bf16 v[208:223], a[224:227], a[32:35], v[208:223]
    ds_read_b64_tr_b16 a[248:249], v12 offset:24576
    ds_read_b64_tr_b16 a[250:251], v12 offset:25600
    v_mfma_f32_32x32x16_bf16 v[208:223], a[228:231], a[36:39], v[208:223]
    ds_read_b64_tr_b16 a[252:253], v14 offset:24576
    ds_read_b64_tr_b16 a[254:255], v14 offset:25600
    s_waitcnt lgkmcnt(8)
    v_mfma_f32_32x32x16_bf16 v[208:223], a[232:235], a[40:43], v[208:223]
    ds_read_b64_tr_b16 a[224:225], v8 offset:26624
    ds_read_b64_tr_b16 a[226:227], v8 offset:27648
    v_mfma_f32_32x32x16_bf16 v[208:223], a[236:239], a[44:47], v[208:223]
    ds_read_b64_tr_b16 a[228:229], v10 offset:26624
    ds_read_b64_tr_b16 a[230:231], v10 offset:27648
    s_waitcnt lgkmcnt(8)
    v_mfma_f32_32x32x16_bf16 v[208:223], a[240:243], v[160:163], v[208:223]
    ds_read_b64_tr_b16 a[232:233], v12 offset:26624
    ds_read_b64_tr_b16 a[234:235], v12 offset:27648
    v_mfma_f32_32x32x16_bf16 v[208:223], a[244:247], v[164:167], v[208:223]
    ds_read_b64_tr_b16 a[236:237], v14 offset:26624
    ds_read_b64_tr_b16 a[238:239], v14 offset:27648
    s_waitcnt lgkmcnt(8)
    v_mfma_f32_32x32x16_bf16 v[208:223], a[248:251], v[176:179], v[208:223]
    ds_read_b64_tr_b16 a[240:241], v8 offset:28672
    ds_read_b64_tr_b16 a[242:243], v8 offset:29696
    v_mfma_f32_32x32x16_bf16 v[208:223], a[252:255], v[180:183], v[208:223]
    ds_read_b64_tr_b16 a[244:245], v10 offset:28672
    ds_read_b64_tr_b16 a[246:247], v10 offset:29696
    s_waitcnt lgkmcnt(8)
    v_mfma_f32_32x32x16_bf16 v[208:223], a[224:227], a[48:51], v[208:223]
    ds_read_b64_tr_b16 a[248:249], v12 offset:28672
    ds_read_b64_tr_b16 a[250:251], v12 offset:29696
    v_mfma_f32_32x32x16_bf16 v[208:223], a[228:231], a[52:55], v[208:223]
    ds_read_b64_tr_b16 a[252:253], v14 offset:28672
    ds_read_b64_tr_b16 a[254:255], v14 offset:29696
    s_waitcnt lgkmcnt(8)
    v_mfma_f32_32x32x16_bf16 v[208:223], a[232:235], a[56:59], v[208:223]
    s_barrier
    ds_read_b64_tr_b16 a[224:225], v8 offset:30720
    ds_read_b64_tr_b16 a[226:227], v8 offset:31744
    v_mfma_f32_32x32x16_bf16 v[208:223], a[236:239], a[60:63], v[208:223]
    ds_read_b64_tr_b16 a[228:229], v10 offset:30720
    ds_read_b64_tr_b16 a[230:231], v10 offset:31744
    s_waitcnt lgkmcnt(8)
    v_mfma_f32_32x32x16_bf16 v[208:223], a[240:243], a[192:195], v[208:223]
    ds_read_b64_tr_b16 a[232:233], v12 offset:30720
    ds_read_b64_tr_b16 a[234:235], v12 offset:31744
    s_waitcnt vmcnt(4)
    v_lshlrev_b32 v192, 16, v168
    v_and_b32 v193, 0xffff0000, v168
    v_mfma_f32_32x32x16_bf16 v[208:223], a[244:247], a[196:199], v[208:223]
    ds_read_b64_tr_b16 a[236:237], v14 offset:30720
    ds_read_b64_tr_b16 a[238:239], v14 offset:31744
    v_lshlrev_b32 v194, 16, v169
    v_and_b32 v195, 0xffff0000, v169
    v_lshlrev_b32 v196, 16, v170
    s_waitcnt lgkmcnt(8)
    v_mfma_f32_32x32x16_bf16 v[208:223], a[248:251], a[200:203], v[208:223]
    ds_read_b64_tr_b16 a[240:241], v8 offset:32768
    ds_read_b64_tr_b16 a[242:243], v8 offset:33792
    v_and_b32 v197, 0xffff0000, v170
    v_lshlrev_b32 v198, 16, v171
    v_and_b32 v199, 0xffff0000, v171
    v_mfma_f32_32x32x16_bf16 v[208:223], a[252:255], a[204:207], v[208:223]
    ds_read_b64_tr_b16 a[244:245], v10 offset:32768
    ds_read_b64_tr_b16 a[246:247], v10 offset:33792
    v_lshlrev_b32 v200, 16, v172
    v_and_b32 v201, 0xffff0000, v172
    v_lshlrev_b32 v202, 16, v173
    s_waitcnt lgkmcnt(8)
    v_mfma_f32_32x32x16_bf16 v[208:223], a[224:227], a[208:211], v[208:223]
    ds_read_b64_tr_b16 a[248:249], v12 offset:32768
    ds_read_b64_tr_b16 a[250:251], v12 offset:33792
    v_and_b32 v203, 0xffff0000, v173
    v_lshlrev_b32 v204, 16, v174
    v_and_b32 v205, 0xffff0000, v174
    v_mfma_f32_32x32x16_bf16 v[208:223], a[228:231], a[212:215], v[208:223]
    ds_read_b64_tr_b16 a[252:253], v14 offset:32768
    ds_read_b64_tr_b16 a[254:255], v14 offset:33792
    v_lshlrev_b32 v206, 16, v175
    v_and_b32 v207, 0xffff0000, v175
    s_waitcnt lgkmcnt(8)
    v_mfma_f32_32x32x16_bf16 v[208:223], a[232:235], a[216:219], v[208:223]
    ds_read_b64_tr_b16 a[224:225], v8 offset:34816
    ds_read_b64_tr_b16 a[226:227], v8 offset:35840
    v_mfma_f32_32x32x16_bf16 v[208:223], a[236:239], a[220:223], v[208:223]
    ds_read_b64_tr_b16 a[228:229], v10 offset:34816
    ds_read_b64_tr_b16 a[230:231], v10 offset:35840
    s_waitcnt lgkmcnt(8)
    v_mfma_f32_32x32x16_bf16 v[208:223], a[240:243], v[32:35], v[208:223]
    ds_read_b64_tr_b16 a[232:233], v12 offset:34816
    ds_read_b64_tr_b16 a[234:235], v12 offset:35840
    v_mfma_f32_32x32x16_bf16 v[208:223], a[244:247], v[36:39], v[208:223]
    ds_read_b64_tr_b16 a[236:237], v14 offset:34816
    ds_read_b64_tr_b16 a[238:239], v14 offset:35840
    s_waitcnt lgkmcnt(8)
    v_mfma_f32_32x32x16_bf16 v[208:223], a[248:251], v[40:43], v[208:223]
    ds_read_b64_tr_b16 a[240:241], v7 offset:18432
    ds_read_b64_tr_b16 a[242:243], v7 offset:19456
    s_xor_b32 s76, s80, 0x1000
    buffer_load_dwordx4 v[72:75], v1, s[52:55], s76 offen offset:0
    v_mfma_f32_32x32x16_bf16 v[208:223], a[252:255], v[44:47], v[208:223]
    ds_read_b64_tr_b16 a[244:245], v9 offset:18432
    ds_read_b64_tr_b16 a[246:247], v9 offset:19456
    s_waitcnt lgkmcnt(8)
    v_mfma_f32_32x32x16_bf16 v[208:223], a[224:227], v[48:51], v[208:223]
    ds_read_b64_tr_b16 a[248:249], v11 offset:18432
    ds_read_b64_tr_b16 a[250:251], v11 offset:19456
    buffer_load_dwordx4 v[76:79], v1, s[52:55], s76 offen offset:1024
    v_mfma_f32_32x32x16_bf16 v[208:223], a[228:231], v[52:55], v[208:223]
    ds_read_b64_tr_b16 a[252:253], v13 offset:18432
    ds_read_b64_tr_b16 a[254:255], v13 offset:19456
    s_waitcnt lgkmcnt(8)
    v_mfma_f32_32x32x16_bf16 v[208:223], a[232:235], v[56:59], v[208:223]
    ds_read_b64_tr_b16 a[224:225], v7 offset:20480
    ds_read_b64_tr_b16 a[226:227], v7 offset:21504
    s_xor_b32 s76, s80, 0x1800
    buffer_load_dwordx4 v[80:83], v1, s[52:55], s76 offen offset:0
    v_mfma_f32_32x32x16_bf16 v[208:223], a[236:239], v[60:63], v[208:223]
    ds_read_b64_tr_b16 a[228:229], v9 offset:20480
    ds_read_b64_tr_b16 a[230:231], v9 offset:21504
    s_waitcnt lgkmcnt(8)
    v_mfma_f32_32x32x16_bf16 v[192:207], a[240:243], a[0:3], v[192:207]
    ds_read_b64_tr_b16 a[232:233], v11 offset:20480
    ds_read_b64_tr_b16 a[234:235], v11 offset:21504
    buffer_load_dwordx4 v[84:87], v1, s[52:55], s76 offen offset:1024
    v_mfma_f32_32x32x16_bf16 v[192:207], a[244:247], a[4:7], v[192:207]
    ds_read_b64_tr_b16 a[236:237], v13 offset:20480
    ds_read_b64_tr_b16 a[238:239], v13 offset:21504
    s_xor_b32 s74, s80, 0x200800
    s_nop 0
    v_cvt_pk_f16_f32 v208, v208, v209
    v_cvt_pk_f16_f32 v209, v210, v211
    v_bfi_b32 v208, s81, v184, v208
    v_bfi_b32 v209, s81, v185, v209
    s_waitcnt lgkmcnt(8)
    v_mfma_f32_32x32x16_bf16 v[192:207], a[248:251], a[8:11], v[192:207]
    ds_read_b64_tr_b16 a[240:241], v7 offset:22528
    ds_read_b64_tr_b16 a[242:243], v7 offset:23552
    v_cvt_pk_f16_f32 v210, v212, v213
    v_cvt_pk_f16_f32 v211, v214, v215
    v_bfi_b32 v210, s81, v186, v210
    v_bfi_b32 v211, s81, v187, v211
    v_cvt_pk_f16_f32 v212, v216, v217
    v_mfma_f32_32x32x16_bf16 v[192:207], a[252:255], a[12:15], v[192:207]
    ds_read_b64_tr_b16 a[244:245], v9 offset:22528
    ds_read_b64_tr_b16 a[246:247], v9 offset:23552
    buffer_store_dwordx4 v[208:211], v1, s[52:55], s74 offen offset:0 sc1
    v_cvt_pk_f16_f32 v213, v218, v219
    v_bfi_b32 v212, s81, v184, v212
    v_bfi_b32 v213, s81, v185, v213
    v_cvt_pk_f16_f32 v214, v220, v221
    s_waitcnt lgkmcnt(8)
    v_mfma_f32_32x32x16_bf16 v[192:207], a[224:227], a[16:19], v[192:207]
    ds_read_b64_tr_b16 a[248:249], v11 offset:22528
    ds_read_b64_tr_b16 a[250:251], v11 offset:23552
    v_cvt_pk_f16_f32 v215, v222, v223
    v_bfi_b32 v214, s81, v186, v214
    v_bfi_b32 v215, s81, v187, v215
    v_mfma_f32_32x32x16_bf16 v[192:207], a[228:231], a[20:23], v[192:207]
    ds_read_b64_tr_b16 a[252:253], v13 offset:22528
    ds_read_b64_tr_b16 a[254:255], v13 offset:23552
    buffer_store_dwordx4 v[212:215], v1, s[52:55], s74 offen offset:1024 sc1
    s_waitcnt lgkmcnt(8)
    v_mfma_f32_32x32x16_bf16 v[192:207], a[232:235], a[24:27], v[192:207]
    ds_read_b64_tr_b16 a[224:225], v7 offset:24576
    ds_read_b64_tr_b16 a[226:227], v7 offset:25600
    v_mfma_f32_32x32x16_bf16 v[192:207], a[236:239], a[28:31], v[192:207]
    ds_read_b64_tr_b16 a[228:229], v9 offset:24576
    ds_read_b64_tr_b16 a[230:231], v9 offset:25600
    s_waitcnt lgkmcnt(8)
    v_mfma_f32_32x32x16_bf16 v[192:207], a[240:243], a[32:35], v[192:207]
    ds_read_b64_tr_b16 a[232:233], v11 offset:24576
    ds_read_b64_tr_b16 a[234:235], v11 offset:25600
    v_mfma_f32_32x32x16_bf16 v[192:207], a[244:247], a[36:39], v[192:207]
    ds_read_b64_tr_b16 a[236:237], v13 offset:24576
    ds_read_b64_tr_b16 a[238:239], v13 offset:25600
    s_waitcnt lgkmcnt(8)
    v_mfma_f32_32x32x16_bf16 v[192:207], a[248:251], a[40:43], v[192:207]
    ds_read_b64_tr_b16 a[240:241], v7 offset:26624
    ds_read_b64_tr_b16 a[242:243], v7 offset:27648
    v_mfma_f32_32x32x16_bf16 v[192:207], a[252:255], a[44:47], v[192:207]
    ds_read_b64_tr_b16 a[244:245], v9 offset:26624
    ds_read_b64_tr_b16 a[246:247], v9 offset:27648
    s_waitcnt lgkmcnt(8)
    v_mfma_f32_32x32x16_bf16 v[192:207], a[224:227], v[160:163], v[192:207]
    ds_read_b64_tr_b16 a[248:249], v11 offset:26624
    ds_read_b64_tr_b16 a[250:251], v11 offset:27648
    v_mfma_f32_32x32x16_bf16 v[192:207], a[228:231], v[164:167], v[192:207]
    ds_read_b64_tr_b16 a[252:253], v13 offset:26624
    ds_read_b64_tr_b16 a[254:255], v13 offset:27648
    s_waitcnt lgkmcnt(8)
    v_mfma_f32_32x32x16_bf16 v[192:207], a[232:235], v[176:179], v[192:207]
    ds_read_b64_tr_b16 a[224:225], v7 offset:28672
    ds_read_b64_tr_b16 a[226:227], v7 offset:29696
    v_mfma_f32_32x32x16_bf16 v[192:207], a[236:239], v[180:183], v[192:207]
    ds_read_b64_tr_b16 a[228:229], v9 offset:28672
    ds_read_b64_tr_b16 a[230:231], v9 offset:29696
    s_waitcnt lgkmcnt(8)
    v_mfma_f32_32x32x16_bf16 v[192:207], a[240:243], a[48:51], v[192:207]
    ds_read_b64_tr_b16 a[232:233], v11 offset:28672
    ds_read_b64_tr_b16 a[234:235], v11 offset:29696
    v_mfma_f32_32x32x16_bf16 v[192:207], a[244:247], a[52:55], v[192:207]
    ds_read_b64_tr_b16 a[236:237], v13 offset:28672
    ds_read_b64_tr_b16 a[238:239], v13 offset:29696
    s_waitcnt lgkmcnt(8)
    v_mfma_f32_32x32x16_bf16 v[192:207], a[248:251], a[56:59], v[192:207]
    ds_read_b64_tr_b16 a[240:241], v7 offset:30720
    ds_read_b64_tr_b16 a[242:243], v7 offset:31744
    v_mfma_f32_32x32x16_bf16 v[192:207], a[252:255], a[60:63], v[192:207]
    ds_read_b64_tr_b16 a[244:245], v9 offset:30720
    ds_read_b64_tr_b16 a[246:247], v9 offset:31744
    s_waitcnt lgkmcnt(8)
    v_mfma_f32_32x32x16_bf16 v[192:207], a[224:227], a[192:195], v[192:207]
    ds_read_b64_tr_b16 a[248:249], v11 offset:30720
    ds_read_b64_tr_b16 a[250:251], v11 offset:31744
    v_mfma_f32_32x32x16_bf16 v[192:207], a[228:231], a[196:199], v[192:207]
    ds_read_b64_tr_b16 a[252:253], v13 offset:30720
    ds_read_b64_tr_b16 a[254:255], v13 offset:31744
    s_waitcnt lgkmcnt(8)
    v_mfma_f32_32x32x16_bf16 v[192:207], a[232:235], a[200:203], v[192:207]
    ds_read_b64_tr_b16 a[224:225], v7 offset:32768
    ds_read_b64_tr_b16 a[226:227], v7 offset:33792
    v_mfma_f32_32x32x16_bf16 v[192:207], a[236:239], a[204:207], v[192:207]
    ds_read_b64_tr_b16 a[228:229], v9 offset:32768
    ds_read_b64_tr_b16 a[230:231], v9 offset:33792
    s_waitcnt lgkmcnt(8)
    v_mfma_f32_32x32x16_bf16 v[192:207], a[240:243], a[208:211], v[192:207]
    ds_read_b64_tr_b16 a[232:233], v11 offset:32768
    ds_read_b64_tr_b16 a[234:235], v11 offset:33792
    v_mfma_f32_32x32x16_bf16 v[192:207], a[244:247], a[212:215], v[192:207]
    ds_read_b64_tr_b16 a[236:237], v13 offset:32768
    ds_read_b64_tr_b16 a[238:239], v13 offset:33792
    s_waitcnt lgkmcnt(8)
    v_mfma_f32_32x32x16_bf16 v[192:207], a[248:251], a[216:219], v[192:207]
    ds_read_b64_tr_b16 a[240:241], v7 offset:34816
    ds_read_b64_tr_b16 a[242:243], v7 offset:35840
    v_mfma_f32_32x32x16_bf16 v[192:207], a[252:255], a[220:223], v[192:207]
    ds_read_b64_tr_b16 a[244:245], v9 offset:34816
    ds_read_b64_tr_b16 a[246:247], v9 offset:35840
    s_waitcnt lgkmcnt(8)
    v_mfma_f32_32x32x16_bf16 v[192:207], a[224:227], v[32:35], v[192:207]
    ds_read_b64_tr_b16 a[248:249], v11 offset:34816
    ds_read_b64_tr_b16 a[250:251], v11 offset:35840
    v_mfma_f32_32x32x16_bf16 v[192:207], a[228:231], v[36:39], v[192:207]
    ds_read_b64_tr_b16 a[252:253], v13 offset:34816
    ds_read_b64_tr_b16 a[254:255], v13 offset:35840
    s_waitcnt lgkmcnt(8)
    v_mfma_f32_32x32x16_bf16 v[192:207], a[232:235], v[40:43], v[192:207]
    v_mfma_f32_32x32x16_bf16 v[192:207], a[236:239], v[44:47], v[192:207]
    s_waitcnt lgkmcnt(4)
    v_mfma_f32_32x32x16_bf16 v[192:207], a[240:243], v[48:51], v[192:207]
    s_xor_b32 s76, s80, 0x800
    buffer_load_dwordx4 v[64:67], v1, s[52:55], s76 offen offset:0
    v_mfma_f32_32x32x16_bf16 v[192:207], a[244:247], v[52:55], v[192:207]
    s_waitcnt lgkmcnt(0)
    v_mfma_f32_32x32x16_bf16 v[192:207], a[248:251], v[56:59], v[192:207]
    buffer_load_dwordx4 v[68:71], v1, s[52:55], s76 offen offset:1024
    v_mfma_f32_32x32x16_bf16 v[192:207], a[252:255], v[60:63], v[192:207]
    s_waitcnt vmcnt(4)
    v_xor_b32 v72, v72, v184
    v_xor_b32 v73, v73, v185
    v_xor_b32 v74, v74, v186
    v_xor_b32 v75, v75, v187
    v_or_b32 v21, v72, v73
    v_xor_b32 v76, v76, v184
    v_xor_b32 v77, v77, v185
    v_or_b32 v20, v74, v75
    v_xor_b32 v78, v78, v186
    v_xor_b32 v79, v79, v187
    v_or3_b32 v21, v76, v77, v21
    v_xor_b32 v80, v80, v184
    v_xor_b32 v81, v81, v185
    v_or3_b32 v20, v78, v79, v20
    v_xor_b32 v82, v82, v186
    v_xor_b32 v83, v83, v187
    v_or3_b32 v21, v80, v81, v21
    v_xor_b32 v84, v84, v184
    v_xor_b32 v85, v85, v185
    v_or3_b32 v20, v82, v83, v20
    v_xor_b32 v86, v86, v186
    v_xor_b32 v87, v87, v187
    v_or3_b32 v21, v84, v85, v21
    v_or3_b32 v20, v86, v87, v20
    v_bitop3_b32 v20, v20, v21, s81 bitop3:0xa8
    v_cmp_ne_u32 vcc, 0, v20
    s_cbranch_vccnz k_rlp2
k_rbp2:
    v_fma_mix_f32 v96, v72, 1.0, v80 op_sel:[0,0,0] op_sel_hi:[1,0,1]
    v_fma_mix_f32 v97, v72, 1.0, v80 op_sel:[1,0,1] op_sel_hi:[1,0,1]
    v_fma_mix_f32 v98, v73, 1.0, v81 op_sel:[0,0,0] op_sel_hi:[1,0,1]
    v_fma_mix_f32 v99, v73, 1.0, v81 op_sel:[1,0,1] op_sel_hi:[1,0,1]
    v_fma_mix_f32 v100, v74, 1.0, v82 op_sel:[0,0,0] op_sel_hi:[1,0,1]
    v_fma_mix_f32 v101, v74, 1.0, v82 op_sel:[1,0,1] op_sel_hi:[1,0,1]
    v_fma_mix_f32 v102, v75, 1.0, v83 op_sel:[0,0,0] op_sel_hi:[1,0,1]
    v_fma_mix_f32 v103, v75, 1.0, v83 op_sel:[1,0,1] op_sel_hi:[1,0,1]
    v_fma_mix_f32 v104, v76, 1.0, v84 op_sel:[0,0,0] op_sel_hi:[1,0,1]
    v_fma_mix_f32 v105, v76, 1.0, v84 op_sel:[1,0,1] op_sel_hi:[1,0,1]
    v_fma_mix_f32 v106, v77, 1.0, v85 op_sel:[0,0,0] op_sel_hi:[1,0,1]
    v_fma_mix_f32 v107, v77, 1.0, v85 op_sel:[1,0,1] op_sel_hi:[1,0,1]
    v_fma_mix_f32 v108, v78, 1.0, v86 op_sel:[0,0,0] op_sel_hi:[1,0,1]
    v_fma_mix_f32 v109, v78, 1.0, v86 op_sel:[1,0,1] op_sel_hi:[1,0,1]
    v_fma_mix_f32 v110, v79, 1.0, v87 op_sel:[0,0,0] op_sel_hi:[1,0,1]
    v_fma_mix_f32 v111, v79, 1.0, v87 op_sel:[1,0,1] op_sel_hi:[1,0,1]
    v_add_f32 v96, v96, v192
    v_add_f32 v97, v97, v193
    v_add_f32 v98, v98, v194
    v_add_f32 v99, v99, v195
    v_add_f32 v100, v100, v196
    v_add_f32 v101, v101, v197
    v_add_f32 v102, v102, v198
    v_add_f32 v103, v103, v199
    v_add_f32 v104, v104, v200
    v_add_f32 v105, v105, v201
    v_add_f32 v106, v106, v202
    v_add_f32 v107, v107, v203
    v_add_f32 v108, v108, v204
    v_add_f32 v109, v109, v205
    v_add_f32 v110, v110, v206
    v_add_f32 v111, v111, v207
    s_waitcnt vmcnt(0)
    v_xor_b32 v64, v64, v184
    v_xor_b32 v65, v65, v185
    v_xor_b32 v66, v66, v186
    v_xor_b32 v67, v67, v187
    v_or_b32 v21, v64, v65
    v_xor_b32 v68, v68, v184
    v_xor_b32 v69, v69, v185
    v_or_b32 v20, v66, v67
    v_xor_b32 v70, v70, v186
    v_xor_b32 v71, v71, v187
    v_or3_b32 v21, v68, v69, v21
    v_or3_b32 v20, v70, v71, v20
    v_bitop3_b32 v20, v20, v21, s81 bitop3:0xa8
    v_cmp_ne_u32 vcc, 0, v20
    s_cbranch_vccnz k_rlp1
k_rbp1:
    v_fma_mix_f32 v96, v64, 1.0, v96 op_sel:[0,0,0] op_sel_hi:[1,0,0]
    v_fma_mix_f32 v97, v64, 1.0, v97 op_sel:[1,0,0] op_sel_hi:[1,0,0]
    v_fma_mix_f32 v98, v65, 1.0, v98 op_sel:[0,0,0] op_sel_hi:[1,0,0]
    v_fma_mix_f32 v99, v65, 1.0, v99 op_sel:[1,0,0] op_sel_hi:[1,0,0]
    v_fma_mix_f32 v100, v66, 1.0, v100 op_sel:[0,0,0] op_sel_hi:[1,0,0]
    v_fma_mix_f32 v101, v66, 1.0, v101 op_sel:[1,0,0] op_sel_hi:[1,0,0]
    v_fma_mix_f32 v102, v67, 1.0, v102 op_sel:[0,0,0] op_sel_hi:[1,0,0]
    v_fma_mix_f32 v103, v67, 1.0, v103 op_sel:[1,0,0] op_sel_hi:[1,0,0]
    v_cvt_pk_bf16_f32 v192, v96, v97
    v_cvt_pk_bf16_f32 v193, v98, v99
    v_cvt_pk_bf16_f32 v194, v100, v101
    v_cvt_pk_bf16_f32 v195, v102, v103
    buffer_store_dwordx4 v[192:195], v22, s[20:23], 0 offen offset:0
    v_fma_mix_f32 v104, v68, 1.0, v104 op_sel:[0,0,0] op_sel_hi:[1,0,0]
    v_fma_mix_f32 v105, v68, 1.0, v105 op_sel:[1,0,0] op_sel_hi:[1,0,0]
    v_fma_mix_f32 v106, v69, 1.0, v106 op_sel:[0,0,0] op_sel_hi:[1,0,0]
    v_fma_mix_f32 v107, v69, 1.0, v107 op_sel:[1,0,0] op_sel_hi:[1,0,0]
    v_fma_mix_f32 v108, v70, 1.0, v108 op_sel:[0,0,0] op_sel_hi:[1,0,0]
    v_fma_mix_f32 v109, v70, 1.0, v109 op_sel:[1,0,0] op_sel_hi:[1,0,0]
    v_fma_mix_f32 v110, v71, 1.0, v110 op_sel:[0,0,0] op_sel_hi:[1,0,0]
    v_fma_mix_f32 v111, v71, 1.0, v111 op_sel:[1,0,0] op_sel_hi:[1,0,0]
    v_cvt_pk_bf16_f32 v196, v104, v105
    v_cvt_pk_bf16_f32 v197, v106, v107
    v_cvt_pk_bf16_f32 v198, v108, v109
    v_cvt_pk_bf16_f32 v199, v110, v111
    buffer_store_dwordx4 v[196:199], v22, s[20:23], 0 offen offset:16
k_exit:
    s_endpgm
k_r0:
    v_cmp_gt_u32 vcc, 32, v0
    v_mov_b32 v16, 0x3f80
    v_mov_b32 v145, 0
    v_mov_b32 v146, 0
    v_mov_b32 v147, 0
    v_cndmask_b32 v144, 0, v16, vcc
    v_mov_b32 v149, 0
    v_mov_b32 v150, 0
    v_mov_b32 v151, 0
    v_mov_b32 v153, 0
    v_mov_b32 v154, 0
    v_mov_b32 v155, 0
    v_mov_b32 v156, 0xf149f2ca
    v_mov_b32 v157, 0xf149f2ca
    v_mov_b32 v158, 0xf149f2ca
    v_mov_b32 v159, 0xf149f2ca
    s_waitcnt vmcnt(9)
    v_mfma_f32_32x32x16_bf16 v[32:47], a[160:163], a[184:187], v[192:207]
    v_mfma_f32_32x32x16_bf16 v[48:63], a[160:163], a[188:191], 0
    s_waitcnt vmcnt(8)
    v_mfma_f32_32x32x16_bf16 v[64:79], a[172:175], a[188:191], v[192:207]
    s_nop 8
    v_max3_f32 v156, v32, v33, v156
    v_max3_f32 v157, v34, v35, v157
    v_max3_f32 v156, v36, v37, v156
    v_max3_f32 v157, v38, v39, v157
    s_mov_b64 exec, s[78:79]
    buffer_load_dwordx4 a[92:95], v23, s[52:55], s30 offen offset:0
    buffer_load_dwordx4 a[96:99], v23, s[52:55], s30 offen offset:512
    s_mov_b64 exec, -1
    v_max3_f32 v156, v40, v41, v156
    v_max3_f32 v157, v42, v43, v157
    v_max3_f32 v156, v44, v45, v156
    v_max3_f32 v157, v46, v47, v157
    v_max3_f32 v158, v48, v49, v158
    v_max3_f32 v159, v50, v51, v159
    v_max3_f32 v158, v52, v53, v158
    v_max3_f32 v159, v54, v55, v159
    v_max3_f32 v158, v56, v57, v158
    v_max3_f32 v159, v58, v59, v159
    v_max3_f32 v158, v60, v61, v158
    v_max3_f32 v159, v62, v63, v159
    v_max3_f32 v158, v64, v65, v158
    v_max3_f32 v159, v66, v67, v159
    v_max3_f32 v158, v68, v69, v158
    v_max3_f32 v159, v70, v71, v159
    s_mov_b64 exec, s[78:79]
    buffer_load_dwordx4 a[104:107], v23, s[52:55], s31 offen offset:0
    buffer_load_dwordx4 a[108:111], v23, s[52:55], s31 offen offset:512
    s_mov_b64 exec, -1
    v_max3_f32 v158, v72, v73, v158
    v_max3_f32 v159, v74, v75, v159
    v_max3_f32 v158, v76, v77, v158
    v_max3_f32 v159, v78, v79, v159
    s_mov_b64 exec, s[78:79]
    buffer_load_dwordx4 a[116:119], v23, s[52:55], s32 offen offset:0
    buffer_load_dwordx4 a[120:123], v23, s[52:55], s32 offen offset:512
    s_mov_b64 exec, -1
    s_mov_b64 exec, s[78:79]
    buffer_load_dwordx4 a[128:131], v23, s[52:55], s33 offen offset:0
    buffer_load_dwordx4 a[132:135], v23, s[52:55], s33 offen offset:512
    s_mov_b64 exec, -1
    s_mov_b64 exec, s[78:79]
    buffer_load_dwordx4 a[140:143], v23, s[52:55], s34 offen offset:0
    buffer_load_dwordx4 a[144:147], v23, s[52:55], s34 offen offset:512
    s_mov_b64 exec, -1
    s_mov_b64 exec, s[78:79]
    buffer_load_dwordx4 a[152:155], v23, s[52:55], s35 offen offset:0
    buffer_load_dwordx4 a[156:159], v23, s[52:55], s35 offen offset:512
    s_mov_b64 exec, -1
    s_mov_b64 exec, s[78:79]
    buffer_load_dwordx4 a[164:167], v23, s[52:55], s36 offen offset:0
    buffer_load_dwordx4 a[168:171], v23, s[52:55], s36 offen offset:512
    s_mov_b64 exec, -1
    s_mov_b64 exec, s[78:79]
    buffer_load_dwordx4 a[176:179], v23, s[52:55], s37 offen offset:0
    buffer_load_dwordx4 a[180:183], v23, s[52:55], s37 offen offset:512
    s_mov_b64 exec, -1
    v_max_f32 v156, v156, v157
    v_max_f32 v158, v158, v159
    v_mov_b32 v157, v156
    v_mov_b32 v159, v158
    s_nop 0
    v_permlane32_swap_b32 v156, v157
    v_permlane32_swap_b32 v158, v159
    v_max_f32 v156, v156, v157
    v_max_f32 v158, v158, v159
    v_cvt_pk_bf16_f32 v148, -v156, 0
    v_cvt_pk_bf16_f32 v152, -v158, 0
    s_nop 0
    v_mfma_f32_32x32x16_bf16 v[32:47], v[144:147], v[148:151], v[192:207]
    v_mfma_f32_32x32x16_bf16 v[32:47], a[160:163], a[184:187], v[32:47]
    v_mfma_f32_32x32x16_bf16 v[96:111], v[144:147], v[152:155], 0
    v_mfma_f32_32x32x16_bf16 v[48:63], a[160:163], a[188:191], v[96:111]
    s_nop 9
    v_exp_f32 v32, v32
    v_exp_f32 v33, v33
    v_exp_f32 v34, v34
    v_exp_f32 v35, v35
    v_exp_f32 v36, v36
    v_exp_f32 v37, v37
    v_exp_f32 v38, v38
    v_exp_f32 v39, v39
    v_mfma_f32_32x32x16_bf16 v[64:79], v[144:147], v[152:155], v[192:207]
    v_mfma_f32_32x32x16_bf16 v[64:79], a[172:175], a[188:191], v[64:79]
    v_exp_f32 v40, v40
    v_cvt_pk_bf16_f32 v32, v32, v33
    v_cvt_pk_bf16_f32 v33, v34, v35
    v_cvt_pk_bf16_f32 v34, v36, v37
    v_cvt_pk_bf16_f32 v35, v38, v39
    v_exp_f32 v41, v41
    v_exp_f32 v42, v42
    v_exp_f32 v43, v43
    s_waitcnt vmcnt(2)
    v_mfma_f32_32x32x16_bf16 v[112:127], a[164:167], v[32:35], 0
    v_exp_f32 v44, v44
    s_add_u32 s83, s0, 0x1840000
    s_mov_b64 exec, 1
    buffer_store_dwordx2 v[28:29], off, s[52:55], s83 sc1
    s_mov_b64 exec, -1
    v_exp_f32 v45, v45
    s_mov_b32 s83, 0x1820000
    buffer_load_dwordx2 v[26:27], v4, s[52:55], s83 offen
    v_exp_f32 v46, v46
    s_add_u32 m0, s73, 0
    s_xor_b32 s77, s48, 0x100080
    buffer_load_dwordx4 v24, s[4:7], s77 offen lds
    buffer_load_dwordx4 v25, s[4:7], s77 offen offset:1024 lds
    v_exp_f32 v47, v47
    v_cvt_pk_bf16_f32 v36, v40, v41
    v_cvt_pk_bf16_f32 v37, v42, v43
    v_cvt_pk_bf16_f32 v38, v44, v45
    v_cvt_pk_bf16_f32 v39, v46, v47
    v_exp_f32 v48, v48
    v_exp_f32 v49, v49
    v_exp_f32 v50, v50
    v_exp_f32 v51, v51
    v_mfma_f32_32x32x16_bf16 v[112:127], a[168:171], v[36:39], v[112:127]
    v_exp_f32 v52, v52
    v_exp_f32 v53, v53
    v_exp_f32 v54, v54
    v_exp_f32 v55, v55
    v_exp_f32 v56, v56
    v_cvt_pk_bf16_f32 v48, v48, v49
    v_cvt_pk_bf16_f32 v49, v50, v51
    v_cvt_pk_bf16_f32 v50, v52, v53
    v_cvt_pk_bf16_f32 v51, v54, v55
    v_exp_f32 v57, v57
    v_exp_f32 v58, v58
    v_exp_f32 v59, v59
    v_mfma_f32_32x32x16_bf16 v[128:143], a[164:167], v[48:51], 0
    v_exp_f32 v60, v60
    s_add_u32 m0, s73, 2048
    s_xor_b32 s77, s48, 0x110080
    buffer_load_dwordx4 v24, s[4:7], s77 offen lds
    buffer_load_dwordx4 v25, s[4:7], s77 offen offset:1024 lds
    v_exp_f32 v61, v61
    s_add_u32 m0, s73, 4096
    s_xor_b32 s77, s49, 0x180080
    buffer_load_dwordx4 v24, s[4:7], s77 offen lds
    buffer_load_dwordx4 v25, s[4:7], s77 offen offset:1024 lds
    v_exp_f32 v62, v62
    s_add_u32 m0, s73, 6144
    s_xor_b32 s77, s19, 0x80
    buffer_load_dwordx4 v24, s[4:7], s77 offen lds
    buffer_load_dwordx4 v25, s[4:7], s77 offen offset:1024 lds
    v_exp_f32 v63, v63
    v_cvt_pk_bf16_f32 v52, v56, v57
    v_cvt_pk_bf16_f32 v53, v58, v59
    v_cvt_pk_bf16_f32 v54, v60, v61
    v_cvt_pk_bf16_f32 v55, v62, v63
    v_exp_f32 v64, v64
    v_exp_f32 v65, v65
    v_exp_f32 v66, v66
    v_exp_f32 v67, v67
    v_mfma_f32_32x32x16_bf16 v[128:143], a[168:171], v[52:55], v[128:143]
    v_exp_f32 v68, v68
    v_exp_f32 v69, v69
    v_exp_f32 v70, v70
    v_exp_f32 v71, v71
    v_exp_f32 v72, v72
    v_cvt_pk_bf16_f32 v64, v64, v65
    v_cvt_pk_bf16_f32 v65, v66, v67
    v_cvt_pk_bf16_f32 v66, v68, v69
    v_cvt_pk_bf16_f32 v67, v70, v71
    v_exp_f32 v73, v73
    v_exp_f32 v74, v74
    v_exp_f32 v75, v75
    s_waitcnt vmcnt(10)
    v_mfma_f32_32x32x16_bf16 v[128:143], a[176:179], v[64:67], v[128:143]
    v_exp_f32 v76, v76
    s_waitcnt vmcnt(8)
    v_cmp_ne_u64 vcc, v[26:27], v[28:29]
    s_cbranch_vccz pok_15
    s_movk_i32 s101, 30000
    s_mov_b32 s83, 0x1820000
plp_16:
    s_mov_b64 exec, vcc
    buffer_load_dwordx2 v[26:27], v4, s[52:55], s83 offen sc1
    s_mov_b64 exec, -1
    s_waitcnt vmcnt(0)
    v_cmp_ne_u64 vcc, v[26:27], v[28:29]
    s_cbranch_vccz pok_15
    s_sub_u32 s101, s101, 1
    s_cbranch_scc0 plp_16
pok_15:
    v_exp_f32 v77, v77
    s_xor_b32 s76, s17, 0x10000
    buffer_load_dwordx4 a[0:3], v30, s[52:55], s76 offen offset:0
    buffer_load_dwordx4 a[4:7], v30, s[52:55], s76 offen offset:1024
    v_exp_f32 v78, v78
    buffer_load_dwordx4 a[8:11], v30, s[52:55], s76 offen offset:2048
    buffer_load_dwordx4 a[12:15], v30, s[52:55], s76 offen offset:3072
    v_exp_f32 v79, v79
    v_cvt_pk_bf16_f32 v68, v72, v73
    v_cvt_pk_bf16_f32 v69, v74, v75
    v_cvt_pk_bf16_f32 v70, v76, v77
    v_cvt_pk_bf16_f32 v71, v78, v79
    s_nop 1
    v_mfma_f32_32x32x16_bf16 v[128:143], a[180:183], v[68:71], v[128:143]
    s_xor_b32 s76, s17, 0x11000
    buffer_load_dwordx4 a[16:19], v30, s[52:55], s76 offen offset:0
    buffer_load_dwordx4 a[20:23], v30, s[52:55], s76 offen offset:1024
    buffer_load_dwordx4 a[24:27], v30, s[52:55], s76 offen offset:2048
    buffer_load_dwordx4 a[28:31], v30, s[52:55], s76 offen offset:3072
    s_xor_b32 s76, s18, 0x18000
    buffer_load_dwordx4 a[32:35], v30, s[52:55], s76 offen offset:0
    buffer_load_dwordx4 a[36:39], v30, s[52:55], s76 offen offset:1024
    buffer_load_dwordx4 a[40:43], v30, s[52:55], s76 offen offset:2048
    buffer_load_dwordx4 a[44:47], v30, s[52:55], s76 offen offset:3072
    s_add_u32 m0, s73, 8192
    s_xor_b32 s77, s19, 0x10080
    buffer_load_dwordx4 v24, s[4:7], s77 offen lds
    buffer_load_dwordx4 v25, s[4:7], s77 offen offset:1024 lds
    s_mov_b32 s83, 0x1840000
    buffer_load_dwordx2 v[26:27], v4, s[52:55], s83 offen
    s_add_u32 m0, s73, 10240
    s_xor_b32 s77, s19, 0x80080
    buffer_load_dwordx4 v24, s[4:7], s77 offen lds
    buffer_load_dwordx4 v25, s[4:7], s77 offen offset:1024 lds
    s_add_u32 m0, s73, 12288
    s_xor_b32 s77, s19, 0x90080
    buffer_load_dwordx4 v24, s[4:7], s77 offen lds
    buffer_load_dwordx4 v25, s[4:7], s77 offen offset:1024 lds
    s_add_u32 m0, s73, 14336
    s_xor_b32 s77, s48, 0x80
    buffer_load_dwordx4 v24, s[12:15], s77 offen lds
    buffer_load_dwordx4 v25, s[12:15], s77 offen offset:1024 lds
    s_add_u32 m0, s73, 16384
    s_xor_b32 s77, s48, 0x10080
    buffer_load_dwordx4 v24, s[12:15], s77 offen lds
    buffer_load_dwordx4 v25, s[12:15], s77 offen offset:1024 lds
    s_waitcnt vmcnt(8)
    v_cmp_ne_u64 vcc, v[26:27], v[28:29]
    s_cbranch_vccz pok_17
    s_movk_i32 s101, 30000
    s_mov_b32 s83, 0x1840000
plp_18:
    s_mov_b64 exec, vcc
    buffer_load_dwordx2 v[26:27], v4, s[52:55], s83 offen sc1
    s_mov_b64 exec, -1
    s_waitcnt vmcnt(0)
    v_cmp_ne_u64 vcc, v[26:27], v[28:29]
    s_cbranch_vccz pok_17
    s_sub_u32 s101, s101, 1
    s_cbranch_scc0 plp_18
pok_17:
    s_xor_b32 s76, s16, 0x1000
    buffer_load_dwordx4 a[48:51], v30, s[52:55], s76 offen offset:0
    buffer_load_dwordx4 a[52:55], v30, s[52:55], s76 offen offset:1024
    buffer_load_dwordx4 a[56:59], v30, s[52:55], s76 offen offset:2048
    buffer_load_dwordx4 a[60:63], v30, s[52:55], s76 offen offset:3072
    s_xor_b32 s76, s16, 0x8000
    buffer_load_dwordx4 a[192:195], v30, s[52:55], s76 offen offset:0
    buffer_load_dwordx4 a[196:199], v30, s[52:55], s76 offen offset:1024
    buffer_load_dwordx4 a[200:203], v30, s[52:55], s76 offen offset:2048
    buffer_load_dwordx4 a[204:207], v30, s[52:55], s76 offen offset:3072
    s_xor_b32 s76, s16, 0x9000
    buffer_load_dwordx4 a[208:211], v30, s[52:55], s76 offen offset:0
    buffer_load_dwordx4 a[212:215], v30, s[52:55], s76 offen offset:1024
    buffer_load_dwordx4 a[216:219], v30, s[52:55], s76 offen offset:2048
    buffer_load_dwordx4 a[220:223], v30, s[52:55], s76 offen offset:3072
    v_rcp_f32 v120, v120
    s_nop 0
    v_mul_f32 v112, v112, v120
    v_mul_f32 v113, v113, v120
    v_mul_f32 v114, v114, v120
    v_mul_f32 v115, v115, v120
    v_mul_f32 v116, v116, v120
    v_mul_f32 v117, v117, v120
    v_mul_f32 v118, v118, v120
    v_mul_f32 v119, v119, v120
    v_cvt_pk_bf16_f32 v112, v112, v113
    v_cvt_pk_bf16_f32 v113, v114, v115
    v_cvt_pk_bf16_f32 v114, v116, v117
    v_cvt_pk_bf16_f32 v115, v118, v119
    buffer_store_dwordx4 v[112:115], v1, s[52:55], s38 offen sc1
    v_rcp_f32 v136, v136
    s_nop 0
    v_mul_f32 v128, v128, v136
    v_mul_f32 v129, v129, v136
    v_mul_f32 v130, v130, v136
    v_mul_f32 v131, v131, v136
    v_mul_f32 v132, v132, v136
    v_mul_f32 v133, v133, v136
    v_mul_f32 v134, v134, v136
    v_mul_f32 v135, v135, v136
    v_cvt_pk_bf16_f32 v128, v128, v129
    v_cvt_pk_bf16_f32 v129, v130, v131
    v_cvt_pk_bf16_f32 v130, v132, v133
    v_cvt_pk_bf16_f32 v131, v134, v135
    buffer_store_dwordx4 v[128:131], v1, s[52:55], s39 offen sc1
    s_branch k_g2
k_r1:
    v_cmp_gt_u32 vcc, 32, v0
    v_mov_b32 v16, 0x3f80
    v_mov_b32 v145, 0
    v_mov_b32 v146, 0
    v_mov_b32 v147, 0
    v_cndmask_b32 v144, 0, v16, vcc
    v_mov_b32 v149, 0
    v_mov_b32 v150, 0
    v_mov_b32 v151, 0
    v_mov_b32 v153, 0
    v_mov_b32 v154, 0
    v_mov_b32 v155, 0
    v_mov_b32 v156, 0xf149f2ca
    v_mov_b32 v157, 0xf149f2ca
    v_mov_b32 v158, 0xf149f2ca
    v_mov_b32 v159, 0xf149f2ca
    s_waitcnt vmcnt(11)
    v_mfma_f32_32x32x16_bf16 v[32:47], a[136:139], a[184:187], 0
    v_mfma_f32_32x32x16_bf16 v[48:63], a[136:139], a[188:191], 0
    s_waitcnt vmcnt(10)
    v_mfma_f32_32x32x16_bf16 v[64:79], a[148:151], a[184:187], 0
    s_nop 8
    v_max3_f32 v156, v32, v33, v156
    v_max3_f32 v157, v34, v35, v157
    v_max3_f32 v156, v36, v37, v156
    v_max3_f32 v157, v38, v39, v157
    s_mov_b64 exec, s[78:79]
    buffer_load_dwordx4 a[92:95], v23, s[52:55], s30 offen offset:0
    buffer_load_dwordx4 a[96:99], v23, s[52:55], s30 offen offset:512
    s_mov_b64 exec, -1
    v_max3_f32 v156, v40, v41, v156
    v_max3_f32 v157, v42, v43, v157
    v_max3_f32 v156, v44, v45, v156
    v_max3_f32 v157, v46, v47, v157
    v_mfma_f32_32x32x16_bf16 v[80:95], a[148:151], a[188:191], 0
    v_max3_f32 v158, v48, v49, v158
    v_max3_f32 v159, v50, v51, v159
    v_max3_f32 v158, v52, v53, v158
    v_max3_f32 v159, v54, v55, v159
    v_max3_f32 v158, v56, v57, v158
    v_max3_f32 v159, v58, v59, v159
    v_max3_f32 v158, v60, v61, v158
    v_max3_f32 v159, v62, v63, v159
    s_waitcnt vmcnt(11)
    v_mfma_f32_32x32x16_bf16 v[96:111], a[160:163], a[184:187], v[192:207]
    v_max3_f32 v156, v64, v65, v156
    v_max3_f32 v157, v66, v67, v157
    v_max3_f32 v156, v68, v69, v156
    v_max3_f32 v157, v70, v71, v157
    s_mov_b64 exec, s[78:79]
    buffer_load_dwordx4 a[104:107], v23, s[52:55], s31 offen offset:0
    buffer_load_dwordx4 a[108:111], v23, s[52:55], s31 offen offset:512
    s_mov_b64 exec, -1
    v_max3_f32 v156, v72, v73, v156
    v_max3_f32 v157, v74, v75, v157
    v_max3_f32 v156, v76, v77, v156
    v_max3_f32 v157, v78, v79, v157
    v_mfma_f32_32x32x16_bf16 v[32:47], a[160:163], a[188:191], 0
    v_max3_f32 v158, v80, v81, v158
    v_max3_f32 v159, v82, v83, v159
    v_max3_f32 v158, v84, v85, v158
    v_max3_f32 v159, v86, v87, v159
    v_max3_f32 v158, v88, v89, v158
    v_max3_f32 v159, v90, v91, v159
    v_max3_f32 v158, v92, v93, v158
    v_max3_f32 v159, v94, v95, v159
    s_waitcnt vmcnt(12)
    v_mfma_f32_32x32x16_bf16 v[48:63], a[172:175], a[188:191], v[192:207]
    v_max3_f32 v156, v96, v97, v156
    v_max3_f32 v157, v98, v99, v157
    v_max3_f32 v156, v100, v101, v156
    v_max3_f32 v157, v102, v103, v157
    s_mov_b64 exec, s[78:79]
    buffer_load_dwordx4 a[116:119], v23, s[52:55], s32 offen offset:0
    buffer_load_dwordx4 a[120:123], v23, s[52:55], s32 offen offset:512
    s_mov_b64 exec, -1
    v_max3_f32 v156, v104, v105, v156
    v_max3_f32 v157, v106, v107, v157
    v_max3_f32 v156, v108, v109, v156
    v_max3_f32 v157, v110, v111, v157
    v_max3_f32 v158, v32, v33, v158
    v_max3_f32 v159, v34, v35, v159
    v_max3_f32 v158, v36, v37, v158
    v_max3_f32 v159, v38, v39, v159
    v_max3_f32 v158, v40, v41, v158
    v_max3_f32 v159, v42, v43, v159
    v_max3_f32 v158, v44, v45, v158
    v_max3_f32 v159, v46, v47, v159
    v_max3_f32 v158, v48, v49, v158
    v_max3_f32 v159, v50, v51, v159
    v_max3_f32 v158, v52, v53, v158
    v_max3_f32 v159, v54, v55, v159
    s_mov_b64 exec, s[78:79]
    buffer_load_dwordx4 a[128:131], v23, s[52:55], s33 offen offset:0
    buffer_load_dwordx4 a[132:135], v23, s[52:55], s33 offen offset:512
    s_mov_b64 exec, -1
    v_max3_f32 v158, v56, v57, v158
    v_max3_f32 v159, v58, v59, v159
    v_max3_f32 v158, v60, v61, v158
    v_max3_f32 v159, v62, v63, v159
    s_mov_b64 exec, s[78:79]
    buffer_load_dwordx4 a[140:143], v23, s[52:55], s34 offen offset:0
    buffer_load_dwordx4 a[144:147], v23, s[52:55], s34 offen offset:512
    s_mov_b64 exec, -1
    s_mov_b64 exec, s[78:79]
    buffer_load_dwordx4 a[152:155], v23, s[52:55], s35 offen offset:0
    buffer_load_dwordx4 a[156:159], v23, s[52:55], s35 offen offset:512
    s_mov_b64 exec, -1
    s_mov_b64 exec, s[78:79]
    buffer_load_dwordx4 a[164:167], v23, s[52:55], s36 offen offset:0
    buffer_load_dwordx4 a[168:171], v23, s[52:55], s36 offen offset:512
    s_mov_b64 exec, -1
    s_mov_b64 exec, s[78:79]
    buffer_load_dwordx4 a[176:179], v23, s[52:55], s37 offen offset:0
    buffer_load_dwordx4 a[180:183], v23, s[52:55], s37 offen offset:512
    s_mov_b64 exec, -1
    v_max_f32 v156, v156, v157
    v_max_f32 v158, v158, v159
    v_mov_b32 v157, v156
    v_mov_b32 v159, v158
    s_nop 0
    v_permlane32_swap_b32 v156, v157
    v_permlane32_swap_b32 v158, v159
    v_max_f32 v156, v156, v157
    v_max_f32 v158, v158, v159
    v_cvt_pk_bf16_f32 v148, -v156, 0
    v_cvt_pk_bf16_f32 v152, -v158, 0
    s_nop 0
    v_mfma_f32_32x32x16_bf16 v[80:95], v[144:147], v[148:151], 0
    v_mfma_f32_32x32x16_bf16 v[32:47], a[136:139], a[184:187], v[80:95]
    v_mfma_f32_32x32x16_bf16 v[96:111], v[144:147], v[152:155], 0
    v_mfma_f32_32x32x16_bf16 v[48:63], a[136:139], a[188:191], v[96:111]
    s_nop 9
    v_exp_f32 v32, v32
    v_exp_f32 v33, v33
    v_exp_f32 v34, v34
    v_exp_f32 v35, v35
    v_exp_f32 v36, v36
    v_exp_f32 v37, v37
    v_exp_f32 v38, v38
    v_exp_f32 v39, v39
    v_mfma_f32_32x32x16_bf16 v[64:79], a[148:151], a[184:187], v[80:95]
    v_exp_f32 v40, v40
    v_cvt_pk_bf16_f32 v32, v32, v33
    v_cvt_pk_bf16_f32 v33, v34, v35
    v_cvt_pk_bf16_f32 v34, v36, v37
    v_cvt_pk_bf16_f32 v35, v38, v39
    v_exp_f32 v41, v41
    v_exp_f32 v42, v42
    v_exp_f32 v43, v43
    s_waitcnt vmcnt(6)
    v_mfma_f32_32x32x16_bf16 v[112:127], a[140:143], v[32:35], 0
    v_exp_f32 v44, v44
    s_add_u32 s83, s0, 0x1840000
    s_mov_b64 exec, 1
    buffer_store_dwordx2 v[28:29], off, s[52:55], s83 sc1
    s_mov_b64 exec, -1
    v_exp_f32 v45, v45
    s_mov_b32 s83, 0x1820000
    buffer_load_dwordx2 v[26:27], v4, s[52:55], s83 offen
    v_exp_f32 v46, v46
    s_add_u32 m0, s73, 0
    s_xor_b32 s77, s48, 0x100080
    buffer_load_dwordx4 v24, s[4:7], s77 offen lds
    buffer_load_dwordx4 v25, s[4:7], s77 offen offset:1024 lds
    v_exp_f32 v47, v47
    v_cvt_pk_bf16_f32 v36, v40, v41
    v_cvt_pk_bf16_f32 v37, v42, v43
    v_cvt_pk_bf16_f32 v38, v44, v45
    v_cvt_pk_bf16_f32 v39, v46, v47
    v_exp_f32 v48, v48
    v_exp_f32 v49, v49
    v_exp_f32 v50, v50
    v_exp_f32 v51, v51
    v_mfma_f32_32x32x16_bf16 v[112:127], a[144:147], v[36:39], v[112:127]
    v_exp_f32 v52, v52
    v_exp_f32 v53, v53
    v_exp_f32 v54, v54
    v_exp_f32 v55, v55
    v_mfma_f32_32x32x16_bf16 v[32:47], a[148:151], a[188:191], v[96:111]
    v_exp_f32 v56, v56
    v_cvt_pk_bf16_f32 v48, v48, v49
    v_cvt_pk_bf16_f32 v49, v50, v51
    v_cvt_pk_bf16_f32 v50, v52, v53
    v_cvt_pk_bf16_f32 v51, v54, v55
    v_exp_f32 v57, v57
    v_exp_f32 v58, v58
    v_exp_f32 v59, v59
    v_mfma_f32_32x32x16_bf16 v[128:143], a[140:143], v[48:51], 0
    v_exp_f32 v60, v60
    s_add_u32 m0, s73, 2048
    s_xor_b32 s77, s48, 0x110080
    buffer_load_dwordx4 v24, s[4:7], s77 offen lds
    buffer_load_dwordx4 v25, s[4:7], s77 offen offset:1024 lds
    v_exp_f32 v61, v61
    s_add_u32 m0, s73, 4096
    s_xor_b32 s77, s49, 0x180080
    buffer_load_dwordx4 v24, s[4:7], s77 offen lds
    buffer_load_dwordx4 v25, s[4:7], s77 offen offset:1024 lds
    v_exp_f32 v62, v62
    s_add_u32 m0, s73, 6144
    s_xor_b32 s77, s19, 0x80
    buffer_load_dwordx4 v24, s[4:7], s77 offen lds
    buffer_load_dwordx4 v25, s[4:7], s77 offen offset:1024 lds
    v_exp_f32 v63, v63
    v_cvt_pk_bf16_f32 v52, v56, v57
    v_cvt_pk_bf16_f32 v53, v58, v59
    v_cvt_pk_bf16_f32 v54, v60, v61
    v_cvt_pk_bf16_f32 v55, v62, v63
    v_exp_f32 v64, v64
    v_exp_f32 v65, v65
    v_exp_f32 v66, v66
    v_exp_f32 v67, v67
    v_mfma_f32_32x32x16_bf16 v[128:143], a[144:147], v[52:55], v[128:143]
    v_exp_f32 v68, v68
    v_exp_f32 v69, v69
    v_exp_f32 v70, v70
    v_exp_f32 v71, v71
    v_mfma_f32_32x32x16_bf16 v[48:63], v[144:147], v[148:151], v[192:207]
    v_mfma_f32_32x32x16_bf16 v[48:63], a[160:163], a[184:187], v[48:63]
    v_exp_f32 v72, v72
    v_cvt_pk_bf16_f32 v64, v64, v65
    v_cvt_pk_bf16_f32 v65, v66, v67
    v_cvt_pk_bf16_f32 v66, v68, v69
    v_cvt_pk_bf16_f32 v67, v70, v71
    v_exp_f32 v73, v73
    v_exp_f32 v74, v74
    v_exp_f32 v75, v75
    s_waitcnt vmcnt(14)
    v_mfma_f32_32x32x16_bf16 v[112:127], a[152:155], v[64:67], v[112:127]
    v_exp_f32 v76, v76
    s_waitcnt vmcnt(8)
    v_cmp_ne_u64 vcc, v[26:27], v[28:29]
    s_cbranch_vccz pok_19
    s_movk_i32 s101, 30000
    s_mov_b32 s83, 0x1820000
plp_20:
    s_mov_b64 exec, vcc
    buffer_load_dwordx2 v[26:27], v4, s[52:55], s83 offen sc1
    s_mov_b64 exec, -1
    s_waitcnt vmcnt(0)
    v_cmp_ne_u64 vcc, v[26:27], v[28:29]
    s_cbranch_vccz pok_19
    s_sub_u32 s101, s101, 1
    s_cbranch_scc0 plp_20
pok_19:
    v_exp_f32 v77, v77
    s_xor_b32 s76, s17, 0x10000
    buffer_load_dwordx4 a[0:3], v30, s[52:55], s76 offen offset:0
    buffer_load_dwordx4 a[4:7], v30, s[52:55], s76 offen offset:1024
    v_exp_f32 v78, v78
    buffer_load_dwordx4 a[8:11], v30, s[52:55], s76 offen offset:2048
    buffer_load_dwordx4 a[12:15], v30, s[52:55], s76 offen offset:3072
    v_exp_f32 v79, v79
    v_cvt_pk_bf16_f32 v68, v72, v73
    v_cvt_pk_bf16_f32 v69, v74, v75
    v_cvt_pk_bf16_f32 v70, v76, v77
    v_cvt_pk_bf16_f32 v71, v78, v79
    v_exp_f32 v32, v32
    v_exp_f32 v33, v33
    v_exp_f32 v34, v34
    v_exp_f32 v35, v35
    v_mfma_f32_32x32x16_bf16 v[112:127], a[156:159], v[68:71], v[112:127]
    v_exp_f32 v36, v36
    v_exp_f32 v37, v37
    v_exp_f32 v38, v38
    v_exp_f32 v39, v39
    v_mfma_f32_32x32x16_bf16 v[64:79], a[160:163], a[188:191], v[96:111]
    v_exp_f32 v40, v40
    v_cvt_pk_bf16_f32 v32, v32, v33
    v_cvt_pk_bf16_f32 v33, v34, v35
    v_cvt_pk_bf16_f32 v34, v36, v37
    v_cvt_pk_bf16_f32 v35, v38, v39
    v_exp_f32 v41, v41
    v_exp_f32 v42, v42
    v_exp_f32 v43, v43
    v_mfma_f32_32x32x16_bf16 v[128:143], a[152:155], v[32:35], v[128:143]
    v_exp_f32 v44, v44
    s_xor_b32 s76, s17, 0x11000
    buffer_load_dwordx4 a[16:19], v30, s[52:55], s76 offen offset:0
    buffer_load_dwordx4 a[20:23], v30, s[52:55], s76 offen offset:1024
    v_exp_f32 v45, v45
    buffer_load_dwordx4 a[24:27], v30, s[52:55], s76 offen offset:2048
    buffer_load_dwordx4 a[28:31], v30, s[52:55], s76 offen offset:3072
    v_exp_f32 v46, v46
    s_xor_b32 s76, s18, 0x18000
    buffer_load_dwordx4 a[32:35], v30, s[52:55], s76 offen offset:0
    buffer_load_dwordx4 a[36:39], v30, s[52:55], s76 offen offset:1024
    v_exp_f32 v47, v47
    v_cvt_pk_bf16_f32 v36, v40, v41
    v_cvt_pk_bf16_f32 v37, v42, v43
    v_cvt_pk_bf16_f32 v38, v44, v45
    v_cvt_pk_bf16_f32 v39, v46, v47
    v_exp_f32 v48, v48
    v_exp_f32 v49, v49
    v_exp_f32 v50, v50
    v_exp_f32 v51, v51
    v_mfma_f32_32x32x16_bf16 v[128:143], a[156:159], v[36:39], v[128:143]
    v_exp_f32 v52, v52
    v_exp_f32 v53, v53
    v_exp_f32 v54, v54
    v_exp_f32 v55, v55
    v_mfma_f32_32x32x16_bf16 v[32:47], v[144:147], v[152:155], v[192:207]
    v_mfma_f32_32x32x16_bf16 v[32:47], a[172:175], a[188:191], v[32:47]
    v_exp_f32 v56, v56
    v_cvt_pk_bf16_f32 v48, v48, v49
    v_cvt_pk_bf16_f32 v49, v50, v51
    v_cvt_pk_bf16_f32 v50, v52, v53
    v_cvt_pk_bf16_f32 v51, v54, v55
    v_exp_f32 v57, v57
    v_exp_f32 v58, v58
    v_exp_f32 v59, v59
    v_mfma_f32_32x32x16_bf16 v[112:127], a[164:167], v[48:51], v[112:127]
    v_exp_f32 v60, v60
    buffer_load_dwordx4 a[40:43], v30, s[52:55], s76 offen offset:2048
    buffer_load_dwordx4 a[44:47], v30, s[52:55], s76 offen offset:3072
    v_exp_f32 v61, v61
    s_add_u32 m0, s73, 8192
    s_xor_b32 s77, s19, 0x10080
    buffer_load_dwordx4 v24, s[4:7], s77 offen lds
    buffer_load_dwordx4 v25, s[4:7], s77 offen offset:1024 lds
    v_exp_f32 v62, v62
    s_mov_b32 s83, 0x1840000
    buffer_load_dwordx2 v[26:27], v4, s[52:55], s83 offen
    v_exp_f32 v63, v63
    v_cvt_pk_bf16_f32 v52, v56, v57
    v_cvt_pk_bf16_f32 v53, v58, v59
    v_cvt_pk_bf16_f32 v54, v60, v61
    v_cvt_pk_bf16_f32 v55, v62, v63
    v_exp_f32 v64, v64
    v_exp_f32 v65, v65
    v_exp_f32 v66, v66
    v_exp_f32 v67, v67
    v_mfma_f32_32x32x16_bf16 v[112:127], a[168:171], v[52:55], v[112:127]
    v_exp_f32 v68, v68
    v_exp_f32 v69, v69
    v_exp_f32 v70, v70
    v_exp_f32 v71, v71
    v_exp_f32 v72, v72
    v_cvt_pk_bf16_f32 v64, v64, v65
    v_cvt_pk_bf16_f32 v65, v66, v67
    v_cvt_pk_bf16_f32 v66, v68, v69
    v_cvt_pk_bf16_f32 v67, v70, v71
    v_exp_f32 v73, v73
    v_exp_f32 v74, v74
    v_exp_f32 v75, v75
    v_mfma_f32_32x32x16_bf16 v[128:143], a[164:167], v[64:67], v[128:143]
    v_exp_f32 v76, v76
    s_add_u32 m0, s73, 10240
    s_xor_b32 s77, s19, 0x80080
    buffer_load_dwordx4 v24, s[4:7], s77 offen lds
    buffer_load_dwordx4 v25, s[4:7], s77 offen offset:1024 lds
    v_exp_f32 v77, v77
    s_add_u32 m0, s73, 12288
    s_xor_b32 s77, s19, 0x90080
    buffer_load_dwordx4 v24, s[4:7], s77 offen lds
    buffer_load_dwordx4 v25, s[4:7], s77 offen offset:1024 lds
    v_exp_f32 v78, v78
    s_add_u32 m0, s73, 14336
    s_xor_b32 s77, s48, 0x80
    buffer_load_dwordx4 v24, s[12:15], s77 offen lds
    buffer_load_dwordx4 v25, s[12:15], s77 offen offset:1024 lds
    v_exp_f32 v79, v79
    v_cvt_pk_bf16_f32 v68, v72, v73
    v_cvt_pk_bf16_f32 v69, v74, v75
    v_cvt_pk_bf16_f32 v70, v76, v77
    v_cvt_pk_bf16_f32 v71, v78, v79
    v_exp_f32 v32, v32
    v_exp_f32 v33, v33
    v_exp_f32 v34, v34
    v_exp_f32 v35, v35
    v_mfma_f32_32x32x16_bf16 v[128:143], a[168:171], v[68:71], v[128:143]
    v_exp_f32 v36, v36
    v_exp_f32 v37, v37
    v_exp_f32 v38, v38
    v_exp_f32 v39, v39
    v_exp_f32 v40, v40
    v_cvt_pk_bf16_f32 v32, v32, v33
    v_cvt_pk_bf16_f32 v33, v34, v35
    v_cvt_pk_bf16_f32 v34, v36, v37
    v_cvt_pk_bf16_f32 v35, v38, v39
    v_exp_f32 v41, v41
    v_exp_f32 v42, v42
    v_exp_f32 v43, v43
    v_mfma_f32_32x32x16_bf16 v[128:143], a[176:179], v[32:35], v[128:143]
    v_exp_f32 v44, v44
    s_add_u32 m0, s73, 16384
    s_xor_b32 s77, s48, 0x10080
    buffer_load_dwordx4 v24, s[12:15], s77 offen lds
    buffer_load_dwordx4 v25, s[12:15], s77 offen offset:1024 lds
    v_exp_f32 v45, v45
    s_waitcnt vmcnt(8)
    v_cmp_ne_u64 vcc, v[26:27], v[28:29]
    s_cbranch_vccz pok_21
    s_movk_i32 s101, 30000
    s_mov_b32 s83, 0x1840000
plp_22:
    s_mov_b64 exec, vcc
    buffer_load_dwordx2 v[26:27], v4, s[52:55], s83 offen sc1
    s_mov_b64 exec, -1
    s_waitcnt vmcnt(0)
    v_cmp_ne_u64 vcc, v[26:27], v[28:29]
    s_cbranch_vccz pok_21
    s_sub_u32 s101, s101, 1
    s_cbranch_scc0 plp_22
pok_21:
    v_exp_f32 v46, v46
    s_xor_b32 s76, s16, 0x1000
    buffer_load_dwordx4 a[48:51], v30, s[52:55], s76 offen offset:0
    buffer_load_dwordx4 a[52:55], v30, s[52:55], s76 offen offset:1024
    v_exp_f32 v47, v47
    v_cvt_pk_bf16_f32 v36, v40, v41
    v_cvt_pk_bf16_f32 v37, v42, v43
    v_cvt_pk_bf16_f32 v38, v44, v45
    v_cvt_pk_bf16_f32 v39, v46, v47
    s_nop 1
    v_mfma_f32_32x32x16_bf16 v[128:143], a[180:183], v[36:39], v[128:143]
    buffer_load_dwordx4 a[56:59], v30, s[52:55], s76 offen offset:2048
    buffer_load_dwordx4 a[60:63], v30, s[52:55], s76 offen offset:3072
    s_xor_b32 s76, s16, 0x8000
    buffer_load_dwordx4 a[192:195], v30, s[52:55], s76 offen offset:0
    buffer_load_dwordx4 a[196:199], v30, s[52:55], s76 offen offset:1024
    buffer_load_dwordx4 a[200:203], v30, s[52:55], s76 offen offset:2048
    buffer_load_dwordx4 a[204:207], v30, s[52:55], s76 offen offset:3072
    s_xor_b32 s76, s16, 0x9000
    buffer_load_dwordx4 a[208:211], v30, s[52:55], s76 offen offset:0
    buffer_load_dwordx4 a[212:215], v30, s[52:55], s76 offen offset:1024
    buffer_load_dwordx4 a[216:219], v30, s[52:55], s76 offen offset:2048
    buffer_load_dwordx4 a[220:223], v30, s[52:55], s76 offen offset:3072
    v_rcp_f32 v120, v120
    s_nop 0
    v_mul_f32 v112, v112, v120
    v_mul_f32 v113, v113, v120
    v_mul_f32 v114, v114, v120
    v_mul_f32 v115, v115, v120
    v_mul_f32 v116, v116, v120
    v_mul_f32 v117, v117, v120
    v_mul_f32 v118, v118, v120
    v_mul_f32 v119, v119, v120
    v_cvt_pk_bf16_f32 v112, v112, v113
    v_cvt_pk_bf16_f32 v113, v114, v115
    v_cvt_pk_bf16_f32 v114, v116, v117
    v_cvt_pk_bf16_f32 v115, v118, v119
    buffer_store_dwordx4 v[112:115], v1, s[52:55], s38 offen sc1
    v_rcp_f32 v136, v136
    s_nop 0
    v_mul_f32 v128, v128, v136
    v_mul_f32 v129, v129, v136
    v_mul_f32 v130, v130, v136
    v_mul_f32 v131, v131, v136
    v_mul_f32 v132, v132, v136
    v_mul_f32 v133, v133, v136
    v_mul_f32 v134, v134, v136
    v_mul_f32 v135, v135, v136
    v_cvt_pk_bf16_f32 v128, v128, v129
    v_cvt_pk_bf16_f32 v129, v130, v131
    v_cvt_pk_bf16_f32 v130, v132, v133
    v_cvt_pk_bf16_f32 v131, v134, v135
    buffer_store_dwordx4 v[128:131], v1, s[52:55], s39 offen sc1
    s_branch k_g2
k_r2:
    v_cmp_gt_u32 vcc, 32, v0
    v_mov_b32 v16, 0x3f80
    v_mov_b32 v145, 0
    v_mov_b32 v146, 0
    v_mov_b32 v147, 0
    v_cndmask_b32 v144, 0, v16, vcc
    v_mov_b32 v149, 0
    v_mov_b32 v150, 0
    v_mov_b32 v151, 0
    v_mov_b32 v153, 0
    v_mov_b32 v154, 0
    v_mov_b32 v155, 0
    v_mov_b32 v156, 0xf149f2ca
    v_mov_b32 v157, 0xf149f2ca
    v_mov_b32 v158, 0xf149f2ca
    v_mov_b32 v159, 0xf149f2ca
    s_waitcnt vmcnt(13)
    v_mfma_f32_32x32x16_bf16 v[32:47], a[112:115], a[184:187], 0
    v_mfma_f32_32x32x16_bf16 v[48:63], a[112:115], a[188:191], 0
    s_waitcnt vmcnt(12)
    v_mfma_f32_32x32x16_bf16 v[64:79], a[124:127], a[184:187], 0
    s_nop 8
    v_max3_f32 v156, v32, v33, v156
    v_max3_f32 v157, v34, v35, v157
    v_max3_f32 v156, v36, v37, v156
    v_max3_f32 v157, v38, v39, v157
    s_mov_b64 exec, s[78:79]
    buffer_load_dwordx4 a[92:95], v23, s[52:55], s30 offen offset:0
    buffer_load_dwordx4 a[96:99], v23, s[52:55], s30 offen offset:512
    s_mov_b64 exec, -1
    v_max3_f32 v156, v40, v41, v156
    v_max3_f32 v157, v42, v43, v157
    v_max3_f32 v156, v44, v45, v156
    v_max3_f32 v157, v46, v47, v157
    v_mfma_f32_32x32x16_bf16 v[80:95], a[124:127], a[188:191], 0
    v_max3_f32 v158, v48, v49, v158
    v_max3_f32 v159, v50, v51, v159
    v_max3_f32 v158, v52, v53, v158
    v_max3_f32 v159, v54, v55, v159
    v_max3_f32 v158, v56, v57, v158
    v_max3_f32 v159, v58, v59, v159
    v_max3_f32 v158, v60, v61, v158
    v_max3_f32 v159, v62, v63, v159
    s_waitcnt vmcnt(13)
    v_mfma_f32_32x32x16_bf16 v[96:111], a[136:139], a[184:187], 0
    v_max3_f32 v156, v64, v65, v156
    v_max3_f32 v157, v66, v67, v157
    v_max3_f32 v156, v68, v69, v156
    v_max3_f32 v157, v70, v71, v157
    s_mov_b64 exec, s[78:79]
    buffer_load_dwordx4 a[104:107], v23, s[52:55], s31 offen offset:0
    buffer_load_dwordx4 a[108:111], v23, s[52:55], s31 offen offset:512
    s_mov_b64 exec, -1
    v_max3_f32 v156, v72, v73, v156
    v_max3_f32 v157, v74, v75, v157
    v_max3_f32 v156, v76, v77, v156
    v_max3_f32 v157, v78, v79, v157
    v_mfma_f32_32x32x16_bf16 v[32:47], a[136:139], a[188:191], 0
    v_max3_f32 v158, v80, v81, v158
    v_max3_f32 v159, v82, v83, v159
    v_max3_f32 v158, v84, v85, v158
    v_max3_f32 v159, v86, v87, v159
    v_max3_f32 v158, v88, v89, v158
    v_max3_f32 v159, v90, v91, v159
    v_max3_f32 v158, v92, v93, v158
    v_max3_f32 v159, v94, v95, v159
    s_waitcnt vmcnt(14)
    v_mfma_f32_32x32x16_bf16 v[48:63], a[148:151], a[184:187], 0
    v_max3_f32 v156, v96, v97, v156
    v_max3_f32 v157, v98, v99, v157
    v_max3_f32 v156, v100, v101, v156
    v_max3_f32 v157, v102, v103, v157
    s_mov_b64 exec, s[78:79]
    buffer_load_dwordx4 a[116:119], v23, s[52:55], s32 offen offset:0
    buffer_load_dwordx4 a[120:123], v23, s[52:55], s32 offen offset:512
    s_mov_b64 exec, -1
    v_max3_f32 v156, v104, v105, v156
    v_max3_f32 v157, v106, v107, v157
    v_max3_f32 v156, v108, v109, v156
    v_max3_f32 v157, v110, v111, v157
    v_mfma_f32_32x32x16_bf16 v[64:79], a[148:151], a[188:191], 0
    v_max3_f32 v158, v32, v33, v158
    v_max3_f32 v159, v34, v35, v159
    v_max3_f32 v158, v36, v37, v158
    v_max3_f32 v159, v38, v39, v159
    v_max3_f32 v158, v40, v41, v158
    v_max3_f32 v159, v42, v43, v159
    v_max3_f32 v158, v44, v45, v158
    v_max3_f32 v159, v46, v47, v159
    s_waitcnt vmcnt(15)
    v_mfma_f32_32x32x16_bf16 v[80:95], a[160:163], a[184:187], v[192:207]
    v_max3_f32 v156, v48, v49, v156
    v_max3_f32 v157, v50, v51, v157
    v_max3_f32 v156, v52, v53, v156
    v_max3_f32 v157, v54, v55, v157
    s_mov_b64 exec, s[78:79]
    buffer_load_dwordx4 a[128:131], v23, s[52:55], s33 offen offset:0
    buffer_load_dwordx4 a[132:135], v23, s[52:55], s33 offen offset:512
    s_mov_b64 exec, -1
    v_max3_f32 v156, v56, v57, v156
    v_max3_f32 v157, v58, v59, v157
    v_max3_f32 v156, v60, v61, v156
    v_max3_f32 v157, v62, v63, v157
    v_mfma_f32_32x32x16_bf16 v[96:111], a[160:163], a[188:191], 0
    v_max3_f32 v158, v64, v65, v158
    v_max3_f32 v159, v66, v67, v159
    v_max3_f32 v158, v68, v69, v158
    v_max3_f32 v159, v70, v71, v159
    v_max3_f32 v158, v72, v73, v158
    v_max3_f32 v159, v74, v75, v159
    v_max3_f32 v158, v76, v77, v158
    v_max3_f32 v159, v78, v79, v159
    s_waitcnt vmcnt(16)
    v_mfma_f32_32x32x16_bf16 v[32:47], a[172:175], a[188:191], v[192:207]
    v_max3_f32 v156, v80, v81, v156
    v_max3_f32 v157, v82, v83, v157
    v_max3_f32 v156, v84, v85, v156
    v_max3_f32 v157, v86, v87, v157
    s_mov_b64 exec, s[78:79]
    buffer_load_dwordx4 a[140:143], v23, s[52:55], s34 offen offset:0
    buffer_load_dwordx4 a[144:147], v23, s[52:55], s34 offen offset:512
    s_mov_b64 exec, -1
    v_max3_f32 v156, v88, v89, v156
    v_max3_f32 v157, v90, v91, v157
    v_max3_f32 v156, v92, v93, v156
    v_max3_f32 v157, v94, v95, v157
    v_max3_f32 v158, v96, v97, v158
    v_max3_f32 v159, v98, v99, v159
    v_max3_f32 v158, v100, v101, v158
    v_max3_f32 v159, v102, v103, v159
    v_max3_f32 v158, v104, v105, v158
    v_max3_f32 v159, v106, v107, v159
    v_max3_f32 v158, v108, v109, v158
    v_max3_f32 v159, v110, v111, v159
    v_max3_f32 v158, v32, v33, v158
    v_max3_f32 v159, v34, v35, v159
    v_max3_f32 v158, v36, v37, v158
    v_max3_f32 v159, v38, v39, v159
    s_mov_b64 exec, s[78:79]
    buffer_load_dwordx4 a[152:155], v23, s[52:55], s35 offen offset:0
    buffer_load_dwordx4 a[156:159], v23, s[52:55], s35 offen offset:512
    s_mov_b64 exec, -1
    v_max3_f32 v158, v40, v41, v158
    v_max3_f32 v159, v42, v43, v159
    v_max3_f32 v158, v44, v45, v158
    v_max3_f32 v159, v46, v47, v159
    s_mov_b64 exec, s[78:79]
    buffer_load_dwordx4 a[164:167], v23, s[52:55], s36 offen offset:0
    buffer_load_dwordx4 a[168:171], v23, s[52:55], s36 offen offset:512
    s_mov_b64 exec, -1
    s_mov_b64 exec, s[78:79]
    buffer_load_dwordx4 a[176:179], v23, s[52:55], s37 offen offset:0
    buffer_load_dwordx4 a[180:183], v23, s[52:55], s37 offen offset:512
    s_mov_b64 exec, -1
    v_max_f32 v156, v156, v157
    v_max_f32 v158, v158, v159
    v_mov_b32 v157, v156
    v_mov_b32 v159, v158
    s_nop 0
    v_permlane32_swap_b32 v156, v157
    v_permlane32_swap_b32 v158, v159
    v_max_f32 v156, v156, v157
    v_max_f32 v158, v158, v159
    v_cvt_pk_bf16_f32 v148, -v156, 0
    v_cvt_pk_bf16_f32 v152, -v158, 0
    s_nop 0
    v_mfma_f32_32x32x16_bf16 v[80:95], v[144:147], v[148:151], 0
    v_mfma_f32_32x32x16_bf16 v[32:47], a[112:115], a[184:187], v[80:95]
    v_mfma_f32_32x32x16_bf16 v[96:111], v[144:147], v[152:155], 0
    v_mfma_f32_32x32x16_bf16 v[48:63], a[112:115], a[188:191], v[96:111]
    s_nop 9
    v_exp_f32 v32, v32
    v_exp_f32 v33, v33
    v_exp_f32 v34, v34
    v_exp_f32 v35, v35
    v_exp_f32 v36, v36
    v_exp_f32 v37, v37
    v_exp_f32 v38, v38
    v_exp_f32 v39, v39
    v_mfma_f32_32x32x16_bf16 v[64:79], a[124:127], a[184:187], v[80:95]
    v_exp_f32 v40, v40
    v_cvt_pk_bf16_f32 v32, v32, v33
    v_cvt_pk_bf16_f32 v33, v34, v35
    v_cvt_pk_bf16_f32 v34, v36, v37
    v_cvt_pk_bf16_f32 v35, v38, v39
    v_exp_f32 v41, v41
    v_exp_f32 v42, v42
    v_exp_f32 v43, v43
    s_waitcnt vmcnt(10)
    v_mfma_f32_32x32x16_bf16 v[112:127], a[116:119], v[32:35], 0
    v_exp_f32 v44, v44
    s_add_u32 s83, s0, 0x1840000
    s_mov_b64 exec, 1
    buffer_store_dwordx2 v[28:29], off, s[52:55], s83 sc1
    s_mov_b64 exec, -1
    v_exp_f32 v45, v45
    s_mov_b32 s83, 0x1820000
    buffer_load_dwordx2 v[26:27], v4, s[52:55], s83 offen
    v_exp_f32 v46, v46
    s_add_u32 m0, s73, 0
    s_xor_b32 s77, s48, 0x100080
    buffer_load_dwordx4 v24, s[4:7], s77 offen lds
    buffer_load_dwordx4 v25, s[4:7], s77 offen offset:1024 lds
    v_exp_f32 v47, v47
    v_cvt_pk_bf16_f32 v36, v40, v41
    v_cvt_pk_bf16_f32 v37, v42, v43
    v_cvt_pk_bf16_f32 v38, v44, v45
    v_cvt_pk_bf16_f32 v39, v46, v47
    v_exp_f32 v48, v48
    v_exp_f32 v49, v49
    v_exp_f32 v50, v50
    v_exp_f32 v51, v51
    v_mfma_f32_32x32x16_bf16 v[112:127], a[120:123], v[36:39], v[112:127]
    v_exp_f32 v52, v52
    v_exp_f32 v53, v53
    v_exp_f32 v54, v54
    v_exp_f32 v55, v55
    v_mfma_f32_32x32x16_bf16 v[32:47], a[124:127], a[188:191], v[96:111]
    v_exp_f32 v56, v56
    v_cvt_pk_bf16_f32 v48, v48, v49
    v_cvt_pk_bf16_f32 v49, v50, v51
    v_cvt_pk_bf16_f32 v50, v52, v53
    v_cvt_pk_bf16_f32 v51, v54, v55
    v_exp_f32 v57, v57
    v_exp_f32 v58, v58
    v_exp_f32 v59, v59
    v_mfma_f32_32x32x16_bf16 v[128:143], a[116:119], v[48:51], 0
    v_exp_f32 v60, v60
    s_add_u32 m0, s73, 2048
    s_xor_b32 s77, s48, 0x110080
    buffer_load_dwordx4 v24, s[4:7], s77 offen lds
    buffer_load_dwordx4 v25, s[4:7], s77 offen offset:1024 lds
    v_exp_f32 v61, v61
    s_add_u32 m0, s73, 4096
    s_xor_b32 s77, s49, 0x180080
    buffer_load_dwordx4 v24, s[4:7], s77 offen lds
    buffer_load_dwordx4 v25, s[4:7], s77 offen offset:1024 lds
    v_exp_f32 v62, v62
    s_add_u32 m0, s73, 6144
    s_xor_b32 s77, s19, 0x80
    buffer_load_dwordx4 v24, s[4:7], s77 offen lds
    buffer_load_dwordx4 v25, s[4:7], s77 offen offset:1024 lds
    v_exp_f32 v63, v63
    v_cvt_pk_bf16_f32 v52, v56, v57
    v_cvt_pk_bf16_f32 v53, v58, v59
    v_cvt_pk_bf16_f32 v54, v60, v61
    v_cvt_pk_bf16_f32 v55, v62, v63
    v_exp_f32 v64, v64
    v_exp_f32 v65, v65
    v_exp_f32 v66, v66
    v_exp_f32 v67, v67
    v_mfma_f32_32x32x16_bf16 v[128:143], a[120:123], v[52:55], v[128:143]
    v_exp_f32 v68, v68
    v_exp_f32 v69, v69
    v_exp_f32 v70, v70
    v_exp_f32 v71, v71
    v_mfma_f32_32x32x16_bf16 v[48:63], a[136:139], a[184:187], v[80:95]
    v_exp_f32 v72, v72
    v_cvt_pk_bf16_f32 v64, v64, v65
    v_cvt_pk_bf16_f32 v65, v66, v67
    v_cvt_pk_bf16_f32 v66, v68, v69
    v_cvt_pk_bf16_f32 v67, v70, v71
    v_exp_f32 v73, v73
    v_exp_f32 v74, v74
    v_exp_f32 v75, v75
    s_waitcnt vmcnt(18)
    v_mfma_f32_32x32x16_bf16 v[112:127], a[128:131], v[64:67], v[112:127]
    v_exp_f32 v76, v76
    s_waitcnt vmcnt(8)
    v_cmp_ne_u64 vcc, v[26:27], v[28:29]
    s_cbranch_vccz pok_23
    s_movk_i32 s101, 30000
    s_mov_b32 s83, 0x1820000
plp_24:
    s_mov_b64 exec, vcc
    buffer_load_dwordx2 v[26:27], v4, s[52:55], s83 offen sc1
    s_mov_b64 exec, -1
    s_waitcnt vmcnt(0)
    v_cmp_ne_u64 vcc, v[26:27], v[28:29]
    s_cbranch_vccz pok_23
    s_sub_u32 s101, s101, 1
    s_cbranch_scc0 plp_24
pok_23:
    v_exp_f32 v77, v77
    s_xor_b32 s76, s17, 0x10000
    buffer_load_dwordx4 a[0:3], v30, s[52:55], s76 offen offset:0
    buffer_load_dwordx4 a[4:7], v30, s[52:55], s76 offen offset:1024
    v_exp_f32 v78, v78
    buffer_load_dwordx4 a[8:11], v30, s[52:55], s76 offen offset:2048
    buffer_load_dwordx4 a[12:15], v30, s[52:55], s76 offen offset:3072
    v_exp_f32 v79, v79
    v_cvt_pk_bf16_f32 v68, v72, v73
    v_cvt_pk_bf16_f32 v69, v74, v75
    v_cvt_pk_bf16_f32 v70, v76, v77
    v_cvt_pk_bf16_f32 v71, v78, v79
    v_exp_f32 v32, v32
    v_exp_f32 v33, v33
    v_exp_f32 v34, v34
    v_exp_f32 v35, v35
    v_mfma_f32_32x32x16_bf16 v[112:127], a[132:135], v[68:71], v[112:127]
    v_exp_f32 v36, v36
    v_exp_f32 v37, v37
    v_exp_f32 v38, v38
    v_exp_f32 v39, v39
    v_mfma_f32_32x32x16_bf16 v[64:79], a[136:139], a[188:191], v[96:111]
    v_exp_f32 v40, v40
    v_cvt_pk_bf16_f32 v32, v32, v33
    v_cvt_pk_bf16_f32 v33, v34, v35
    v_cvt_pk_bf16_f32 v34, v36, v37
    v_cvt_pk_bf16_f32 v35, v38, v39
    v_exp_f32 v41, v41
    v_exp_f32 v42, v42
    v_exp_f32 v43, v43
    v_mfma_f32_32x32x16_bf16 v[128:143], a[128:131], v[32:35], v[128:143]
    v_exp_f32 v44, v44
    s_xor_b32 s76, s17, 0x11000
    buffer_load_dwordx4 a[16:19], v30, s[52:55], s76 offen offset:0
    buffer_load_dwordx4 a[20:23], v30, s[52:55], s76 offen offset:1024
    v_exp_f32 v45, v45
    buffer_load_dwordx4 a[24:27], v30, s[52:55], s76 offen offset:2048
    buffer_load_dwordx4 a[28:31], v30, s[52:55], s76 offen offset:3072
    v_exp_f32 v46, v46
    s_xor_b32 s76, s18, 0x18000
    buffer_load_dwordx4 a[32:35], v30, s[52:55], s76 offen offset:0
    buffer_load_dwordx4 a[36:39], v30, s[52:55], s76 offen offset:1024
    v_exp_f32 v47, v47
    v_cvt_pk_bf16_f32 v36, v40, v41
    v_cvt_pk_bf16_f32 v37, v42, v43
    v_cvt_pk_bf16_f32 v38, v44, v45
    v_cvt_pk_bf16_f32 v39, v46, v47
    v_exp_f32 v48, v48
    v_exp_f32 v49, v49
    v_exp_f32 v50, v50
    v_exp_f32 v51, v51
    v_mfma_f32_32x32x16_bf16 v[128:143], a[132:135], v[36:39], v[128:143]
    v_exp_f32 v52, v52
    v_exp_f32 v53, v53
    v_exp_f32 v54, v54
    v_exp_f32 v55, v55
    v_mfma_f32_32x32x16_bf16 v[32:47], a[148:151], a[184:187], v[80:95]
    v_exp_f32 v56, v56
    v_cvt_pk_bf16_f32 v48, v48, v49
    v_cvt_pk_bf16_f32 v49, v50, v51
    v_cvt_pk_bf16_f32 v50, v52, v53
    v_cvt_pk_bf16_f32 v51, v54, v55
    v_exp_f32 v57, v57
    v_exp_f32 v58, v58
    v_exp_f32 v59, v59
    v_mfma_f32_32x32x16_bf16 v[112:127], a[140:143], v[48:51], v[112:127]
    v_exp_f32 v60, v60
    buffer_load_dwordx4 a[40:43], v30, s[52:55], s76 offen offset:2048
    buffer_load_dwordx4 a[44:47], v30, s[52:55], s76 offen offset:3072
    v_exp_f32 v61, v61
    s_add_u32 m0, s73, 8192
    s_xor_b32 s77, s19, 0x10080
    buffer_load_dwordx4 v24, s[4:7], s77 offen lds
    buffer_load_dwordx4 v25, s[4:7], s77 offen offset:1024 lds
    v_exp_f32 v62, v62
    s_mov_b32 s83, 0x1840000
    buffer_load_dwordx2 v[26:27], v4, s[52:55], s83 offen
    v_exp_f32 v63, v63
    v_cvt_pk_bf16_f32 v52, v56, v57
    v_cvt_pk_bf16_f32 v53, v58, v59
    v_cvt_pk_bf16_f32 v54, v60, v61
    v_cvt_pk_bf16_f32 v55, v62, v63
    v_exp_f32 v64, v64
    v_exp_f32 v65, v65
    v_exp_f32 v66, v66
    v_exp_f32 v67, v67
    v_mfma_f32_32x32x16_bf16 v[112:127], a[144:147], v[52:55], v[112:127]
    v_exp_f32 v68, v68
    v_exp_f32 v69, v69
    v_exp_f32 v70, v70
    v_exp_f32 v71, v71
    v_mfma_f32_32x32x16_bf16 v[48:63], a[148:151], a[188:191], v[96:111]
    v_exp_f32 v72, v72
    v_cvt_pk_bf16_f32 v64, v64, v65
    v_cvt_pk_bf16_f32 v65, v66, v67
    v_cvt_pk_bf16_f32 v66, v68, v69
    v_cvt_pk_bf16_f32 v67, v70, v71
    v_exp_f32 v73, v73
    v_exp_f32 v74, v74
    v_exp_f32 v75, v75
    v_mfma_f32_32x32x16_bf16 v[128:143], a[140:143], v[64:67], v[128:143]
    v_exp_f32 v76, v76
    s_add_u32 m0, s73, 10240
    s_xor_b32 s77, s19, 0x80080
    buffer_load_dwordx4 v24, s[4:7], s77 offen lds
    buffer_load_dwordx4 v25, s[4:7], s77 offen offset:1024 lds
    v_exp_f32 v77, v77
    s_add_u32 m0, s73, 12288
    s_xor_b32 s77, s19, 0x90080
    buffer_load_dwordx4 v24, s[4:7], s77 offen lds
    buffer_load_dwordx4 v25, s[4:7], s77 offen offset:1024 lds
    v_exp_f32 v78, v78
    s_add_u32 m0, s73, 14336
    s_xor_b32 s77, s48, 0x80
    buffer_load_dwordx4 v24, s[12:15], s77 offen lds
    buffer_load_dwordx4 v25, s[12:15], s77 offen offset:1024 lds
    v_exp_f32 v79, v79
    v_cvt_pk_bf16_f32 v68, v72, v73
    v_cvt_pk_bf16_f32 v69, v74, v75
    v_cvt_pk_bf16_f32 v70, v76, v77
    v_cvt_pk_bf16_f32 v71, v78, v79
    v_exp_f32 v32, v32
    v_exp_f32 v33, v33
    v_exp_f32 v34, v34
    v_exp_f32 v35, v35
    v_mfma_f32_32x32x16_bf16 v[128:143], a[144:147], v[68:71], v[128:143]
    v_exp_f32 v36, v36
    v_exp_f32 v37, v37
    v_exp_f32 v38, v38
    v_exp_f32 v39, v39
    v_mfma_f32_32x32x16_bf16 v[64:79], v[144:147], v[148:151], v[192:207]
    v_mfma_f32_32x32x16_bf16 v[64:79], a[160:163], a[184:187], v[64:79]
    v_exp_f32 v40, v40
    v_cvt_pk_bf16_f32 v32, v32, v33
    v_cvt_pk_bf16_f32 v33, v34, v35
    v_cvt_pk_bf16_f32 v34, v36, v37
    v_cvt_pk_bf16_f32 v35, v38, v39
    v_exp_f32 v41, v41
    v_exp_f32 v42, v42
    v_exp_f32 v43, v43
    v_mfma_f32_32x32x16_bf16 v[112:127], a[152:155], v[32:35], v[112:127]
    v_exp_f32 v44, v44
    s_add_u32 m0, s73, 16384
    s_xor_b32 s77, s48, 0x10080
    buffer_load_dwordx4 v24, s[12:15], s77 offen lds
    buffer_load_dwordx4 v25, s[12:15], s77 offen offset:1024 lds
    v_exp_f32 v45, v45
    s_waitcnt vmcnt(8)
    v_cmp_ne_u64 vcc, v[26:27], v[28:29]
    s_cbranch_vccz pok_25
    s_movk_i32 s101, 30000
    s_mov_b32 s83, 0x1840000
plp_26:
    s_mov_b64 exec, vcc
    buffer_load_dwordx2 v[26:27], v4, s[52:55], s83 offen sc1
    s_mov_b64 exec, -1
    s_waitcnt vmcnt(0)
    v_cmp_ne_u64 vcc, v[26:27], v[28:29]
    s_cbranch_vccz pok_25
    s_sub_u32 s101, s101, 1
    s_cbranch_scc0 plp_26
pok_25:
    v_exp_f32 v46, v46
    s_xor_b32 s76, s16, 0x1000
    buffer_load_dwordx4 a[48:51], v30, s[52:55], s76 offen offset:0
    buffer_load_dwordx4 a[52:55], v30, s[52:55], s76 offen offset:1024
    v_exp_f32 v47, v47
    v_cvt_pk_bf16_f32 v36, v40, v41
    v_cvt_pk_bf16_f32 v37, v42, v43
    v_cvt_pk_bf16_f32 v38, v44, v45
    v_cvt_pk_bf16_f32 v39, v46, v47
    v_exp_f32 v48, v48
    v_exp_f32 v49, v49
    v_exp_f32 v50, v50
    v_exp_f32 v51, v51
    v_mfma_f32_32x32x16_bf16 v[112:127], a[156:159], v[36:39], v[112:127]
    v_exp_f32 v52, v52
    v_exp_f32 v53, v53
    v_exp_f32 v54, v54
    v_exp_f32 v55, v55
    v_mfma_f32_32x32x16_bf16 v[32:47], a[160:163], a[188:191], v[96:111]
    v_exp_f32 v56, v56
    v_cvt_pk_bf16_f32 v48, v48, v49
    v_cvt_pk_bf16_f32 v49, v50, v51
    v_cvt_pk_bf16_f32 v50, v52, v53
    v_cvt_pk_bf16_f32 v51, v54, v55
    v_exp_f32 v57, v57
    v_exp_f32 v58, v58
    v_exp_f32 v59, v59
    v_mfma_f32_32x32x16_bf16 v[128:143], a[152:155], v[48:51], v[128:143]
    v_exp_f32 v60, v60
    buffer_load_dwordx4 a[56:59], v30, s[52:55], s76 offen offset:2048
    buffer_load_dwordx4 a[60:63], v30, s[52:55], s76 offen offset:3072
    v_exp_f32 v61, v61
    s_xor_b32 s76, s16, 0x8000
    buffer_load_dwordx4 a[192:195], v30, s[52:55], s76 offen offset:0
    buffer_load_dwordx4 a[196:199], v30, s[52:55], s76 offen offset:1024
    v_exp_f32 v62, v62
    buffer_load_dwordx4 a[200:203], v30, s[52:55], s76 offen offset:2048
    buffer_load_dwordx4 a[204:207], v30, s[52:55], s76 offen offset:3072
    v_exp_f32 v63, v63
    v_cvt_pk_bf16_f32 v52, v56, v57
    v_cvt_pk_bf16_f32 v53, v58, v59
    v_cvt_pk_bf16_f32 v54, v60, v61
    v_cvt_pk_bf16_f32 v55, v62, v63
    v_exp_f32 v64, v64
    v_exp_f32 v65, v65
    v_exp_f32 v66, v66
    v_exp_f32 v67, v67
    v_mfma_f32_32x32x16_bf16 v[128:143], a[156:159], v[52:55], v[128:143]
    v_exp_f32 v68, v68
    v_exp_f32 v69, v69
    v_exp_f32 v70, v70
    v_exp_f32 v71, v71
    v_mfma_f32_32x32x16_bf16 v[48:63], v[144:147], v[152:155], v[192:207]
    v_mfma_f32_32x32x16_bf16 v[48:63], a[172:175], a[188:191], v[48:63]
    v_exp_f32 v72, v72
    v_cvt_pk_bf16_f32 v64, v64, v65
    v_cvt_pk_bf16_f32 v65, v66, v67
    v_cvt_pk_bf16_f32 v66, v68, v69
    v_cvt_pk_bf16_f32 v67, v70, v71
    v_exp_f32 v73, v73
    v_exp_f32 v74, v74
    v_exp_f32 v75, v75
    v_mfma_f32_32x32x16_bf16 v[112:127], a[164:167], v[64:67], v[112:127]
    v_exp_f32 v76, v76
    s_xor_b32 s76, s16, 0x9000
    buffer_load_dwordx4 a[208:211], v30, s[52:55], s76 offen offset:0
    buffer_load_dwordx4 a[212:215], v30, s[52:55], s76 offen offset:1024
    v_exp_f32 v77, v77
    buffer_load_dwordx4 a[216:219], v30, s[52:55], s76 offen offset:2048
    buffer_load_dwordx4 a[220:223], v30, s[52:55], s76 offen offset:3072
    v_exp_f32 v78, v78
    v_exp_f32 v79, v79
    v_cvt_pk_bf16_f32 v68, v72, v73
    v_cvt_pk_bf16_f32 v69, v74, v75
    v_cvt_pk_bf16_f32 v70, v76, v77
    v_cvt_pk_bf16_f32 v71, v78, v79
    v_exp_f32 v32, v32
    v_exp_f32 v33, v33
    v_exp_f32 v34, v34
    v_exp_f32 v35, v35
    v_mfma_f32_32x32x16_bf16 v[112:127], a[168:171], v[68:71], v[112:127]
    v_exp_f32 v36, v36
    v_exp_f32 v37, v37
    v_exp_f32 v38, v38
    v_exp_f32 v39, v39
    v_exp_f32 v40, v40
    v_cvt_pk_bf16_f32 v32, v32, v33
    v_cvt_pk_bf16_f32 v33, v34, v35
    v_cvt_pk_bf16_f32 v34, v36, v37
    v_cvt_pk_bf16_f32 v35, v38, v39
    v_exp_f32 v41, v41
    v_exp_f32 v42, v42
    v_exp_f32 v43, v43
    v_mfma_f32_32x32x16_bf16 v[128:143], a[164:167], v[32:35], v[128:143]
    v_exp_f32 v44, v44
    v_exp_f32 v45, v45
    v_exp_f32 v46, v46
    v_exp_f32 v47, v47
    v_cvt_pk_bf16_f32 v36, v40, v41
    v_cvt_pk_bf16_f32 v37, v42, v43
    v_cvt_pk_bf16_f32 v38, v44, v45
    v_cvt_pk_bf16_f32 v39, v46, v47
    v_exp_f32 v48, v48
    v_exp_f32 v49, v49
    v_exp_f32 v50, v50
    v_exp_f32 v51, v51
    v_mfma_f32_32x32x16_bf16 v[128:143], a[168:171], v[36:39], v[128:143]
    v_exp_f32 v52, v52
    v_exp_f32 v53, v53
    v_exp_f32 v54, v54
    v_exp_f32 v55, v55
    v_exp_f32 v56, v56
    v_cvt_pk_bf16_f32 v48, v48, v49
    v_cvt_pk_bf16_f32 v49, v50, v51
    v_cvt_pk_bf16_f32 v50, v52, v53
    v_cvt_pk_bf16_f32 v51, v54, v55
    v_exp_f32 v57, v57
    v_exp_f32 v58, v58
    v_exp_f32 v59, v59
    v_mfma_f32_32x32x16_bf16 v[128:143], a[176:179], v[48:51], v[128:143]
    v_exp_f32 v60, v60
    v_exp_f32 v61, v61
    v_exp_f32 v62, v62
    v_exp_f32 v63, v63
    v_cvt_pk_bf16_f32 v52, v56, v57
    v_cvt_pk_bf16_f32 v53, v58, v59
    v_cvt_pk_bf16_f32 v54, v60, v61
    v_cvt_pk_bf16_f32 v55, v62, v63
    s_nop 1
    v_mfma_f32_32x32x16_bf16 v[128:143], a[180:183], v[52:55], v[128:143]
    v_rcp_f32 v120, v120
    s_nop 0
    v_mul_f32 v112, v112, v120
    v_mul_f32 v113, v113, v120
    v_mul_f32 v114, v114, v120
    v_mul_f32 v115, v115, v120
    v_mul_f32 v116, v116, v120
    v_mul_f32 v117, v117, v120
    v_mul_f32 v118, v118, v120
    v_mul_f32 v119, v119, v120
    v_cvt_pk_bf16_f32 v112, v112, v113
    v_cvt_pk_bf16_f32 v113, v114, v115
    v_cvt_pk_bf16_f32 v114, v116, v117
    v_cvt_pk_bf16_f32 v115, v118, v119
    buffer_store_dwordx4 v[112:115], v1, s[52:55], s38 offen sc1
    v_rcp_f32 v136, v136
    s_nop 0
    v_mul_f32 v128, v128, v136
    v_mul_f32 v129, v129, v136
    v_mul_f32 v130, v130, v136
    v_mul_f32 v131, v131, v136
    v_mul_f32 v132, v132, v136
    v_mul_f32 v133, v133, v136
    v_mul_f32 v134, v134, v136
    v_mul_f32 v135, v135, v136
    v_cvt_pk_bf16_f32 v128, v128, v129
    v_cvt_pk_bf16_f32 v129, v130, v131
    v_cvt_pk_bf16_f32 v130, v132, v133
    v_cvt_pk_bf16_f32 v131, v134, v135
    buffer_store_dwordx4 v[128:131], v1, s[52:55], s39 offen sc1
    s_branch k_g2
k_r3:
    v_cmp_gt_u32 vcc, 32, v0
    v_mov_b32 v16, 0x3f80
    v_mov_b32 v145, 0
    v_mov_b32 v146, 0
    v_mov_b32 v147, 0
    v_cndmask_b32 v144, 0, v16, vcc
    v_mov_b32 v149, 0
    v_mov_b32 v150, 0
    v_mov_b32 v151, 0
    v_mov_b32 v153, 0
    v_mov_b32 v154, 0
    v_mov_b32 v155, 0
    v_mov_b32 v156, 0xf149f2ca
    v_mov_b32 v157, 0xf149f2ca
    v_mov_b32 v158, 0xf149f2ca
    v_mov_b32 v159, 0xf149f2ca
    s_waitcnt vmcnt(15)
    v_mfma_f32_32x32x16_bf16 v[32:47], a[88:91], a[184:187], 0
    v_mfma_f32_32x32x16_bf16 v[48:63], a[88:91], a[188:191], 0
    s_waitcnt vmcnt(14)
    v_mfma_f32_32x32x16_bf16 v[64:79], a[100:103], a[184:187], 0
    s_nop 8
    v_max3_f32 v156, v32, v33, v156
    v_max3_f32 v157, v34, v35, v157
    v_max3_f32 v156, v36, v37, v156
    v_max3_f32 v157, v38, v39, v157
    s_mov_b64 exec, s[78:79]
    buffer_load_dwordx4 a[92:95], v23, s[52:55], s30 offen offset:0
    buffer_load_dwordx4 a[96:99], v23, s[52:55], s30 offen offset:512
    s_mov_b64 exec, -1
    v_max3_f32 v156, v40, v41, v156
    v_max3_f32 v157, v42, v43, v157
    v_max3_f32 v156, v44, v45, v156
    v_max3_f32 v157, v46, v47, v157
    v_mfma_f32_32x32x16_bf16 v[80:95], a[100:103], a[188:191], 0
    v_max3_f32 v158, v48, v49, v158
    v_max3_f32 v159, v50, v51, v159
    v_max3_f32 v158, v52, v53, v158
    v_max3_f32 v159, v54, v55, v159
    v_max3_f32 v158, v56, v57, v158
    v_max3_f32 v159, v58, v59, v159
    v_max3_f32 v158, v60, v61, v158
    v_max3_f32 v159, v62, v63, v159
    s_waitcnt vmcnt(15)
    v_mfma_f32_32x32x16_bf16 v[96:111], a[112:115], a[184:187], 0
    v_max3_f32 v156, v64, v65, v156
    v_max3_f32 v157, v66, v67, v157
    v_max3_f32 v156, v68, v69, v156
    v_max3_f32 v157, v70, v71, v157
    s_mov_b64 exec, s[78:79]
    buffer_load_dwordx4 a[104:107], v23, s[52:55], s31 offen offset:0
    buffer_load_dwordx4 a[108:111], v23, s[52:55], s31 offen offset:512
    s_mov_b64 exec, -1
    v_max3_f32 v156, v72, v73, v156
    v_max3_f32 v157, v74, v75, v157
    v_max3_f32 v156, v76, v77, v156
    v_max3_f32 v157, v78, v79, v157
    v_mfma_f32_32x32x16_bf16 v[32:47], a[112:115], a[188:191], 0
    v_max3_f32 v158, v80, v81, v158
    v_max3_f32 v159, v82, v83, v159
    v_max3_f32 v158, v84, v85, v158
    v_max3_f32 v159, v86, v87, v159
    v_max3_f32 v158, v88, v89, v158
    v_max3_f32 v159, v90, v91, v159
    v_max3_f32 v158, v92, v93, v158
    v_max3_f32 v159, v94, v95, v159
    s_waitcnt vmcnt(16)
    v_mfma_f32_32x32x16_bf16 v[48:63], a[124:127], a[184:187], 0
    v_max3_f32 v156, v96, v97, v156
    v_max3_f32 v157, v98, v99, v157
    v_max3_f32 v156, v100, v101, v156
    v_max3_f32 v157, v102, v103, v157
    s_mov_b64 exec, s[78:79]
    buffer_load_dwordx4 a[116:119], v23, s[52:55], s32 offen offset:0
    buffer_load_dwordx4 a[120:123], v23, s[52:55], s32 offen offset:512
    s_mov_b64 exec, -1
    v_max3_f32 v156, v104, v105, v156
    v_max3_f32 v157, v106, v107, v157
    v_max3_f32 v156, v108, v109, v156
    v_max3_f32 v157, v110, v111, v157
    v_mfma_f32_32x32x16_bf16 v[64:79], a[124:127], a[188:191], 0
    v_max3_f32 v158, v32, v33, v158
    v_max3_f32 v159, v34, v35, v159
    v_max3_f32 v158, v36, v37, v158
    v_max3_f32 v159, v38, v39, v159
    v_max3_f32 v158, v40, v41, v158
    v_max3_f32 v159, v42, v43, v159
    v_max3_f32 v158, v44, v45, v158
    v_max3_f32 v159, v46, v47, v159
    s_waitcnt vmcnt(17)
    v_mfma_f32_32x32x16_bf16 v[80:95], a[136:139], a[184:187], 0
    v_max3_f32 v156, v48, v49, v156
    v_max3_f32 v157, v50, v51, v157
    v_max3_f32 v156, v52, v53, v156
    v_max3_f32 v157, v54, v55, v157
    s_mov_b64 exec, s[78:79]
    buffer_load_dwordx4 a[128:131], v23, s[52:55], s33 offen offset:0
    buffer_load_dwordx4 a[132:135], v23, s[52:55], s33 offen offset:512
    s_mov_b64 exec, -1
    v_max3_f32 v156, v56, v57, v156
    v_max3_f32 v157, v58, v59, v157
    v_max3_f32 v156, v60, v61, v156
    v_max3_f32 v157, v62, v63, v157
    v_mfma_f32_32x32x16_bf16 v[96:111], a[136:139], a[188:191], 0
    v_max3_f32 v158, v64, v65, v158
    v_max3_f32 v159, v66, v67, v159
    v_max3_f32 v158, v68, v69, v158
    v_max3_f32 v159, v70, v71, v159
    v_max3_f32 v158, v72, v73, v158
    v_max3_f32 v159, v74, v75, v159
    v_max3_f32 v158, v76, v77, v158
    v_max3_f32 v159, v78, v79, v159
    s_waitcnt vmcnt(18)
    v_mfma_f32_32x32x16_bf16 v[32:47], a[148:151], a[184:187], 0
    v_max3_f32 v156, v80, v81, v156
    v_max3_f32 v157, v82, v83, v157
    v_max3_f32 v156, v84, v85, v156
    v_max3_f32 v157, v86, v87, v157
    s_mov_b64 exec, s[78:79]
    buffer_load_dwordx4 a[140:143], v23, s[52:55], s34 offen offset:0
    buffer_load_dwordx4 a[144:147], v23, s[52:55], s34 offen offset:512
    s_mov_b64 exec, -1
    v_max3_f32 v156, v88, v89, v156
    v_max3_f32 v157, v90, v91, v157
    v_max3_f32 v156, v92, v93, v156
    v_max3_f32 v157, v94, v95, v157
    v_mfma_f32_32x32x16_bf16 v[48:63], a[148:151], a[188:191], 0
    v_max3_f32 v158, v96, v97, v158
    v_max3_f32 v159, v98, v99, v159
    v_max3_f32 v158, v100, v101, v158
    v_max3_f32 v159, v102, v103, v159
    v_max3_f32 v158, v104, v105, v158
    v_max3_f32 v159, v106, v107, v159
    v_max3_f32 v158, v108, v109, v158
    v_max3_f32 v159, v110, v111, v159
    s_waitcnt vmcnt(19)
    v_mfma_f32_32x32x16_bf16 v[64:79], a[160:163], a[184:187], v[192:207]
    v_max3_f32 v156, v32, v33, v156
    v_max3_f32 v157, v34, v35, v157
    v_max3_f32 v156, v36, v37, v156
    v_max3_f32 v157, v38, v39, v157
    s_mov_b64 exec, s[78:79]
    buffer_load_dwordx4 a[152:155], v23, s[52:55], s35 offen offset:0
    buffer_load_dwordx4 a[156:159], v23, s[52:55], s35 offen offset:512
    s_mov_b64 exec, -1
    v_max3_f32 v156, v40, v41, v156
    v_max3_f32 v157, v42, v43, v157
    v_max3_f32 v156, v44, v45, v156
    v_max3_f32 v157, v46, v47, v157
    v_mfma_f32_32x32x16_bf16 v[80:95], a[160:163], a[188:191], 0
    v_max3_f32 v158, v48, v49, v158
    v_max3_f32 v159, v50, v51, v159
    v_max3_f32 v158, v52, v53, v158
    v_max3_f32 v159, v54, v55, v159
    v_max3_f32 v158, v56, v57, v158
    v_max3_f32 v159, v58, v59, v159
    v_max3_f32 v158, v60, v61, v158
    v_max3_f32 v159, v62, v63, v159
    s_waitcnt vmcnt(20)
    v_mfma_f32_32x32x16_bf16 v[96:111], a[172:175], a[188:191], v[192:207]
    v_max3_f32 v156, v64, v65, v156
    v_max3_f32 v157, v66, v67, v157
    v_max3_f32 v156, v68, v69, v156
    v_max3_f32 v157, v70, v71, v157
    s_mov_b64 exec, s[78:79]
    buffer_load_dwordx4 a[164:167], v23, s[52:55], s36 offen offset:0
    buffer_load_dwordx4 a[168:171], v23, s[52:55], s36 offen offset:512
    s_mov_b64 exec, -1
    v_max3_f32 v156, v72, v73, v156
    v_max3_f32 v157, v74, v75, v157
    v_max3_f32 v156, v76, v77, v156
    v_max3_f32 v157, v78, v79, v157
    v_max3_f32 v158, v80, v81, v158
    v_max3_f32 v159, v82, v83, v159
    v_max3_f32 v158, v84, v85, v158
    v_max3_f32 v159, v86, v87, v159
    v_max3_f32 v158, v88, v89, v158
    v_max3_f32 v159, v90, v91, v159
    v_max3_f32 v158, v92, v93, v158
    v_max3_f32 v159, v94, v95, v159
    v_max3_f32 v158, v96, v97, v158
    v_max3_f32 v159, v98, v99, v159
    v_max3_f32 v158, v100, v101, v158
    v_max3_f32 v159, v102, v103, v159
    s_mov_b64 exec, s[78:79]
    buffer_load_dwordx4 a[176:179], v23, s[52:55], s37 offen offset:0
    buffer_load_dwordx4 a[180:183], v23, s[52:55], s37 offen offset:512
    s_mov_b64 exec, -1
    v_max3_f32 v158, v104, v105, v158
    v_max3_f32 v159, v106, v107, v159
    v_max3_f32 v158, v108, v109, v158
    v_max3_f32 v159, v110, v111, v159
    v_max_f32 v156, v156, v157
    v_max_f32 v158, v158, v159
    v_mov_b32 v157, v156
    v_mov_b32 v159, v158
    s_nop 0
    v_permlane32_swap_b32 v156, v157
    v_permlane32_swap_b32 v158, v159
    v_max_f32 v156, v156, v157
    v_max_f32 v158, v158, v159
    v_cvt_pk_bf16_f32 v148, -v156, 0
    v_cvt_pk_bf16_f32 v152, -v158, 0
    s_nop 0
    v_mfma_f32_32x32x16_bf16 v[80:95], v[144:147], v[148:151], 0
    v_mfma_f32_32x32x16_bf16 v[32:47], a[88:91], a[184:187], v[80:95]
    v_mfma_f32_32x32x16_bf16 v[96:111], v[144:147], v[152:155], 0
    v_mfma_f32_32x32x16_bf16 v[48:63], a[88:91], a[188:191], v[96:111]
    s_nop 9
    v_exp_f32 v32, v32
    v_exp_f32 v33, v33
    v_exp_f32 v34, v34
    v_exp_f32 v35, v35
    v_exp_f32 v36, v36
    v_exp_f32 v37, v37
    v_exp_f32 v38, v38
    v_exp_f32 v39, v39
    v_mfma_f32_32x32x16_bf16 v[64:79], a[100:103], a[184:187], v[80:95]
    v_exp_f32 v40, v40
    v_cvt_pk_bf16_f32 v32, v32, v33
    v_cvt_pk_bf16_f32 v33, v34, v35
    v_cvt_pk_bf16_f32 v34, v36, v37
    v_cvt_pk_bf16_f32 v35, v38, v39
    v_exp_f32 v41, v41
    v_exp_f32 v42, v42
    v_exp_f32 v43, v43
    s_waitcnt vmcnt(14)
    v_mfma_f32_32x32x16_bf16 v[112:127], a[92:95], v[32:35], 0
    v_exp_f32 v44, v44
    s_add_u32 s83, s0, 0x1840000
    s_mov_b64 exec, 1
    buffer_store_dwordx2 v[28:29], off, s[52:55], s83 sc1
    s_mov_b64 exec, -1
    v_exp_f32 v45, v45
    s_mov_b32 s83, 0x1820000
    buffer_load_dwordx2 v[26:27], v4, s[52:55], s83 offen
    v_exp_f32 v46, v46
    s_add_u32 m0, s73, 0
    s_xor_b32 s77, s48, 0x100080
    buffer_load_dwordx4 v24, s[4:7], s77 offen lds
    buffer_load_dwordx4 v25, s[4:7], s77 offen offset:1024 lds
    v_exp_f32 v47, v47
    v_cvt_pk_bf16_f32 v36, v40, v41
    v_cvt_pk_bf16_f32 v37, v42, v43
    v_cvt_pk_bf16_f32 v38, v44, v45
    v_cvt_pk_bf16_f32 v39, v46, v47
    v_exp_f32 v48, v48
    v_exp_f32 v49, v49
    v_exp_f32 v50, v50
    v_exp_f32 v51, v51
    v_mfma_f32_32x32x16_bf16 v[112:127], a[96:99], v[36:39], v[112:127]
    v_exp_f32 v52, v52
    v_exp_f32 v53, v53
    v_exp_f32 v54, v54
    v_exp_f32 v55, v55
    v_mfma_f32_32x32x16_bf16 v[32:47], a[100:103], a[188:191], v[96:111]
    v_exp_f32 v56, v56
    v_cvt_pk_bf16_f32 v48, v48, v49
    v_cvt_pk_bf16_f32 v49, v50, v51
    v_cvt_pk_bf16_f32 v50, v52, v53
    v_cvt_pk_bf16_f32 v51, v54, v55
    v_exp_f32 v57, v57
    v_exp_f32 v58, v58
    v_exp_f32 v59, v59
    v_mfma_f32_32x32x16_bf16 v[128:143], a[92:95], v[48:51], 0
    v_exp_f32 v60, v60
    s_add_u32 m0, s73, 2048
    s_xor_b32 s77, s48, 0x110080
    buffer_load_dwordx4 v24, s[4:7], s77 offen lds
    buffer_load_dwordx4 v25, s[4:7], s77 offen offset:1024 lds
    v_exp_f32 v61, v61
    s_add_u32 m0, s73, 4096
    s_xor_b32 s77, s49, 0x180080
    buffer_load_dwordx4 v24, s[4:7], s77 offen lds
    buffer_load_dwordx4 v25, s[4:7], s77 offen offset:1024 lds
    v_exp_f32 v62, v62
    s_add_u32 m0, s73, 6144
    s_xor_b32 s77, s19, 0x80
    buffer_load_dwordx4 v24, s[4:7], s77 offen lds
    buffer_load_dwordx4 v25, s[4:7], s77 offen offset:1024 lds
    v_exp_f32 v63, v63
    v_cvt_pk_bf16_f32 v52, v56, v57
    v_cvt_pk_bf16_f32 v53, v58, v59
    v_cvt_pk_bf16_f32 v54, v60, v61
    v_cvt_pk_bf16_f32 v55, v62, v63
    v_exp_f32 v64, v64
    v_exp_f32 v65, v65
    v_exp_f32 v66, v66
    v_exp_f32 v67, v67
    v_mfma_f32_32x32x16_bf16 v[128:143], a[96:99], v[52:55], v[128:143]
    v_exp_f32 v68, v68
    v_exp_f32 v69, v69
    v_exp_f32 v70, v70
    v_exp_f32 v71, v71
    v_mfma_f32_32x32x16_bf16 v[48:63], a[112:115], a[184:187], v[80:95]
    v_exp_f32 v72, v72
    v_cvt_pk_bf16_f32 v64, v64, v65
    v_cvt_pk_bf16_f32 v65, v66, v67
    v_cvt_pk_bf16_f32 v66, v68, v69
    v_cvt_pk_bf16_f32 v67, v70, v71
    v_exp_f32 v73, v73
    v_exp_f32 v74, v74
    v_exp_f32 v75, v75
    s_waitcnt vmcnt(22)
    v_mfma_f32_32x32x16_bf16 v[112:127], a[104:107], v[64:67], v[112:127]
    v_exp_f32 v76, v76
    s_waitcnt vmcnt(8)
    v_cmp_ne_u64 vcc, v[26:27], v[28:29]
    s_cbranch_vccz pok_27
    s_movk_i32 s101, 30000
    s_mov_b32 s83, 0x1820000
plp_28:
    s_mov_b64 exec, vcc
    buffer_load_dwordx2 v[26:27], v4, s[52:55], s83 offen sc1
    s_mov_b64 exec, -1
    s_waitcnt vmcnt(0)
    v_cmp_ne_u64 vcc, v[26:27], v[28:29]
    s_cbranch_vccz pok_27
    s_sub_u32 s101, s101, 1
    s_cbranch_scc0 plp_28
pok_27:
    v_exp_f32 v77, v77
    s_xor_b32 s76, s17, 0x10000
    buffer_load_dwordx4 a[0:3], v30, s[52:55], s76 offen offset:0
    buffer_load_dwordx4 a[4:7], v30, s[52:55], s76 offen offset:1024
    v_exp_f32 v78, v78
    buffer_load_dwordx4 a[8:11], v30, s[52:55], s76 offen offset:2048
    buffer_load_dwordx4 a[12:15], v30, s[52:55], s76 offen offset:3072
    v_exp_f32 v79, v79
    v_cvt_pk_bf16_f32 v68, v72, v73
    v_cvt_pk_bf16_f32 v69, v74, v75
    v_cvt_pk_bf16_f32 v70, v76, v77
    v_cvt_pk_bf16_f32 v71, v78, v79
    v_exp_f32 v32, v32
    v_exp_f32 v33, v33
    v_exp_f32 v34, v34
    v_exp_f32 v35, v35
    v_mfma_f32_32x32x16_bf16 v[112:127], a[108:111], v[68:71], v[112:127]
    v_exp_f32 v36, v36
    v_exp_f32 v37, v37
    v_exp_f32 v38, v38
    v_exp_f32 v39, v39
    v_mfma_f32_32x32x16_bf16 v[64:79], a[112:115], a[188:191], v[96:111]
    v_exp_f32 v40, v40
    v_cvt_pk_bf16_f32 v32, v32, v33
    v_cvt_pk_bf16_f32 v33, v34, v35
    v_cvt_pk_bf16_f32 v34, v36, v37
    v_cvt_pk_bf16_f32 v35, v38, v39
    v_exp_f32 v41, v41
    v_exp_f32 v42, v42
    v_exp_f32 v43, v43
    v_mfma_f32_32x32x16_bf16 v[128:143], a[104:107], v[32:35], v[128:143]
    v_exp_f32 v44, v44
    s_xor_b32 s76, s17, 0x11000
    buffer_load_dwordx4 a[16:19], v30, s[52:55], s76 offen offset:0
    buffer_load_dwordx4 a[20:23], v30, s[52:55], s76 offen offset:1024
    v_exp_f32 v45, v45
    buffer_load_dwordx4 a[24:27], v30, s[52:55], s76 offen offset:2048
    buffer_load_dwordx4 a[28:31], v30, s[52:55], s76 offen offset:3072
    v_exp_f32 v46, v46
    s_xor_b32 s76, s18, 0x18000
    buffer_load_dwordx4 a[32:35], v30, s[52:55], s76 offen offset:0
    buffer_load_dwordx4 a[36:39], v30, s[52:55], s76 offen offset:1024
    v_exp_f32 v47, v47
    v_cvt_pk_bf16_f32 v36, v40, v41
    v_cvt_pk_bf16_f32 v37, v42, v43
    v_cvt_pk_bf16_f32 v38, v44, v45
    v_cvt_pk_bf16_f32 v39, v46, v47
    v_exp_f32 v48, v48
    v_exp_f32 v49, v49
    v_exp_f32 v50, v50
    v_exp_f32 v51, v51
    v_mfma_f32_32x32x16_bf16 v[128:143], a[108:111], v[36:39], v[128:143]
    v_exp_f32 v52, v52
    v_exp_f32 v53, v53
    v_exp_f32 v54, v54
    v_exp_f32 v55, v55
    v_mfma_f32_32x32x16_bf16 v[32:47], a[124:127], a[184:187], v[80:95]
    v_exp_f32 v56, v56
    v_cvt_pk_bf16_f32 v48, v48, v49
    v_cvt_pk_bf16_f32 v49, v50, v51
    v_cvt_pk_bf16_f32 v50, v52, v53
    v_cvt_pk_bf16_f32 v51, v54, v55
    v_exp_f32 v57, v57
    v_exp_f32 v58, v58
    v_exp_f32 v59, v59
    v_mfma_f32_32x32x16_bf16 v[112:127], a[116:119], v[48:51], v[112:127]
    v_exp_f32 v60, v60
    buffer_load_dwordx4 a[40:43], v30, s[52:55], s76 offen offset:2048
    buffer_load_dwordx4 a[44:47], v30, s[52:55], s76 offen offset:3072
    v_exp_f32 v61, v61
    s_add_u32 m0, s73, 8192
    s_xor_b32 s77, s19, 0x10080
    buffer_load_dwordx4 v24, s[4:7], s77 offen lds
    buffer_load_dwordx4 v25, s[4:7], s77 offen offset:1024 lds
    v_exp_f32 v62, v62
    v_exp_f32 v63, v63
    v_cvt_pk_bf16_f32 v52, v56, v57
    v_cvt_pk_bf16_f32 v53, v58, v59
    v_cvt_pk_bf16_f32 v54, v60, v61
    v_cvt_pk_bf16_f32 v55, v62, v63
    v_exp_f32 v64, v64
    v_exp_f32 v65, v65
    v_exp_f32 v66, v66
    v_exp_f32 v67, v67
    v_mfma_f32_32x32x16_bf16 v[112:127], a[120:123], v[52:55], v[112:127]
    v_exp_f32 v68, v68
    v_exp_f32 v69, v69
    v_exp_f32 v70, v70
    v_exp_f32 v71, v71
    v_mfma_f32_32x32x16_bf16 v[48:63], a[124:127], a[188:191], v[96:111]
    v_exp_f32 v72, v72
    v_cvt_pk_bf16_f32 v64, v64, v65
    v_cvt_pk_bf16_f32 v65, v66, v67
    v_cvt_pk_bf16_f32 v66, v68, v69
    v_cvt_pk_bf16_f32 v67, v70, v71
    v_exp_f32 v73, v73
    v_exp_f32 v74, v74
    v_exp_f32 v75, v75
    v_mfma_f32_32x32x16_bf16 v[128:143], a[116:119], v[64:67], v[128:143]
    v_exp_f32 v76, v76
    s_mov_b32 s83, 0x1840000
    buffer_load_dwordx2 v[26:27], v4, s[52:55], s83 offen
    v_exp_f32 v77, v77
    s_add_u32 m0, s73, 10240
    s_xor_b32 s77, s19, 0x80080
    buffer_load_dwordx4 v24, s[4:7], s77 offen lds
    buffer_load_dwordx4 v25, s[4:7], s77 offen offset:1024 lds
    v_exp_f32 v78, v78
    s_add_u32 m0, s73, 12288
    s_xor_b32 s77, s19, 0x90080
    buffer_load_dwordx4 v24, s[4:7], s77 offen lds
    buffer_load_dwordx4 v25, s[4:7], s77 offen offset:1024 lds
    v_exp_f32 v79, v79
    v_cvt_pk_bf16_f32 v68, v72, v73
    v_cvt_pk_bf16_f32 v69, v74, v75
    v_cvt_pk_bf16_f32 v70, v76, v77
    v_cvt_pk_bf16_f32 v71, v78, v79
    v_exp_f32 v32, v32
    v_exp_f32 v33, v33
    v_exp_f32 v34, v34
    v_exp_f32 v35, v35
    v_mfma_f32_32x32x16_bf16 v[128:143], a[120:123], v[68:71], v[128:143]
    v_exp_f32 v36, v36
    v_exp_f32 v37, v37
    v_exp_f32 v38, v38
    v_exp_f32 v39, v39
    v_mfma_f32_32x32x16_bf16 v[64:79], a[136:139], a[184:187], v[80:95]
    v_exp_f32 v40, v40
    v_cvt_pk_bf16_f32 v32, v32, v33
    v_cvt_pk_bf16_f32 v33, v34, v35
    v_cvt_pk_bf16_f32 v34, v36, v37
    v_cvt_pk_bf16_f32 v35, v38, v39
    v_exp_f32 v41, v41
    v_exp_f32 v42, v42
    v_exp_f32 v43, v43
    v_mfma_f32_32x32x16_bf16 v[112:127], a[128:131], v[32:35], v[112:127]
    v_exp_f32 v44, v44
    s_add_u32 m0, s73, 14336
    s_xor_b32 s77, s48, 0x80
    buffer_load_dwordx4 v24, s[12:15], s77 offen lds
    buffer_load_dwordx4 v25, s[12:15], s77 offen offset:1024 lds
    v_exp_f32 v45, v45
    s_add_u32 m0, s73, 16384
    s_xor_b32 s77, s48, 0x10080
    buffer_load_dwordx4 v24, s[12:15], s77 offen lds
    buffer_load_dwordx4 v25, s[12:15], s77 offen offset:1024 lds
    v_exp_f32 v46, v46
    v_exp_f32 v47, v47
    v_cvt_pk_bf16_f32 v36, v40, v41
    v_cvt_pk_bf16_f32 v37, v42, v43
    v_cvt_pk_bf16_f32 v38, v44, v45
    v_cvt_pk_bf16_f32 v39, v46, v47
    v_exp_f32 v48, v48
    v_exp_f32 v49, v49
    v_exp_f32 v50, v50
    v_exp_f32 v51, v51
    v_mfma_f32_32x32x16_bf16 v[112:127], a[132:135], v[36:39], v[112:127]
    v_exp_f32 v52, v52
    v_exp_f32 v53, v53
    v_exp_f32 v54, v54
    v_exp_f32 v55, v55
    v_mfma_f32_32x32x16_bf16 v[32:47], a[136:139], a[188:191], v[96:111]
    v_exp_f32 v56, v56
    v_cvt_pk_bf16_f32 v48, v48, v49
    v_cvt_pk_bf16_f32 v49, v50, v51
    v_cvt_pk_bf16_f32 v50, v52, v53
    v_cvt_pk_bf16_f32 v51, v54, v55
    v_exp_f32 v57, v57
    v_exp_f32 v58, v58
    v_exp_f32 v59, v59
    v_mfma_f32_32x32x16_bf16 v[128:143], a[128:131], v[48:51], v[128:143]
    v_exp_f32 v60, v60
    v_exp_f32 v61, v61
    v_exp_f32 v62, v62
    v_exp_f32 v63, v63
    v_cvt_pk_bf16_f32 v52, v56, v57
    v_cvt_pk_bf16_f32 v53, v58, v59
    v_cvt_pk_bf16_f32 v54, v60, v61
    v_cvt_pk_bf16_f32 v55, v62, v63
    v_exp_f32 v64, v64
    v_exp_f32 v65, v65
    v_exp_f32 v66, v66
    v_exp_f32 v67, v67
    v_mfma_f32_32x32x16_bf16 v[128:143], a[132:135], v[52:55], v[128:143]
    v_exp_f32 v68, v68
    v_exp_f32 v69, v69
    v_exp_f32 v70, v70
    v_exp_f32 v71, v71
    v_mfma_f32_32x32x16_bf16 v[48:63], a[148:151], a[184:187], v[80:95]
    v_exp_f32 v72, v72
    v_cvt_pk_bf16_f32 v64, v64, v65
    v_cvt_pk_bf16_f32 v65, v66, v67
    v_cvt_pk_bf16_f32 v66, v68, v69
    v_cvt_pk_bf16_f32 v67, v70, v71
    v_exp_f32 v73, v73
    v_exp_f32 v74, v74
    v_exp_f32 v75, v75
    v_mfma_f32_32x32x16_bf16 v[112:127], a[140:143], v[64:67], v[112:127]
    v_exp_f32 v76, v76
    v_exp_f32 v77, v77
    v_exp_f32 v78, v78
    v_exp_f32 v79, v79
    v_cvt_pk_bf16_f32 v68, v72, v73
    v_cvt_pk_bf16_f32 v69, v74, v75
    v_cvt_pk_bf16_f32 v70, v76, v77
    v_cvt_pk_bf16_f32 v71, v78, v79
    v_exp_f32 v32, v32
    v_exp_f32 v33, v33
    v_exp_f32 v34, v34
    v_exp_f32 v35, v35
    v_mfma_f32_32x32x16_bf16 v[112:127], a[144:147], v[68:71], v[112:127]
    v_exp_f32 v36, v36
    v_exp_f32 v37, v37
    v_exp_f32 v38, v38
    v_exp_f32 v39, v39
    v_mfma_f32_32x32x16_bf16 v[64:79], a[148:151], a[188:191], v[96:111]
    v_exp_f32 v40, v40
    v_cvt_pk_bf16_f32 v32, v32, v33
    v_cvt_pk_bf16_f32 v33, v34, v35
    v_cvt_pk_bf16_f32 v34, v36, v37
    v_cvt_pk_bf16_f32 v35, v38, v39
    v_exp_f32 v41, v41
    v_exp_f32 v42, v42
    v_exp_f32 v43, v43
    v_mfma_f32_32x32x16_bf16 v[128:143], a[140:143], v[32:35], v[128:143]
    v_exp_f32 v44, v44
    s_waitcnt vmcnt(8)
    v_cmp_ne_u64 vcc, v[26:27], v[28:29]
    s_cbranch_vccz pok_29
    s_movk_i32 s101, 30000
    s_mov_b32 s83, 0x1840000
plp_30:
    s_mov_b64 exec, vcc
    buffer_load_dwordx2 v[26:27], v4, s[52:55], s83 offen sc1
    s_mov_b64 exec, -1
    s_waitcnt vmcnt(0)
    v_cmp_ne_u64 vcc, v[26:27], v[28:29]
    s_cbranch_vccz pok_29
    s_sub_u32 s101, s101, 1
    s_cbranch_scc0 plp_30
pok_29:
    v_exp_f32 v45, v45
    s_xor_b32 s76, s16, 0x1000
    buffer_load_dwordx4 a[48:51], v30, s[52:55], s76 offen offset:0
    buffer_load_dwordx4 a[52:55], v30, s[52:55], s76 offen offset:1024
    v_exp_f32 v46, v46
    buffer_load_dwordx4 a[56:59], v30, s[52:55], s76 offen offset:2048
    buffer_load_dwordx4 a[60:63], v30, s[52:55], s76 offen offset:3072
    v_exp_f32 v47, v47
    v_cvt_pk_bf16_f32 v36, v40, v41
    v_cvt_pk_bf16_f32 v37, v42, v43
    v_cvt_pk_bf16_f32 v38, v44, v45
    v_cvt_pk_bf16_f32 v39, v46, v47
    v_exp_f32 v48, v48
    v_exp_f32 v49, v49
    v_exp_f32 v50, v50
    v_exp_f32 v51, v51
    v_mfma_f32_32x32x16_bf16 v[128:143], a[144:147], v[36:39], v[128:143]
    v_exp_f32 v52, v52
    v_exp_f32 v53, v53
    v_exp_f32 v54, v54
    v_exp_f32 v55, v55
    v_mfma_f32_32x32x16_bf16 v[32:47], v[144:147], v[148:151], v[192:207]
    v_mfma_f32_32x32x16_bf16 v[32:47], a[160:163], a[184:187], v[32:47]
    v_exp_f32 v56, v56
    v_cvt_pk_bf16_f32 v48, v48, v49
    v_cvt_pk_bf16_f32 v49, v50, v51
    v_cvt_pk_bf16_f32 v50, v52, v53
    v_cvt_pk_bf16_f32 v51, v54, v55
    v_exp_f32 v57, v57
    v_exp_f32 v58, v58
    v_exp_f32 v59, v59
    v_mfma_f32_32x32x16_bf16 v[112:127], a[152:155], v[48:51], v[112:127]
    v_exp_f32 v60, v60
    s_xor_b32 s76, s16, 0x8000
    buffer_load_dwordx4 a[192:195], v30, s[52:55], s76 offen offset:0
    buffer_load_dwordx4 a[196:199], v30, s[52:55], s76 offen offset:1024
    v_exp_f32 v61, v61
    buffer_load_dwordx4 a[200:203], v30, s[52:55], s76 offen offset:2048
    buffer_load_dwordx4 a[204:207], v30, s[52:55], s76 offen offset:3072
    v_exp_f32 v62, v62
    s_xor_b32 s76, s16, 0x9000
    buffer_load_dwordx4 a[208:211], v30, s[52:55], s76 offen offset:0
    buffer_load_dwordx4 a[212:215], v30, s[52:55], s76 offen offset:1024
    v_exp_f32 v63, v63
    v_cvt_pk_bf16_f32 v52, v56, v57
    v_cvt_pk_bf16_f32 v53, v58, v59
    v_cvt_pk_bf16_f32 v54, v60, v61
    v_cvt_pk_bf16_f32 v55, v62, v63
    v_exp_f32 v64, v64
    v_exp_f32 v65, v65
    v_exp_f32 v66, v66
    v_exp_f32 v67, v67
    v_mfma_f32_32x32x16_bf16 v[112:127], a[156:159], v[52:55], v[112:127]
    v_exp_f32 v68, v68
    v_exp_f32 v69, v69
    v_exp_f32 v70, v70
    v_exp_f32 v71, v71
    v_mfma_f32_32x32x16_bf16 v[48:63], a[160:163], a[188:191], v[96:111]
    v_exp_f32 v72, v72
    v_cvt_pk_bf16_f32 v64, v64, v65
    v_cvt_pk_bf16_f32 v65, v66, v67
    v_cvt_pk_bf16_f32 v66, v68, v69
    v_cvt_pk_bf16_f32 v67, v70, v71
    v_exp_f32 v73, v73
    v_exp_f32 v74, v74
    v_exp_f32 v75, v75
    v_mfma_f32_32x32x16_bf16 v[128:143], a[152:155], v[64:67], v[128:143]
    v_exp_f32 v76, v76
    buffer_load_dwordx4 a[216:219], v30, s[52:55], s76 offen offset:2048
    buffer_load_dwordx4 a[220:223], v30, s[52:55], s76 offen offset:3072
    v_exp_f32 v77, v77
    v_exp_f32 v78, v78
    v_exp_f32 v79, v79
    v_cvt_pk_bf16_f32 v68, v72, v73
    v_cvt_pk_bf16_f32 v69, v74, v75
    v_cvt_pk_bf16_f32 v70, v76, v77
    v_cvt_pk_bf16_f32 v71, v78, v79
    v_exp_f32 v32, v32
    v_exp_f32 v33, v33
    v_exp_f32 v34, v34
    v_exp_f32 v35, v35
    v_mfma_f32_32x32x16_bf16 v[128:143], a[156:159], v[68:71], v[128:143]
    v_exp_f32 v36, v36
    v_exp_f32 v37, v37
    v_exp_f32 v38, v38
    v_exp_f32 v39, v39
    v_mfma_f32_32x32x16_bf16 v[64:79], v[144:147], v[152:155], v[192:207]
    v_mfma_f32_32x32x16_bf16 v[64:79], a[172:175], a[188:191], v[64:79]
    v_exp_f32 v40, v40
    v_cvt_pk_bf16_f32 v32, v32, v33
    v_cvt_pk_bf16_f32 v33, v34, v35
    v_cvt_pk_bf16_f32 v34, v36, v37
    v_cvt_pk_bf16_f32 v35, v38, v39
    v_exp_f32 v41, v41
    v_exp_f32 v42, v42
    v_exp_f32 v43, v43
    v_mfma_f32_32x32x16_bf16 v[112:127], a[164:167], v[32:35], v[112:127]
    v_exp_f32 v44, v44
    v_exp_f32 v45, v45
    v_exp_f32 v46, v46
    v_exp_f32 v47, v47
    v_cvt_pk_bf16_f32 v36, v40, v41
    v_cvt_pk_bf16_f32 v37, v42, v43
    v_cvt_pk_bf16_f32 v38, v44, v45
    v_cvt_pk_bf16_f32 v39, v46, v47
    v_exp_f32 v48, v48
    v_exp_f32 v49, v49
    v_exp_f32 v50, v50
    v_exp_f32 v51, v51
    v_mfma_f32_32x32x16_bf16 v[112:127], a[168:171], v[36:39], v[112:127]
    v_exp_f32 v52, v52
    v_exp_f32 v53, v53
    v_exp_f32 v54, v54
    v_exp_f32 v55, v55
    v_exp_f32 v56, v56
    v_cvt_pk_bf16_f32 v48, v48, v49
    v_cvt_pk_bf16_f32 v49, v50, v51
    v_cvt_pk_bf16_f32 v50, v52, v53
    v_cvt_pk_bf16_f32 v51, v54, v55
    v_exp_f32 v57, v57
    v_exp_f32 v58, v58
    v_exp_f32 v59, v59
    v_mfma_f32_32x32x16_bf16 v[128:143], a[164:167], v[48:51], v[128:143]
    v_exp_f32 v60, v60
    v_exp_f32 v61, v61
    v_exp_f32 v62, v62
    v_exp_f32 v63, v63
    v_cvt_pk_bf16_f32 v52, v56, v57
    v_cvt_pk_bf16_f32 v53, v58, v59
    v_cvt_pk_bf16_f32 v54, v60, v61
    v_cvt_pk_bf16_f32 v55, v62, v63
    v_exp_f32 v64, v64
    v_exp_f32 v65, v65
    v_exp_f32 v66, v66
    v_exp_f32 v67, v67
    v_mfma_f32_32x32x16_bf16 v[128:143], a[168:171], v[52:55], v[128:143]
    v_exp_f32 v68, v68
    v_exp_f32 v69, v69
    v_exp_f32 v70, v70
    v_exp_f32 v71, v71
    v_exp_f32 v72, v72
    v_cvt_pk_bf16_f32 v64, v64, v65
    v_cvt_pk_bf16_f32 v65, v66, v67
    v_cvt_pk_bf16_f32 v66, v68, v69
    v_cvt_pk_bf16_f32 v67, v70, v71
    v_exp_f32 v73, v73
    v_exp_f32 v74, v74
    v_exp_f32 v75, v75
    v_mfma_f32_32x32x16_bf16 v[128:143], a[176:179], v[64:67], v[128:143]
    v_exp_f32 v76, v76
    v_exp_f32 v77, v77
    v_exp_f32 v78, v78
    v_exp_f32 v79, v79
    v_cvt_pk_bf16_f32 v68, v72, v73
    v_cvt_pk_bf16_f32 v69, v74, v75
    v_cvt_pk_bf16_f32 v70, v76, v77
    v_cvt_pk_bf16_f32 v71, v78, v79
    s_nop 1
    v_mfma_f32_32x32x16_bf16 v[128:143], a[180:183], v[68:71], v[128:143]
    v_rcp_f32 v120, v120
    s_nop 0
    v_mul_f32 v112, v112, v120
    v_mul_f32 v113, v113, v120
    v_mul_f32 v114, v114, v120
    v_mul_f32 v115, v115, v120
    v_mul_f32 v116, v116, v120
    v_mul_f32 v117, v117, v120
    v_mul_f32 v118, v118, v120
    v_mul_f32 v119, v119, v120
    v_cvt_pk_bf16_f32 v112, v112, v113
    v_cvt_pk_bf16_f32 v113, v114, v115
    v_cvt_pk_bf16_f32 v114, v116, v117
    v_cvt_pk_bf16_f32 v115, v118, v119
    buffer_store_dwordx4 v[112:115], v1, s[52:55], s38 offen sc1
    v_rcp_f32 v136, v136
    s_nop 0
    v_mul_f32 v128, v128, v136
    v_mul_f32 v129, v129, v136
    v_mul_f32 v130, v130, v136
    v_mul_f32 v131, v131, v136
    v_mul_f32 v132, v132, v136
    v_mul_f32 v133, v133, v136
    v_mul_f32 v134, v134, v136
    v_mul_f32 v135, v135, v136
    v_cvt_pk_bf16_f32 v128, v128, v129
    v_cvt_pk_bf16_f32 v129, v130, v131
    v_cvt_pk_bf16_f32 v130, v132, v133
    v_cvt_pk_bf16_f32 v131, v134, v135
    buffer_store_dwordx4 v[128:131], v1, s[52:55], s39 offen sc1
    s_branch k_g2
k_rlo7:
    s_movk_i32 s101, 3000
k_rpo7:
    s_xor_b32 s83, s17, 0x20000
    buffer_load_dwordx4 v[32:35], v30, s[52:55], s83 offen offset:0 sc1
    buffer_load_dwordx4 v[36:39], v30, s[52:55], s83 offen offset:1024 sc1
    buffer_load_dwordx4 v[40:43], v30, s[52:55], s83 offen offset:2048 sc1
    buffer_load_dwordx4 v[44:47], v30, s[52:55], s83 offen offset:3072 sc1
    s_waitcnt vmcnt(0)
    v_max3_u32 v20, v32, v33, v34
    v_max3_u32 v21, v35, v36, v37
    v_max3_u32 v20, v38, v39, v20
    v_max3_u32 v21, v40, v41, v21
    v_max3_u32 v20, v42, v43, v20
    v_max3_u32 v21, v44, v45, v21
    v_max3_u32 v20, v46, v47, v20
    v_max_u32 v20, v20, v21
    v_cmp_eq_u32 vcc, -1, v20
    s_cbranch_vccz k_rbo7
    s_sub_u32 s101, s101, 1
    s_cbranch_scc0 k_rpo7
    s_branch k_rbo7
k_rlo8:
    s_movk_i32 s101, 3000
k_rpo8:
    s_xor_b32 s83, s17, 0x21000
    buffer_load_dwordx4 v[48:51], v30, s[52:55], s83 offen offset:0 sc1
    buffer_load_dwordx4 v[52:55], v30, s[52:55], s83 offen offset:1024 sc1
    buffer_load_dwordx4 v[56:59], v30, s[52:55], s83 offen offset:2048 sc1
    buffer_load_dwordx4 v[60:63], v30, s[52:55], s83 offen offset:3072 sc1
    s_waitcnt vmcnt(0)
    v_max3_u32 v20, v48, v49, v50
    v_max3_u32 v21, v51, v52, v53
    v_max3_u32 v20, v54, v55, v20
    v_max3_u32 v21, v56, v57, v21
    v_max3_u32 v20, v58, v59, v20
    v_max3_u32 v21, v60, v61, v21
    v_max3_u32 v20, v62, v63, v20
    v_max_u32 v20, v20, v21
    v_cmp_eq_u32 vcc, -1, v20
    s_cbranch_vccz k_rbo8
    s_sub_u32 s101, s101, 1
    s_cbranch_scc0 k_rpo8
    s_branch k_rbo8
k_rlp2:
    s_movk_i32 s101, 3000
k_rpp2:
    s_xor_b32 s83, s80, 0x1000
    buffer_load_dwordx4 v[72:75], v1, s[52:55], s83 offen offset:0 sc1
    buffer_load_dwordx4 v[76:79], v1, s[52:55], s83 offen offset:1024 sc1
    s_xor_b32 s83, s80, 0x1800
    buffer_load_dwordx4 v[80:83], v1, s[52:55], s83 offen offset:0 sc1
    buffer_load_dwordx4 v[84:87], v1, s[52:55], s83 offen offset:1024 sc1
    s_waitcnt vmcnt(0)
    v_xor_b32 v72, v72, v184
    v_xor_b32 v73, v73, v185
    v_xor_b32 v74, v74, v186
    v_xor_b32 v75, v75, v187
    v_or_b32 v21, v72, v73
    v_xor_b32 v76, v76, v184
    v_xor_b32 v77, v77, v185
    v_or_b32 v20, v74, v75
    v_xor_b32 v78, v78, v186
    v_xor_b32 v79, v79, v187
    v_or3_b32 v21, v76, v77, v21
    v_xor_b32 v80, v80, v184
    v_xor_b32 v81, v81, v185
    v_or3_b32 v20, v78, v79, v20
    v_xor_b32 v82, v82, v186
    v_xor_b32 v83, v83, v187
    v_or3_b32 v21, v80, v81, v21
    v_xor_b32 v84, v84, v184
    v_xor_b32 v85, v85, v185
    v_or3_b32 v20, v82, v83, v20
    v_xor_b32 v86, v86, v186
    v_xor_b32 v87, v87, v187
    v_or3_b32 v21, v84, v85, v21
    v_or3_b32 v20, v86, v87, v20
    v_bitop3_b32 v20, v20, v21, s81 bitop3:0xa8
    v_cmp_ne_u32 vcc, 0, v20
    s_cbranch_vccz k_rbp2
    s_sub_u32 s101, s101, 1
    s_cbranch_scc0 k_rpp2
    s_branch k_rbp2
k_rlp1:
    s_movk_i32 s101, 3000
k_rpp1:
    s_xor_b32 s83, s80, 0x800
    buffer_load_dwordx4 v[64:67], v1, s[52:55], s83 offen offset:0 sc1
    buffer_load_dwordx4 v[68:71], v1, s[52:55], s83 offen offset:1024 sc1
    s_waitcnt vmcnt(0)
    v_xor_b32 v64, v64, v184
    v_xor_b32 v65, v65, v185
    v_xor_b32 v66, v66, v186
    v_xor_b32 v67, v67, v187
    v_or_b32 v21, v64, v65
    v_xor_b32 v68, v68, v184
    v_xor_b32 v69, v69, v185
    v_or_b32 v20, v66, v67
    v_xor_b32 v70, v70, v186
    v_xor_b32 v71, v71, v187
    v_or3_b32 v21, v68, v69, v21
    v_or3_b32 v20, v70, v71, v20
    v_bitop3_b32 v20, v20, v21, s81 bitop3:0xa8
    v_cmp_ne_u32 vcc, 0, v20
    s_cbranch_vccz k_rbp1
    s_sub_u32 s101, s101, 1
    s_cbranch_scc0 k_rpp1
    s_branch k_rbp1
k_end:
    s_endpgm
.section .rodata,"a"
.p2align 6
.amdhsa_kernel parallel_sum__sliding_block__glu_gated_bilinear__prompt_kernel
  .amdhsa_next_free_vgpr 512
  .amdhsa_next_free_sgpr 102
  .amdhsa_accum_offset 256
  .amdhsa_group_segment_fixed_size 0
  .amdhsa_kernarg_size 80
  .amdhsa_user_sgpr_count 2
  .amdhsa_user_sgpr_kernarg_segment_ptr 1
  .amdhsa_system_sgpr_workgroup_id_x 1
.end_amdhsa_kernel
```
